```python
import torch

def _softmax(x, axis=-1):
    return torch.softmax(x, dim=axis)

def _gelu(x):
    return torch.nn.functional.gelu(x, approximate='tanh')

def _silu(x):
    return torch.nn.functional.silu(x)

def _sigmoid(x):
    return torch.sigmoid(x)

def _layernorm(x, axis=-1, eps=1e-05):
    m = x.mean(dim=axis, keepdim=True)
    v = x.var(dim=axis, keepdim=True, unbiased=False)
    return (x - m) / torch.sqrt(v + eps)

def _scatter_add(tgt, idx, src, axis=0):
    return tgt.clone().index_add_(axis, idx, src)

def _segment_sum(src, seg, n):
    out = torch.zeros((n,) + src.shape[1:], dtype=src.dtype)
    return out.index_add_(0, seg, src)

def _pad(x, pw):
    flat = tuple((v for pair in reversed(pw) for v in pair))
    return torch.nn.functional.pad(x, flat)
kernel_name = 'adaLN_cond__gqa_block_cached__glu_gated_bilinear__prompt'

def setup_inputs():

    _w = lambda a: (lambda t: t.to(torch.bfloat16) if t.is_floating_point() else t)(torch.as_tensor(a))

    def _A_setup():
        B, Sq, D = (1, 2048, 448)
        Hq, Hkv, Sk, Dh = (16, 8, 2048, 256)
        assert Hq % Hkv == 0, (Hq, Hkv)
        return {'x': _w((lambda *s: torch.randn(*s, dtype=torch.bfloat16) * 0.05)(B, Sq, D)), 'k_cache': _w((lambda *s: torch.randn(*s, dtype=torch.bfloat16) * 0.8)(B, Hkv, Sk, Dh)), 'v_cache': _w((lambda *s: torch.randn(*s, dtype=torch.bfloat16) * 3.2)(B, Hkv, Sk, Dh)), 'wq': _w((lambda *s: torch.randn(*s, dtype=torch.bfloat16) * 0.8)(D, Hq * Dh) * D ** (-0.5)), 'wo': _w((lambda *s: torch.randn(*s, dtype=torch.bfloat16) * 3.2)(Hq * Dh, D) * (Hq * Dh) ** (-0.5))}
    _A_in = _A_setup()

    def _B_setup():
        B, S, D, F = (1, 2048, 448, 1792)
        return {'x': _w((lambda *s: torch.randn(*s, dtype=torch.bfloat16) * 0.05)(B, S, D)), 'w_gate': _w((lambda *s: torch.randn(*s, dtype=torch.bfloat16) * 3.2)(D, F) * D ** (-0.5)), 'w_up': _w((lambda *s: torch.randn(*s, dtype=torch.bfloat16) * 3.2)(D, F) * D ** (-0.5)), 'w_down': _w((lambda *s: torch.randn(*s, dtype=torch.bfloat16) * 3.2)(F, D) * F ** (-0.5))}
    _B_in = _B_setup()
    return {'A_x': _A_in['x'], 'A_k_cache': _A_in['k_cache'], 'A_v_cache': _A_in['v_cache'], 'A_wq': _A_in['wq'], 'A_wo': _A_in['wo'], 'B_x': _B_in['x'], 'B_w_gate': _B_in['w_gate'], 'B_w_up': _B_in['w_up'], 'B_w_down': _B_in['w_down'], 'c': _w((lambda *s: torch.randn(*s, dtype=torch.bfloat16) * 0.4)(1, 448) * 8.0), 'w_mod': _w((lambda *s: torch.randn(*s, dtype=torch.bfloat16) * 0.4)(448, 6 * 448) * 448 ** (-0.5) * 8.0)}

def reference(A_x, A_k_cache, A_v_cache, A_wq, A_wo, B_x, B_w_gate, B_w_up, B_w_down, c, w_mod):

    def _A_ref(x, k_cache, v_cache, wq, wo):
        B, Sq, D = x.shape
        Hq, Dh = (16, 256)
        Hkv = k_cache.shape[1]
        rep = Hq // Hkv
        q = (lambda x, *d: x.permute(*d))((x @ wq).reshape(B, Sq, Hq, Dh), 0, 2, 1, 3)
        k = (lambda x, n, axis: torch.repeat_interleave(x, n, dim=axis))(k_cache, rep, axis=1)
        v = (lambda x, n, axis: torch.repeat_interleave(x, n, dim=axis))(v_cache, rep, axis=1)
        scores = torch.einsum('bhqd,bhkd->bhqk', q, k) * Dh ** (-0.5)
        p = _softmax(scores, axis=-1)
        o = torch.einsum('bhqk,bhkd->bhqd', p, v)
        return (lambda x, *d: x.permute(*d))(o, 0, 2, 1, 3).reshape(B, Sq, Hq * Dh) @ wo

    def _B_ref(x, w_gate, w_up, w_down):
        g = torch.einsum('bsd,df->bsf', x, w_gate)
        u = torch.einsum('bsd,df->bsf', x, w_up)
        h = g * u
        return torch.einsum('bsf,fd->bsd', h, w_down)
    x = A_x
    mod = (_silu(c) @ w_mod).reshape(c.shape[0], 6, 1, -1)
    sa, ca, ga, sb, cb, gb = (mod[:, 0].clone(), mod[:, 1].clone(), mod[:, 2].clone(), mod[:, 3].clone(), mod[:, 4].clone(), mod[:, 5].clone())
    h = _layernorm(x, axis=-1) * (1 + ca) + sa
    x = x + ga * _A_ref(h, A_k_cache, A_v_cache, A_wq, A_wo)
    h = _layernorm(x, axis=-1) * (1 + cb) + sb
    x = x + gb * _B_ref(h, B_w_gate, B_w_up, B_w_down)
    return x
```

```asm
; @launch kernel=k1_kernel grid=(256,1,1) block=(256,1,1) lds=163840
.amdgcn_target "amdgcn-amd-amdhsa--gfx950"
.text
.globl k1_kernel
.p2align 8
.type k1_kernel,@function
k1_kernel:
  s_cmp_ge_u32 s2, 256
  s_cbranch_scc1 K1_END
  s_mov_b32 s38, s2
  s_mov_b32 s39, 0
K1_TOP:
  s_load_dwordx4 s[88:91], s[0:1], 72
  s_load_dwordx4 s[92:95], s[0:1], 96
  s_load_dwordx2 s[46:47], s[0:1], 0
  s_load_dwordx8 s[48:55], s[0:1], 8
  s_load_dwordx4 s[96:99], s[0:1], 48
  s_load_dwordx2 s[100:101], s[0:1], 64
  v_lshrrev_b32 v1, 6, v0
  v_and_b32 v2, 63, v0
  s_and_b32 s4, s2, 7
  s_lshr_b32 s6, s2, 3
  v_readfirstlane_b32 s3, v1
  s_getpc_b64 s[58:59]
K1_PC:
  v_and_b32 v3, 7, v2
  v_lshl_add_u32 v3, v3, 2, v1
  v_lshlrev_b32 v3, 5, v3
  v_add_lshl_u32 v3, v3, s6, 6
  v_min_u32 v3, CODE_END-K1_PC-4, v3
  v_mov_b32 v5, s59
  v_add_co_u32 v4, vcc, s58, v3
  s_nop 1
  v_addc_co_u32 v5, vcc, 0, v5, vcc
  s_mov_b64 exec, 0xff
  global_load_dword v46, v[4:5], off
  s_mov_b64 exec, -1
  s_and_b32 s58, s2, 7
  s_lshl_b32 s58, s58, 1
  s_bfe_u32 s59, s2, 0x10003
  s_add_u32 s58, s58, s59
  s_and_b32 s59, s2, 0x70
  s_add_u32 s58, s58, s59
  s_cmp_ge_u32 s2, 80
  s_cselect_b32 s58, s2, s58
  v_lshlrev_b32 v53, 4, v2
  v_cmp_gt_u32 vcc, 56, v2
  v_mov_b32 v3, 0x7fff0000
  s_lshl_b32 s32, s3, 13
  s_lshl2_add_u32 s63, s6, s3
  s_mul_i32 s63, s63, 14336
  v_cndmask_b32 v54, v3, v53, vcc
  s_waitcnt lgkmcnt(0)
  s_mov_b32 s56, s94
  s_mov_b32 s57, s95
  s_mov_b32 s84, s88
  s_and_b32 s85, s89, 0xffff
  s_mov_b32 s86, 896
  s_mov_b32 s87, 0x20000
  s_mov_b32 s80, s90
  s_and_b32 s81, s91, 0xffff
  s_mov_b32 s82, 2408448
  s_mov_b32 s83, 0x20000
  s_add_u32 s28, s56, 16384
  s_addc_u32 s29, s57, 0
  s_and_b32 s29, s29, 0xffff
  s_mov_b32 s30, 3584
  s_mov_b32 s31, 0x20000
  s_add_u32 s24, s46, s63
  s_addc_u32 s25, s47, 0
  s_and_b32 s25, s25, 0xffff
  s_mov_b32 s26, 14336
  s_mov_b32 s27, 0x20000
  s_movk_i32 s44, 3584
  s_movk_i32 s45, 7168
  s_movk_i32 s46, 10752
  s_cmp_lt_u32 s58, 84
  s_cbranch_scc1 K1_P1
  buffer_load_dwordx4 v[64:67], v54, s[24:27], 0 offen offset:0
  buffer_load_dwordx4 v[68:71], v54, s[24:27], 0 offen offset:896
  buffer_load_dwordx4 v[72:75], v54, s[24:27], 0 offen offset:1792
  buffer_load_dwordx4 v[76:79], v54, s[24:27], 0 offen offset:2688
  buffer_load_dwordx4 v[80:83], v54, s[24:27], s44 offen offset:0
  buffer_load_dwordx4 v[84:87], v54, s[24:27], s44 offen offset:896
  s_branch K1_NP1
K1_P1:
  s_lshl_b32 s61, s58, 7
  v_mov_b32 v1, 4
  v_lshlrev_b32 v3, 3, v2
  v_mov_b32 v4, 0
  v_mov_b32 v5, 0
  s_lshl2_add_u32 s60, s61, 16384
  s_mov_b32 s30, 0x10000
  buffer_store_dwordx2 v[4:5], v3, s[28:31], s60 offen sc1
  s_mov_b32 s30, 3584
  buffer_load_dword v188, v1, s[28:31], s61 offen sc1
  v_lshrrev_b32 v172, 2, v0
  v_and_b32 v173, 3, v0
  v_mul_u32_u24 v174, 5376, v172
  v_lshl_add_u32 v174, v173, 4, v174
  v_lshlrev_b32 v175, 1, v172
  s_lshl_b32 s59, s58, 6
  buffer_load_short_d16_hi v128, v175, s[84:87], 0 offen offset:0
  buffer_load_short_d16_hi v129, v175, s[84:87], 0 offen offset:128
  buffer_load_short_d16_hi v130, v175, s[84:87], 0 offen offset:256
  buffer_load_short_d16_hi v131, v175, s[84:87], 0 offen offset:384
  buffer_load_short_d16_hi v132, v175, s[84:87], 0 offen offset:512
  buffer_load_short_d16_hi v133, v175, s[84:87], 0 offen offset:640
  buffer_load_short_d16_hi v134, v175, s[84:87], 0 offen offset:768
  buffer_load_dwordx4 v[136:139], v174, s[80:83], s59 offen nt
  s_add_u32 s59, s59, 344064
  buffer_load_dwordx4 v[140:143], v174, s[80:83], s59 offen nt
  s_add_u32 s59, s59, 344064
  buffer_load_dwordx4 v[144:147], v174, s[80:83], s59 offen nt
  s_add_u32 s59, s59, 344064
  buffer_load_dwordx4 v[148:151], v174, s[80:83], s59 offen nt
  s_add_u32 s59, s59, 344064
  buffer_load_dwordx4 v[152:155], v174, s[80:83], s59 offen nt
  s_add_u32 s59, s59, 344064
  buffer_load_dwordx4 v[156:159], v174, s[80:83], s59 offen nt
  s_add_u32 s59, s59, 344064
  buffer_load_dwordx4 v[160:163], v174, s[80:83], s59 offen nt
K1_NP1:
  s_lshl2_add_u32 s42, s4, s3
  s_lshl_b32 s42, s42, 8
  s_add_u32 s16, s52, s42
  s_addc_u32 s17, s53, 0
  s_and_b32 s17, s17, 0xffff
  s_mov_b32 s18, 3662080
  s_mov_b32 s19, 0x20000
  v_lshrrev_b32 v1, 1, v2
  v_and_b32 v3, 1, v2
  v_min_u32 v1, 7, v1
  v_lshlrev_b32 v3, 6, v3
  v_lshl_add_u32 v1, v1, 13, v3
  s_mul_i32 s41, s6, 65536
  s_add_u32 s41, s41, 0
  buffer_load_dword v46, v1, s[16:19], s41 offen
  v_lshrrev_b32 v1, 3, v2
  v_and_b32 v3, 6, v1
  v_and_b32 v47, 7, v2
  v_xor_b32 v3, v3, v47
  v_lshlrev_b32 v47, 4, v3
  v_and_b32 v3, 4, v1
  v_add_u32 v1, v1, v3
  v_lshl_add_u32 v48, v1, 13, v47
  v_add_u32 v49, 130048, v48
  v_add_u32 v50, 30720, v48
  v_add_u32 v51, 160768, v48
  s_lshl_b32 s42, s4, 20
  s_add_u32 s8, s48, s42
  s_addc_u32 s9, s49, 0
  s_and_b32 s9, s9, 0xffff
  s_mov_b32 s10, 1048576
  s_mov_b32 s11, 0x20000
  s_add_u32 s12, s50, s42
  s_addc_u32 s13, s51, 0
  s_and_b32 s13, s13, 0xffff
  s_mov_b32 s14, 1048576
  s_mov_b32 s15, 0x20000
  s_and_b32 s5, s6, 24
  s_lshl_b32 s34, s5, 15
  s_add_u32 s34, s34, s32
  s_add_u32 s35, s34, 4096
  s_add_u32 s36, s34, 32768
  s_and_b32 s36, s36, 0xfffff
  s_add_u32 s37, s36, 4096
  s_mov_b32 s20, s92
  s_and_b32 s21, s93, 0xffff
  s_mov_b32 s22, 256
  s_mov_b32 s23, 0x20000
  v_lshrrev_b32 v1, 2, v2
  v_and_b32 v3, 3, v2
  v_lshlrev_b32 v3, 3, v3
  v_lshl_add_u32 v3, v1, 7, v3
  v_add_u32 v3, s32, v3
  v_bfe_u32 v1, v2, 3, 2
  v_add_u32 v3, 65536, v3
  v_xor_b32 v47, 0, v1
  v_lshl_add_u32 v42, v47, 5, v3
  v_xor_b32 v47, 1, v1
  v_lshl_add_u32 v43, v47, 5, v3
  v_xor_b32 v47, 2, v1
  v_lshl_add_u32 v44, v47, 5, v3
  v_xor_b32 v47, 3, v1
  v_lshl_add_u32 v45, v47, 5, v3
  v_and_b32 v3, 1, v2
  v_xor_b32 v1, v1, v3
  v_bfe_u32 v3, v2, 1, 1
  v_lshl_add_u32 v1, v1, 1, v3
  v_lshrrev_b32 v3, 2, v2
  v_lshl_add_u32 v3, v3, 7, s32
  v_lshl_add_u32 v56, v1, 4, v3
  v_xor_b32 v57, 64, v56
  v_add_u32 v58, 65536, v56
  v_add_u32 v60, 131072, v56
  v_add_u32 v59, 65536, v57
  v_add_u32 v61, 131072, v57
  s_mov_b32 s62, 0x5f800000
  v_lshrrev_b32 v1, 5, v2
  v_and_b32 v3, 31, v2
  v_lshlrev_b32 v47, 1, v1
  v_xor_b32 v52, v3, v47
  v_xor_b32 v3, v3, v1
  v_xor_b32 v47, 0, v3
  v_lshlrev_b32 v47, 4, v47
  v_lshl_add_u32 v34, v1, 9, v47
  v_xor_b32 v47, 0, v52
  v_lshlrev_b32 v47, 4, v47
  v_lshl_add_u32 v38, v1, 9, v47
  v_xor_b32 v47, 4, v3
  v_lshlrev_b32 v47, 4, v47
  v_lshl_add_u32 v35, v1, 9, v47
  v_xor_b32 v47, 4, v52
  v_lshlrev_b32 v47, 4, v47
  v_lshl_add_u32 v39, v1, 9, v47
  v_xor_b32 v47, 8, v3
  v_lshlrev_b32 v47, 4, v47
  v_lshl_add_u32 v36, v1, 9, v47
  v_xor_b32 v47, 8, v52
  v_lshlrev_b32 v47, 4, v47
  v_lshl_add_u32 v40, v1, 9, v47
  v_xor_b32 v47, 12, v3
  v_lshlrev_b32 v47, 4, v47
  v_lshl_add_u32 v37, v1, 9, v47
  v_xor_b32 v47, 12, v52
  v_lshlrev_b32 v47, 4, v47
  v_lshl_add_u32 v41, v1, 9, v47
  s_and_b32 s42, s3, 1
  s_mul_i32 s42, s42, 16640
  v_and_b32 v1, 15, v2
  v_lshlrev_b32 v1, 9, v1
  v_add_u32 v1, s42, v1
  v_and_b32 v3, 6, v2
  v_lshlrev_b32 v3, 1, v3
  v_and_b32 v47, 1, v2
  v_or_b32 v3, v3, v47
  v_bfe_u32 v47, v2, 4, 1
  v_lshlrev_b32 v47, 1, v47
  v_xor_b32 v3, v3, v47
  v_lshrrev_b32 v47, 5, v2
  v_xor_b32 v3, v3, v47
  v_xor_b32 v47, 0, v3
  v_lshl_add_u32 v8, v47, 4, v1
  v_xor_b32 v12, 0x100, v8
  v_xor_b32 v47, 4, v3
  v_lshl_add_u32 v9, v47, 4, v1
  v_xor_b32 v13, 0x100, v9
  v_xor_b32 v47, 8, v3
  v_lshl_add_u32 v10, v47, 4, v1
  v_xor_b32 v14, 0x100, v10
  v_xor_b32 v47, 12, v3
  v_lshl_add_u32 v11, v47, 4, v1
  v_xor_b32 v15, 0x100, v11
  v_lshrrev_b32 v52, 2, v2
  v_lshlrev_b32 v1, 9, v52
  v_add_u32 v1, s42, v1
  v_add_u32 v1, 65536, v1
  v_and_b32 v47, 1, v2
  v_lshl_add_u32 v1, v47, 3, v1
  v_and_b32 v3, 7, v52
  v_lshlrev_b32 v3, 1, v3
  v_bfe_u32 v47, v2, 1, 1
  v_xor_b32 v3, v3, v47
  v_xor_b32 v47, 0, v3
  v_lshl_add_u32 v16, v47, 4, v1
  v_xor_b32 v24, 0x4000, v16
  v_xor_b32 v47, 2, v3
  v_lshl_add_u32 v17, v47, 4, v1
  v_xor_b32 v25, 0x4000, v17
  v_xor_b32 v47, 4, v3
  v_lshl_add_u32 v18, v47, 4, v1
  v_xor_b32 v26, 0x4000, v18
  v_xor_b32 v47, 6, v3
  v_lshl_add_u32 v19, v47, 4, v1
  v_xor_b32 v27, 0x4000, v19
  v_xor_b32 v47, 8, v3
  v_lshl_add_u32 v20, v47, 4, v1
  v_xor_b32 v28, 0x4000, v20
  v_xor_b32 v47, 10, v3
  v_lshl_add_u32 v21, v47, 4, v1
  v_xor_b32 v29, 0x4000, v21
  v_xor_b32 v47, 12, v3
  v_lshl_add_u32 v22, v47, 4, v1
  v_xor_b32 v30, 0x4000, v22
  v_xor_b32 v47, 14, v3
  v_lshl_add_u32 v23, v47, 4, v1
  v_xor_b32 v31, 0x4000, v23
  s_lshl_b32 s42, s3, 12
  s_add_u32 s42, s42, 131072
  v_lshlrev_b32 v32, 3, v2
  v_add_u32 v32, s42, v32
  v_xor_b32 v33, 0x1000, v32
  v_lshrrev_b32 v1, 4, v2
  v_xor_b32 v3, v1, v2
  v_xor_b32 v47, 0, v3
  v_lshlrev_b32 v4, 4, v47
  v_xor_b32 v47, 4, v3
  v_lshlrev_b32 v5, 4, v47
  v_xor_b32 v47, 8, v3
  v_lshlrev_b32 v6, 4, v47
  v_xor_b32 v47, 12, v3
  v_lshlrev_b32 v7, 4, v47
  v_mov_b32 v52, v54
  s_and_b32 s7, s6, 7
  s_lshl2_add_u32 s7, s7, s3
  s_mul_i32 s7, s7, 1024
  s_lshl_b32 s59, s5, 15
  s_add_u32 s7, s7, s59
  s_cmp_lt_u32 s58, 84
  s_cbranch_scc1 K1_CRIT
  s_branch K1_NP2
K1_CRIT:
  s_waitcnt vmcnt(15)
  s_mov_b32 s60, 0x9e3779b1
  v_mul_lo_u32 v189, v188, s60
  v_add_u32 v189, 0x7f4a7c15, v189
  v_or_b32 v189, 0x80000000, v189
  v_cmp_eq_u32 vcc, v188, v189
  v_xor_b32 v190, 1, v189
  s_and_b32 s60, s58, 7
  s_lshl_b32 s60, s60, 4
  s_lshr_b32 s61, s58, 3
  s_lshl2_add_u32 s60, s61, s60
  s_cmp_lt_u32 s58, 28
  s_cselect_b32 s60, s60, 256
  v_cndmask_b32 v189, v189, v190, vcc
  v_lshlrev_b32 v190, 8, v0
  v_add_u32 v190, s60, v190
  buffer_store_dword v189, v190, s[20:23], 0 offen sc1
  buffer_load_dwordx4 v[64:67], v52, s[24:27], 0 offen offset:0
  buffer_load_dwordx4 v[68:71], v52, s[24:27], 0 offen offset:896
  buffer_load_dwordx4 v[72:75], v52, s[24:27], 0 offen offset:1792
  s_waitcnt vmcnt(12)
  v_and_b32 v128, 0xffff0000, v128
  v_and_b32 v129, 0xffff0000, v129
  v_and_b32 v130, 0xffff0000, v130
  v_and_b32 v131, 0xffff0000, v131
  v_and_b32 v132, 0xffff0000, v132
  v_and_b32 v133, 0xffff0000, v133
  v_and_b32 v134, 0xffff0000, v134
  v_mul_f32 v172, 0xbfb8aa3b, v128
  v_mul_f32 v173, 0xbfb8aa3b, v129
  v_mul_f32 v174, 0xbfb8aa3b, v130
  v_mul_f32 v175, 0xbfb8aa3b, v131
  v_mul_f32 v176, 0xbfb8aa3b, v132
  v_mul_f32 v177, 0xbfb8aa3b, v133
  v_mul_f32 v178, 0xbfb8aa3b, v134
  v_exp_f32 v172, v172
  v_exp_f32 v173, v173
  v_exp_f32 v174, v174
  v_exp_f32 v175, v175
  v_exp_f32 v176, v176
  v_exp_f32 v177, v177
  v_exp_f32 v178, v178
  v_add_f32 v172, 1.0, v172
  v_add_f32 v173, 1.0, v173
  v_add_f32 v174, 1.0, v174
  v_add_f32 v175, 1.0, v175
  v_add_f32 v176, 1.0, v176
  v_add_f32 v177, 1.0, v177
  v_add_f32 v178, 1.0, v178
  v_rcp_f32 v172, v172
  v_rcp_f32 v173, v173
  v_rcp_f32 v174, v174
  v_rcp_f32 v175, v175
  v_rcp_f32 v176, v176
  v_rcp_f32 v177, v177
  v_rcp_f32 v178, v178
  v_mul_f32 v128, v128, v172
  v_mul_f32 v129, v129, v173
  v_mul_f32 v130, v130, v174
  v_mul_f32 v131, v131, v175
  v_mul_f32 v132, v132, v176
  v_mul_f32 v133, v133, v177
  v_mul_f32 v134, v134, v178
  v_cvt_pk_bf16_f32 v128, v128, v129
  v_cvt_pk_bf16_f32 v129, v130, v131
  v_cvt_pk_bf16_f32 v130, v132, v133
  v_cvt_pk_bf16_f32 v131, v134, 0
  s_mov_b32 s60, 0x05040100
  s_mov_b32 s61, 0x07060302
  v_lshlrev_b32 v132, 5, v0
  s_waitcnt vmcnt(10)
  buffer_load_dwordx4 v[76:79], v52, s[24:27], 0 offen offset:2688
  buffer_load_dwordx4 v[80:83], v52, s[24:27], s44 offen offset:0
  v_perm_b32 v172, v140, v136, s60
  v_perm_b32 v173, v140, v136, s61
  v_perm_b32 v174, v141, v137, s60
  v_perm_b32 v175, v141, v137, s61
  v_perm_b32 v176, v142, v138, s60
  v_perm_b32 v177, v142, v138, s61
  v_perm_b32 v178, v143, v139, s60
  v_perm_b32 v179, v143, v139, s61
  v_dot2_f32_bf16 v164, v172, v128, 0
  v_dot2_f32_bf16 v165, v173, v128, 0
  v_dot2_f32_bf16 v166, v174, v128, 0
  v_dot2_f32_bf16 v167, v175, v128, 0
  v_dot2_f32_bf16 v168, v176, v128, 0
  v_dot2_f32_bf16 v169, v177, v128, 0
  v_dot2_f32_bf16 v170, v178, v128, 0
  v_dot2_f32_bf16 v171, v179, v128, 0
  s_waitcnt vmcnt(10)
  buffer_load_dwordx4 v[84:87], v52, s[24:27], s44 offen offset:896
  v_perm_b32 v172, v148, v144, s60
  v_perm_b32 v173, v148, v144, s61
  v_perm_b32 v174, v149, v145, s60
  v_perm_b32 v175, v149, v145, s61
  v_perm_b32 v176, v150, v146, s60
  v_perm_b32 v177, v150, v146, s61
  v_perm_b32 v178, v151, v147, s60
  v_perm_b32 v179, v151, v147, s61
  v_dot2_f32_bf16 v164, v172, v129, v164
  v_dot2_f32_bf16 v165, v173, v129, v165
  v_dot2_f32_bf16 v166, v174, v129, v166
  v_dot2_f32_bf16 v167, v175, v129, v167
  v_dot2_f32_bf16 v168, v176, v129, v168
  v_dot2_f32_bf16 v169, v177, v129, v169
  v_dot2_f32_bf16 v170, v178, v129, v170
  v_dot2_f32_bf16 v171, v179, v129, v171
  s_waitcnt vmcnt(9)
  v_perm_b32 v172, v156, v152, s60
  v_perm_b32 v173, v156, v152, s61
  v_perm_b32 v174, v157, v153, s60
  v_perm_b32 v175, v157, v153, s61
  v_perm_b32 v176, v158, v154, s60
  v_perm_b32 v177, v158, v154, s61
  v_perm_b32 v178, v159, v155, s60
  v_perm_b32 v179, v159, v155, s61
  v_dot2_f32_bf16 v164, v172, v130, v164
  v_dot2_f32_bf16 v165, v173, v130, v165
  v_dot2_f32_bf16 v166, v174, v130, v166
  v_dot2_f32_bf16 v167, v175, v130, v167
  v_dot2_f32_bf16 v168, v176, v130, v168
  v_dot2_f32_bf16 v169, v177, v130, v169
  v_dot2_f32_bf16 v170, v178, v130, v170
  v_dot2_f32_bf16 v171, v179, v130, v171
  s_waitcnt vmcnt(8)
  v_perm_b32 v172, v160, v160, s60
  v_perm_b32 v173, v160, v160, s61
  v_perm_b32 v174, v161, v161, s60
  v_perm_b32 v175, v161, v161, s61
  v_perm_b32 v176, v162, v162, s60
  v_perm_b32 v177, v162, v162, s61
  v_perm_b32 v178, v163, v163, s60
  v_perm_b32 v179, v163, v163, s61
  v_dot2_f32_bf16 v164, v172, v131, v164
  v_dot2_f32_bf16 v165, v173, v131, v165
  v_dot2_f32_bf16 v166, v174, v131, v166
  v_dot2_f32_bf16 v167, v175, v131, v167
  v_dot2_f32_bf16 v168, v176, v131, v168
  v_dot2_f32_bf16 v169, v177, v131, v169
  v_dot2_f32_bf16 v170, v178, v131, v170
  v_dot2_f32_bf16 v171, v179, v131, v171
  ds_write_b128 v132, v[164:167]
  s_nop 2
  ds_write_b128 v132, v[168:171] offset:16
  s_mul_i32 s60, s58, 4682
  s_lshr_b32 s60, s60, 16
  s_waitcnt lgkmcnt(0)
  s_barrier
  s_cmp_lg_u32 s3, 0
  s_cbranch_scc1 K1_NP2
  v_and_b32 v128, 31, v2
  v_lshrrev_b32 v129, 5, v2
  v_lshlrev_b32 v130, 2, v128
  v_lshl_add_u32 v130, v129, 12, v130
  v_add_u32 v131, 128, v130
  ds_read2st64_b32 v[136:137], v130 offset0:0 offset1:1
  ds_read2st64_b32 v[138:139], v131 offset0:0 offset1:1
  ds_read2st64_b32 v[140:141], v130 offset0:2 offset1:3
  ds_read2st64_b32 v[142:143], v131 offset0:2 offset1:3
  ds_read2st64_b32 v[144:145], v130 offset0:4 offset1:5
  ds_read2st64_b32 v[146:147], v131 offset0:4 offset1:5
  ds_read2st64_b32 v[148:149], v130 offset0:6 offset1:7
  ds_read2st64_b32 v[150:151], v131 offset0:6 offset1:7
  ds_read2st64_b32 v[152:153], v130 offset0:8 offset1:9
  ds_read2st64_b32 v[154:155], v131 offset0:8 offset1:9
  ds_read2st64_b32 v[156:157], v130 offset0:10 offset1:11
  ds_read2st64_b32 v[158:159], v131 offset0:10 offset1:11
  ds_read2st64_b32 v[160:161], v130 offset0:12 offset1:13
  ds_read2st64_b32 v[162:163], v131 offset0:12 offset1:13
  ds_read2st64_b32 v[164:165], v130 offset0:14 offset1:15
  ds_read2st64_b32 v[166:167], v131 offset0:14 offset1:15
  s_cmp_eq_u32 s60, 1
  s_cselect_b32 s61, 1.0, 0
  s_cmp_eq_u32 s60, 4
  s_cselect_b32 s61, 1.0, s61
  s_waitcnt lgkmcnt(12)
  v_pk_add_f32 v[136:137], v[136:137], v[138:139]
  v_pk_add_f32 v[140:141], v[140:141], v[142:143]
  v_pk_add_f32 v[136:137], v[136:137], v[140:141]
  s_waitcnt lgkmcnt(8)
  v_pk_add_f32 v[144:145], v[144:145], v[146:147]
  v_pk_add_f32 v[148:149], v[148:149], v[150:151]
  v_pk_add_f32 v[144:145], v[144:145], v[148:149]
  v_pk_add_f32 v[136:137], v[136:137], v[144:145]
  s_waitcnt lgkmcnt(4)
  v_pk_add_f32 v[152:153], v[152:153], v[154:155]
  v_pk_add_f32 v[156:157], v[156:157], v[158:159]
  v_pk_add_f32 v[152:153], v[152:153], v[156:157]
  v_pk_add_f32 v[136:137], v[136:137], v[152:153]
  s_waitcnt lgkmcnt(0)
  v_pk_add_f32 v[160:161], v[160:161], v[162:163]
  v_pk_add_f32 v[164:165], v[164:165], v[166:167]
  v_pk_add_f32 v[160:161], v[160:161], v[164:165]
  v_pk_add_f32 v[136:137], v[136:137], v[160:161]
  v_add_f32 v136, v136, v137
  v_mov_b32 v137, v136
  s_nop 1
  v_permlane32_swap_b32 v136, v137
  v_add_f32 v136, v136, v137
  v_cvt_pk_bf16_f32 v136, v136, v136
  v_and_b32 v136, 0xffff0000, v136
  v_add_f32 v136, s61, v136
  s_cmp_lt_u32 s58, 28
  s_cbranch_scc0 K1_LATE
  s_nop 1
  v_mov_b32_dpp v137, v136 quad_perm:[1,0,3,2] row_mask:0xf bank_mask:0xf
  v_cvt_pk_bf16_f32 v136, v136, v137
  v_mov_b32 v137, v189
  v_lshlrev_b32 v128, 2, v2
  v_and_b32 v129, 33, v2
  v_lshl_add_u32 v128, v129, 16, v128
  s_lshl_b32 s61, s58, 7
  buffer_store_dwordx2 v[136:137], v128, s[28:31], s61 offen sc1
  s_branch K1_NP2
K1_LATE:
  v_cvt_pk_bf16_f32 v136, v136, v136
  v_and_b32 v136, 0xffff0000, v136
  s_mul_i32 s61, s60, 14
  s_sub_u32 s61, s58, s61
  s_mov_b32 s59, 4096
  s_cmp_eq_u32 s60, 3
  s_cselect_b32 s59, 8192, s59
  s_cmp_eq_u32 s60, 4
  s_cselect_b32 s59, 6144, s59
  s_cmp_eq_u32 s60, 5
  s_cselect_b32 s59, 10240, s59
  s_lshl_b32 s61, s61, 7
  s_add_u32 s59, s59, s61
  s_add_u32 s84, s56, s59
  s_addc_u32 s85, s57, 0
  s_and_b32 s85, s85, 0xffff
  s_mov_b32 s86, 128
  s_mov_b32 s87, 0x20000
  v_bfe_u32 v128, v2, 2, 2
  v_lshlrev_b32 v128, 5, v128
  v_and_b32 v129, 3, v2
  v_lshl_add_u32 v128, v129, 2, v128
  v_and_b32 v129, 16, v2
  v_add_u32 v128, v128, v129
  v_and_b32 v129, 32, v2
  v_lshl_add_u32 v128, v129, 2, v128
  buffer_store_dword v136, v128, s[84:87], 0 offen sc1
  s_mov_b32 s84, s88
  s_and_b32 s85, s89, 0xffff
  s_mov_b32 s86, 896
  s_mov_b32 s87, 0x20000
K1_NP2:
  s_bitcmp1_b32 s39, 15
  s_cbranch_scc1 T_FB
  s_mov_b32 s60, 0x3f803f80
  s_waitcnt vmcnt(5)
  v_dot2_f32_bf16 v54, v64, s60, 0
  v_dot2_f32_bf16 v55, v64, v64, 0
  v_dot2_f32_bf16 v54, v65, s60, v54
  v_dot2_f32_bf16 v55, v65, v65, v55
  v_dot2_f32_bf16 v54, v66, s60, v54
  v_dot2_f32_bf16 v55, v66, v66, v55
  v_dot2_f32_bf16 v54, v67, s60, v54
  v_dot2_f32_bf16 v55, v67, v67, v55
  v_lshlrev_b32 v128, 16, v64
  v_and_b32 v129, 0xffff0000, v64
  v_lshlrev_b32 v130, 16, v65
  v_and_b32 v131, 0xffff0000, v65
  v_lshlrev_b32 v132, 16, v66
  v_and_b32 v133, 0xffff0000, v66
  v_lshlrev_b32 v134, 16, v67
  v_and_b32 v135, 0xffff0000, v67
  buffer_load_dwordx4 v[88:91], v52, s[24:27], s44 offen offset:1792
  buffer_load_dwordx4 v[92:95], v52, s[24:27], s44 offen offset:2688
  s_waitcnt vmcnt(6)
  v_dot2_f32_bf16 v64, v68, s60, 0
  v_dot2_f32_bf16 v65, v68, v68, 0
  v_dot2_f32_bf16 v64, v69, s60, v64
  v_dot2_f32_bf16 v65, v69, v69, v65
  v_dot2_f32_bf16 v64, v70, s60, v64
  v_dot2_f32_bf16 v65, v70, v70, v65
  v_dot2_f32_bf16 v64, v71, s60, v64
  v_dot2_f32_bf16 v65, v71, v71, v65
  v_lshlrev_b32 v136, 16, v68
  v_and_b32 v137, 0xffff0000, v68
  v_lshlrev_b32 v138, 16, v69
  v_and_b32 v139, 0xffff0000, v69
  v_permlane32_swap_b32 v54, v64
  v_permlane32_swap_b32 v55, v65
  v_pk_add_f32 v[54:55], v[54:55], v[64:65]
  v_lshlrev_b32 v140, 16, v70
  v_and_b32 v141, 0xffff0000, v70
  v_lshlrev_b32 v142, 16, v71
  v_and_b32 v143, 0xffff0000, v71
  buffer_load_dwordx4 v[96:99], v52, s[24:27], s45 offen offset:0
  buffer_load_dwordx4 v[100:103], v52, s[24:27], s45 offen offset:896
  s_waitcnt vmcnt(7)
  v_dot2_f32_bf16 v68, v72, s60, 0
  v_dot2_f32_bf16 v69, v72, v72, 0
  v_dot2_f32_bf16 v68, v73, s60, v68
  v_dot2_f32_bf16 v69, v73, v73, v69
  v_dot2_f32_bf16 v68, v74, s60, v68
  v_dot2_f32_bf16 v69, v74, v74, v69
  v_dot2_f32_bf16 v68, v75, s60, v68
  v_dot2_f32_bf16 v69, v75, v75, v69
  v_lshlrev_b32 v144, 16, v72
  v_and_b32 v145, 0xffff0000, v72
  v_lshlrev_b32 v146, 16, v73
  v_and_b32 v147, 0xffff0000, v73
  v_lshlrev_b32 v148, 16, v74
  v_and_b32 v149, 0xffff0000, v74
  v_lshlrev_b32 v150, 16, v75
  v_and_b32 v151, 0xffff0000, v75
  buffer_load_dwordx4 v[104:107], v52, s[24:27], s45 offen offset:1792
  buffer_load_dwordx4 v[108:111], v52, s[24:27], s45 offen offset:2688
  s_waitcnt vmcnt(8)
  v_dot2_f32_bf16 v72, v76, s60, 0
  v_dot2_f32_bf16 v73, v76, v76, 0
  v_dot2_f32_bf16 v72, v77, s60, v72
  v_dot2_f32_bf16 v73, v77, v77, v73
  v_dot2_f32_bf16 v72, v78, s60, v72
  v_dot2_f32_bf16 v73, v78, v78, v73
  v_dot2_f32_bf16 v72, v79, s60, v72
  v_dot2_f32_bf16 v73, v79, v79, v73
  v_lshlrev_b32 v152, 16, v76
  v_and_b32 v153, 0xffff0000, v76
  v_lshlrev_b32 v154, 16, v77
  v_and_b32 v155, 0xffff0000, v77
  v_permlane32_swap_b32 v68, v72
  v_permlane32_swap_b32 v69, v73
  v_pk_add_f32 v[68:69], v[68:69], v[72:73]
  v_lshlrev_b32 v156, 16, v78
  v_and_b32 v157, 0xffff0000, v78
  v_permlane16_swap_b32 v54, v68
  v_permlane16_swap_b32 v55, v69
  v_pk_add_f32 v[54:55], v[54:55], v[68:69]
  v_lshlrev_b32 v158, 16, v79
  v_and_b32 v159, 0xffff0000, v79
  buffer_load_dwordx4 v[112:115], v52, s[24:27], s46 offen offset:0
  buffer_load_dwordx4 v[116:119], v52, s[24:27], s46 offen offset:896
  s_waitcnt vmcnt(9)
  v_dot2_f32_bf16 v76, v80, s60, 0
  v_dot2_f32_bf16 v77, v80, v80, 0
  v_dot2_f32_bf16 v76, v81, s60, v76
  v_dot2_f32_bf16 v77, v81, v81, v77
  v_dot2_f32_bf16 v76, v82, s60, v76
  v_dot2_f32_bf16 v77, v82, v82, v77
  v_dot2_f32_bf16 v76, v83, s60, v76
  v_dot2_f32_bf16 v77, v83, v83, v77
  v_lshlrev_b32 v160, 16, v80
  v_and_b32 v161, 0xffff0000, v80
  v_lshlrev_b32 v162, 16, v81
  v_and_b32 v163, 0xffff0000, v81
  v_lshlrev_b32 v164, 16, v82
  v_and_b32 v165, 0xffff0000, v82
  v_lshlrev_b32 v166, 16, v83
  v_and_b32 v167, 0xffff0000, v83
  buffer_load_dwordx4 v[120:123], v52, s[24:27], s46 offen offset:1792
  buffer_load_dwordx4 v[124:127], v52, s[24:27], s46 offen offset:2688
  s_waitcnt vmcnt(10)
  v_dot2_f32_bf16 v80, v84, s60, 0
  v_dot2_f32_bf16 v81, v84, v84, 0
  v_dot2_f32_bf16 v80, v85, s60, v80
  v_dot2_f32_bf16 v81, v85, v85, v81
  v_dot2_f32_bf16 v80, v86, s60, v80
  v_dot2_f32_bf16 v81, v86, v86, v81
  v_dot2_f32_bf16 v80, v87, s60, v80
  v_dot2_f32_bf16 v81, v87, v87, v81
  v_lshlrev_b32 v168, 16, v84
  v_and_b32 v169, 0xffff0000, v84
  v_lshlrev_b32 v170, 16, v85
  v_and_b32 v171, 0xffff0000, v85
  v_permlane32_swap_b32 v76, v80
  v_permlane32_swap_b32 v77, v81
  v_pk_add_f32 v[76:77], v[76:77], v[80:81]
  v_lshlrev_b32 v172, 16, v86
  v_and_b32 v173, 0xffff0000, v86
  v_lshlrev_b32 v174, 16, v87
  v_and_b32 v175, 0xffff0000, v87
  v_lshrrev_b32 v1, 1, v2
  v_and_b32 v3, 1, v2
  v_min_u32 v1, 5, v1
  v_lshlrev_b32 v3, 6, v3
  v_lshl_add_u32 v1, v1, 13, v3
  s_mul_i32 s41, s6, 49152
  s_add_u32 s41, s41, 2097152
  buffer_load_dword v46, v1, s[16:19], s41 offen
  v_lshrrev_b32 v1, 1, v2
  v_and_b32 v3, 1, v2
  v_min_u32 v1, 13, v1
  v_lshlrev_b32 v3, 6, v3
  v_lshl_add_u32 v1, v1, 13, v3
  s_mul_i32 s41, s6, 114688
  s_add_u32 s41, s41, 128
  buffer_load_dword v46, v1, s[16:19], s41 offen
  s_waitcnt vmcnt(11)
  v_dot2_f32_bf16 v84, v88, s60, 0
  v_dot2_f32_bf16 v85, v88, v88, 0
  v_dot2_f32_bf16 v84, v89, s60, v84
  v_dot2_f32_bf16 v85, v89, v89, v85
  v_dot2_f32_bf16 v84, v90, s60, v84
  v_dot2_f32_bf16 v85, v90, v90, v85
  v_dot2_f32_bf16 v84, v91, s60, v84
  v_dot2_f32_bf16 v85, v91, v91, v85
  v_lshlrev_b32 v176, 16, v88
  v_and_b32 v177, 0xffff0000, v88
  v_lshlrev_b32 v178, 16, v89
  v_and_b32 v179, 0xffff0000, v89
  v_lshlrev_b32 v180, 16, v90
  v_and_b32 v181, 0xffff0000, v90
  v_lshlrev_b32 v182, 16, v91
  v_and_b32 v183, 0xffff0000, v91
  s_mov_b32 s40, 0
  s_add_u32 m0, s32, 65536
  s_nop 0
  buffer_load_dwordx4 v48, s[16:19], s40 offen lds
  s_waitcnt vmcnt(11)
  v_dot2_f32_bf16 v88, v92, s60, 0
  v_dot2_f32_bf16 v89, v92, v92, 0
  v_dot2_f32_bf16 v88, v93, s60, v88
  v_dot2_f32_bf16 v89, v93, v93, v89
  v_dot2_f32_bf16 v88, v94, s60, v88
  v_dot2_f32_bf16 v89, v94, v94, v89
  v_dot2_f32_bf16 v88, v95, s60, v88
  v_dot2_f32_bf16 v89, v95, v95, v89
  v_lshlrev_b32 v184, 16, v92
  v_and_b32 v185, 0xffff0000, v92
  v_lshlrev_b32 v186, 16, v93
  v_and_b32 v187, 0xffff0000, v93
  v_permlane32_swap_b32 v84, v88
  v_permlane32_swap_b32 v85, v89
  v_pk_add_f32 v[84:85], v[84:85], v[88:89]
  v_lshlrev_b32 v188, 16, v94
  v_and_b32 v189, 0xffff0000, v94
  v_permlane16_swap_b32 v76, v84
  v_permlane16_swap_b32 v77, v85
  v_pk_add_f32 v[76:77], v[76:77], v[84:85]
  v_lshlrev_b32 v190, 16, v95
  v_and_b32 v191, 0xffff0000, v95
  v_add_f32_dpp v54, v54, v54 row_ror:8 row_mask:0xf bank_mask:0x3
  v_add_f32_dpp v55, v55, v55 row_ror:8 row_mask:0xf bank_mask:0x3
  s_nop 0
  v_add_f32_dpp v54, v76, v76 row_ror:8 row_mask:0xf bank_mask:0xc
  v_add_f32_dpp v55, v77, v77 row_ror:8 row_mask:0xf bank_mask:0xc
  s_nop 1
  buffer_load_dwordx4 v49, s[16:19], s40 offen offset:1024 lds
  s_waitcnt vmcnt(11)
  v_dot2_f32_bf16 v92, v96, s60, 0
  v_dot2_f32_bf16 v93, v96, v96, 0
  v_dot2_f32_bf16 v92, v97, s60, v92
  v_dot2_f32_bf16 v93, v97, v97, v93
  v_dot2_f32_bf16 v92, v98, s60, v92
  v_dot2_f32_bf16 v93, v98, v98, v93
  v_dot2_f32_bf16 v92, v99, s60, v92
  v_dot2_f32_bf16 v93, v99, v99, v93
  v_lshlrev_b32 v192, 16, v96
  v_and_b32 v193, 0xffff0000, v96
  v_lshlrev_b32 v194, 16, v97
  v_and_b32 v195, 0xffff0000, v97
  v_lshlrev_b32 v196, 16, v98
  v_and_b32 v197, 0xffff0000, v98
  v_lshlrev_b32 v198, 16, v99
  v_and_b32 v199, 0xffff0000, v99
  buffer_load_dwordx4 v50, s[16:19], s40 offen offset:2048 lds
  s_waitcnt vmcnt(11)
  v_dot2_f32_bf16 v96, v100, s60, 0
  v_dot2_f32_bf16 v97, v100, v100, 0
  v_dot2_f32_bf16 v96, v101, s60, v96
  v_dot2_f32_bf16 v97, v101, v101, v97
  v_dot2_f32_bf16 v96, v102, s60, v96
  v_dot2_f32_bf16 v97, v102, v102, v97
  v_dot2_f32_bf16 v96, v103, s60, v96
  v_dot2_f32_bf16 v97, v103, v103, v97
  v_lshlrev_b32 v200, 16, v100
  v_and_b32 v201, 0xffff0000, v100
  v_lshlrev_b32 v202, 16, v101
  v_and_b32 v203, 0xffff0000, v101
  v_permlane32_swap_b32 v92, v96
  v_permlane32_swap_b32 v93, v97
  v_pk_add_f32 v[92:93], v[92:93], v[96:97]
  v_lshlrev_b32 v204, 16, v102
  v_and_b32 v205, 0xffff0000, v102
  v_lshlrev_b32 v206, 16, v103
  v_and_b32 v207, 0xffff0000, v103
  buffer_load_dwordx4 v51, s[16:19], s40 offen offset:3072 lds
  s_waitcnt vmcnt(11)
  v_dot2_f32_bf16 v100, v104, s60, 0
  v_dot2_f32_bf16 v101, v104, v104, 0
  v_dot2_f32_bf16 v100, v105, s60, v100
  v_dot2_f32_bf16 v101, v105, v105, v101
  v_dot2_f32_bf16 v100, v106, s60, v100
  v_dot2_f32_bf16 v101, v106, v106, v101
  v_dot2_f32_bf16 v100, v107, s60, v100
  v_dot2_f32_bf16 v101, v107, v107, v101
  v_lshlrev_b32 v208, 16, v104
  v_and_b32 v209, 0xffff0000, v104
  v_lshlrev_b32 v210, 16, v105
  v_and_b32 v211, 0xffff0000, v105
  v_lshlrev_b32 v212, 16, v106
  v_and_b32 v213, 0xffff0000, v106
  v_lshlrev_b32 v214, 16, v107
  v_and_b32 v215, 0xffff0000, v107
  s_mov_b32 s40, 262144
  s_add_u32 m0, s32, 69632
  s_nop 0
  buffer_load_dwordx4 v48, s[16:19], s40 offen lds
  buffer_load_dwordx4 v49, s[16:19], s40 offen offset:1024 lds
  s_waitcnt vmcnt(12)
  v_dot2_f32_bf16 v104, v108, s60, 0
  v_dot2_f32_bf16 v105, v108, v108, 0
  v_dot2_f32_bf16 v104, v109, s60, v104
  v_dot2_f32_bf16 v105, v109, v109, v105
  v_dot2_f32_bf16 v104, v110, s60, v104
  v_dot2_f32_bf16 v105, v110, v110, v105
  v_dot2_f32_bf16 v104, v111, s60, v104
  v_dot2_f32_bf16 v105, v111, v111, v105
  v_lshlrev_b32 v216, 16, v108
  v_and_b32 v217, 0xffff0000, v108
  v_lshlrev_b32 v218, 16, v109
  v_and_b32 v219, 0xffff0000, v109
  v_permlane32_swap_b32 v100, v104
  v_permlane32_swap_b32 v101, v105
  v_pk_add_f32 v[100:101], v[100:101], v[104:105]
  v_lshlrev_b32 v220, 16, v110
  v_and_b32 v221, 0xffff0000, v110
  v_permlane16_swap_b32 v92, v100
  v_permlane16_swap_b32 v93, v101
  v_pk_add_f32 v[92:93], v[92:93], v[100:101]
  v_lshlrev_b32 v222, 16, v111
  v_and_b32 v223, 0xffff0000, v111
  buffer_load_dwordx4 v50, s[16:19], s40 offen offset:2048 lds
  buffer_load_dwordx4 v51, s[16:19], s40 offen offset:3072 lds
  s_waitcnt vmcnt(13)
  v_dot2_f32_bf16 v108, v112, s60, 0
  v_dot2_f32_bf16 v109, v112, v112, 0
  v_dot2_f32_bf16 v108, v113, s60, v108
  v_dot2_f32_bf16 v109, v113, v113, v109
  v_dot2_f32_bf16 v108, v114, s60, v108
  v_dot2_f32_bf16 v109, v114, v114, v109
  v_dot2_f32_bf16 v108, v115, s60, v108
  v_dot2_f32_bf16 v109, v115, v115, v109
  v_lshlrev_b32 v224, 16, v112
  v_and_b32 v225, 0xffff0000, v112
  v_lshlrev_b32 v226, 16, v113
  v_and_b32 v227, 0xffff0000, v113
  v_lshlrev_b32 v228, 16, v114
  v_and_b32 v229, 0xffff0000, v114
  v_lshlrev_b32 v230, 16, v115
  v_and_b32 v231, 0xffff0000, v115
  s_mov_b32 s40, 524288
  s_add_u32 m0, s32, 98304
  s_nop 0
  buffer_load_dwordx4 v48, s[16:19], s40 offen lds
  buffer_load_dwordx4 v49, s[16:19], s40 offen offset:1024 lds
  s_waitcnt vmcnt(14)
  v_dot2_f32_bf16 v112, v116, s60, 0
  v_dot2_f32_bf16 v113, v116, v116, 0
  v_dot2_f32_bf16 v112, v117, s60, v112
  v_dot2_f32_bf16 v113, v117, v117, v113
  v_dot2_f32_bf16 v112, v118, s60, v112
  v_dot2_f32_bf16 v113, v118, v118, v113
  v_dot2_f32_bf16 v112, v119, s60, v112
  v_dot2_f32_bf16 v113, v119, v119, v113
  v_lshlrev_b32 v232, 16, v116
  v_and_b32 v233, 0xffff0000, v116
  v_lshlrev_b32 v234, 16, v117
  v_and_b32 v235, 0xffff0000, v117
  v_permlane32_swap_b32 v108, v112
  v_permlane32_swap_b32 v109, v113
  v_pk_add_f32 v[108:109], v[108:109], v[112:113]
  v_lshlrev_b32 v236, 16, v118
  v_and_b32 v237, 0xffff0000, v118
  v_lshlrev_b32 v238, 16, v119
  v_and_b32 v239, 0xffff0000, v119
  buffer_load_dwordx4 v50, s[16:19], s40 offen offset:2048 lds
  buffer_load_dwordx4 v51, s[16:19], s40 offen offset:3072 lds
  s_waitcnt vmcnt(15)
  v_dot2_f32_bf16 v116, v120, s60, 0
  v_dot2_f32_bf16 v117, v120, v120, 0
  v_dot2_f32_bf16 v116, v121, s60, v116
  v_dot2_f32_bf16 v117, v121, v121, v117
  v_dot2_f32_bf16 v116, v122, s60, v116
  v_dot2_f32_bf16 v117, v122, v122, v117
  v_dot2_f32_bf16 v116, v123, s60, v116
  v_dot2_f32_bf16 v117, v123, v123, v117
  v_lshlrev_b32 v240, 16, v120
  v_and_b32 v241, 0xffff0000, v120
  v_lshlrev_b32 v242, 16, v121
  v_and_b32 v243, 0xffff0000, v121
  v_lshlrev_b32 v244, 16, v122
  v_and_b32 v245, 0xffff0000, v122
  v_lshlrev_b32 v246, 16, v123
  v_and_b32 v247, 0xffff0000, v123
  s_mov_b32 s40, 786432
  s_add_u32 m0, s32, 102400
  s_nop 0
  buffer_load_dwordx4 v48, s[16:19], s40 offen lds
  buffer_load_dwordx4 v49, s[16:19], s40 offen offset:1024 lds
  s_waitcnt vmcnt(16)
  v_dot2_f32_bf16 v120, v124, s60, 0
  v_dot2_f32_bf16 v121, v124, v124, 0
  v_dot2_f32_bf16 v120, v125, s60, v120
  v_dot2_f32_bf16 v121, v125, v125, v121
  v_dot2_f32_bf16 v120, v126, s60, v120
  v_dot2_f32_bf16 v121, v126, v126, v121
  v_dot2_f32_bf16 v120, v127, s60, v120
  v_dot2_f32_bf16 v121, v127, v127, v121
  v_lshlrev_b32 v248, 16, v124
  v_and_b32 v249, 0xffff0000, v124
  v_lshlrev_b32 v250, 16, v125
  v_and_b32 v251, 0xffff0000, v125
  v_permlane32_swap_b32 v116, v120
  v_permlane32_swap_b32 v117, v121
  v_pk_add_f32 v[116:117], v[116:117], v[120:121]
  v_lshlrev_b32 v252, 16, v126
  v_and_b32 v253, 0xffff0000, v126
  v_permlane16_swap_b32 v108, v116
  v_permlane16_swap_b32 v109, v117
  v_pk_add_f32 v[108:109], v[108:109], v[116:117]
  v_lshlrev_b32 v254, 16, v127
  v_and_b32 v255, 0xffff0000, v127
  v_add_f32_dpp v92, v92, v92 row_ror:8 row_mask:0xf bank_mask:0x3
  v_add_f32_dpp v93, v93, v93 row_ror:8 row_mask:0xf bank_mask:0x3
  s_nop 0
  v_add_f32_dpp v92, v108, v108 row_ror:8 row_mask:0xf bank_mask:0xc
  v_add_f32_dpp v93, v109, v109 row_ror:8 row_mask:0xf bank_mask:0xc
  s_nop 1
  v_add_f32_dpp v54, v54, v54 row_half_mirror row_mask:0xf bank_mask:0x5
  v_add_f32_dpp v55, v55, v55 row_half_mirror row_mask:0xf bank_mask:0x5
  s_nop 0
  v_add_f32_dpp v54, v92, v92 row_half_mirror row_mask:0xf bank_mask:0xa
  v_add_f32_dpp v55, v93, v93 row_half_mirror row_mask:0xf bank_mask:0xa
  s_nop 1
  buffer_load_dwordx4 v50, s[16:19], s40 offen offset:2048 lds
  buffer_load_dwordx4 v51, s[16:19], s40 offen offset:3072 lds
  v_add_f32_dpp v54, v54, v54 quad_perm:[1,0,3,2] row_mask:0xf bank_mask:0xf
  v_add_f32_dpp v55, v55, v55 quad_perm:[1,0,3,2] row_mask:0xf bank_mask:0xf
  s_nop 0
  v_add_f32_dpp v54, v54, v54 quad_perm:[2,3,0,1] row_mask:0xf bank_mask:0xf
  v_add_f32_dpp v55, v55, v55 quad_perm:[2,3,0,1] row_mask:0xf bank_mask:0xf
  s_nop 0
  v_mul_f32 v54, 0x3b124925, v54
  v_mul_f32 v55, 0x3b124925, v55
  v_fma_f32 v55, -v54, v54, v55
  v_max_f32 v55, 0, v55
  v_cvt_pk_bf16_f32 v55, v55, v55
  v_and_b32 v55, 0xffff0000, v55
  v_add_f32 v55, 0x3727c5ac, v55
  v_cvt_pk_bf16_f32 v55, v55, v55
  v_and_b32 v55, 0xffff0000, v55
  v_sqrt_f32 v55, v55
  v_cvt_pk_bf16_f32 v54, v54, v54
  v_and_b32 v54, 0xffff0000, v54
  v_cvt_pk_bf16_f32 v55, v55, v55
  v_and_b32 v55, 0xffff0000, v55
  v_rcp_f32 v55, v55
  s_lshl_b32 s41, s3, 8
  s_add_u32 s41, s41, 59392
  v_lshl_add_u32 v1, v2, 2, s41
  v_and_b32 v3, 2, v2
  v_cmp_eq_u32 vcc, 0, v3
  v_mul_f32 v55, 0x3db8aa3b, v55
  v_mul_f32 v54, -v54, v55
  v_mov_b32 v3, s41
  v_cndmask_b32 v54, v54, v55, vcc
  ds_write_b32 v1, v54
  ds_read_b128 v[64:67], v3 offset:0
  ds_read_b128 v[68:71], v3 offset:128
  ds_read_b128 v[72:75], v3 offset:64
  ds_read_b128 v[76:79], v3 offset:192
  ds_read_b128 v[80:83], v3 offset:32
  ds_read_b128 v[84:87], v3 offset:160
  ds_read_b128 v[88:91], v3 offset:96
  ds_read_b128 v[92:95], v3 offset:224
  ds_read_b128 v[96:99], v3 offset:16
  ds_read_b128 v[100:103], v3 offset:144
  ds_read_b128 v[104:107], v3 offset:80
  ds_read_b128 v[108:111], v3 offset:208
  ds_read_b128 v[112:115], v3 offset:48
  ds_read_b128 v[116:119], v3 offset:176
  ds_read_b128 v[120:123], v3 offset:112
  ds_read_b128 v[124:127], v3 offset:240
  s_mov_b32 s40, 1048576
  s_add_u32 m0, s32, 131072
  s_nop 0
  buffer_load_dwordx4 v48, s[16:19], s40 offen lds
  buffer_load_dwordx4 v49, s[16:19], s40 offen offset:1024 lds
  buffer_load_dwordx4 v50, s[16:19], s40 offen offset:2048 lds
  buffer_load_dwordx4 v51, s[16:19], s40 offen offset:3072 lds
  s_mov_b32 s40, 1310720
  s_add_u32 m0, s32, 135168
  s_nop 0
  buffer_load_dwordx4 v48, s[16:19], s40 offen lds
  buffer_load_dwordx4 v49, s[16:19], s40 offen offset:1024 lds
  buffer_load_dwordx4 v50, s[16:19], s40 offen offset:2048 lds
  buffer_load_dwordx4 v51, s[16:19], s40 offen offset:3072 lds
  s_waitcnt lgkmcnt(12)
  v_pk_fma_f32 v[128:129], v[128:129], v[64:65], v[66:67]
  v_pk_fma_f32 v[130:131], v[130:131], v[64:65], v[66:67]
  v_pk_fma_f32 v[132:133], v[132:133], v[64:65], v[66:67]
  v_pk_fma_f32 v[134:135], v[134:135], v[64:65], v[66:67]
  v_pk_fma_f32 v[136:137], v[136:137], v[68:69], v[70:71]
  v_pk_fma_f32 v[138:139], v[138:139], v[68:69], v[70:71]
  v_pk_fma_f32 v[140:141], v[140:141], v[68:69], v[70:71]
  v_pk_fma_f32 v[142:143], v[142:143], v[68:69], v[70:71]
  v_pk_fma_f32 v[144:145], v[144:145], v[72:73], v[74:75]
  v_pk_fma_f32 v[146:147], v[146:147], v[72:73], v[74:75]
  v_pk_fma_f32 v[148:149], v[148:149], v[72:73], v[74:75]
  v_pk_fma_f32 v[150:151], v[150:151], v[72:73], v[74:75]
  v_pk_fma_f32 v[152:153], v[152:153], v[76:77], v[78:79]
  v_pk_fma_f32 v[154:155], v[154:155], v[76:77], v[78:79]
  v_pk_fma_f32 v[156:157], v[156:157], v[76:77], v[78:79]
  v_pk_fma_f32 v[158:159], v[158:159], v[76:77], v[78:79]
  s_waitcnt lgkmcnt(8)
  v_pk_fma_f32 v[160:161], v[160:161], v[80:81], v[82:83]
  v_pk_fma_f32 v[162:163], v[162:163], v[80:81], v[82:83]
  v_pk_fma_f32 v[164:165], v[164:165], v[80:81], v[82:83]
  v_pk_fma_f32 v[166:167], v[166:167], v[80:81], v[82:83]
  v_pk_fma_f32 v[168:169], v[168:169], v[84:85], v[86:87]
  v_pk_fma_f32 v[170:171], v[170:171], v[84:85], v[86:87]
  v_pk_fma_f32 v[172:173], v[172:173], v[84:85], v[86:87]
  v_pk_fma_f32 v[174:175], v[174:175], v[84:85], v[86:87]
  v_pk_fma_f32 v[176:177], v[176:177], v[88:89], v[90:91]
  v_pk_fma_f32 v[178:179], v[178:179], v[88:89], v[90:91]
  v_pk_fma_f32 v[180:181], v[180:181], v[88:89], v[90:91]
  v_pk_fma_f32 v[182:183], v[182:183], v[88:89], v[90:91]
  v_pk_fma_f32 v[184:185], v[184:185], v[92:93], v[94:95]
  v_pk_fma_f32 v[186:187], v[186:187], v[92:93], v[94:95]
  v_pk_fma_f32 v[188:189], v[188:189], v[92:93], v[94:95]
  v_pk_fma_f32 v[190:191], v[190:191], v[92:93], v[94:95]
  s_waitcnt lgkmcnt(4)
  v_pk_fma_f32 v[192:193], v[192:193], v[96:97], v[98:99]
  v_pk_fma_f32 v[194:195], v[194:195], v[96:97], v[98:99]
  v_pk_fma_f32 v[196:197], v[196:197], v[96:97], v[98:99]
  v_pk_fma_f32 v[198:199], v[198:199], v[96:97], v[98:99]
  v_pk_fma_f32 v[200:201], v[200:201], v[100:101], v[102:103]
  v_pk_fma_f32 v[202:203], v[202:203], v[100:101], v[102:103]
  v_pk_fma_f32 v[204:205], v[204:205], v[100:101], v[102:103]
  v_pk_fma_f32 v[206:207], v[206:207], v[100:101], v[102:103]
  v_pk_fma_f32 v[208:209], v[208:209], v[104:105], v[106:107]
  v_pk_fma_f32 v[210:211], v[210:211], v[104:105], v[106:107]
  v_pk_fma_f32 v[212:213], v[212:213], v[104:105], v[106:107]
  v_pk_fma_f32 v[214:215], v[214:215], v[104:105], v[106:107]
  v_pk_fma_f32 v[216:217], v[216:217], v[108:109], v[110:111]
  v_pk_fma_f32 v[218:219], v[218:219], v[108:109], v[110:111]
  v_pk_fma_f32 v[220:221], v[220:221], v[108:109], v[110:111]
  v_pk_fma_f32 v[222:223], v[222:223], v[108:109], v[110:111]
  s_waitcnt lgkmcnt(0)
  v_pk_fma_f32 v[224:225], v[224:225], v[112:113], v[114:115]
  v_pk_fma_f32 v[226:227], v[226:227], v[112:113], v[114:115]
  v_pk_fma_f32 v[228:229], v[228:229], v[112:113], v[114:115]
  v_pk_fma_f32 v[230:231], v[230:231], v[112:113], v[114:115]
  v_pk_fma_f32 v[232:233], v[232:233], v[116:117], v[118:119]
  v_pk_fma_f32 v[234:235], v[234:235], v[116:117], v[118:119]
  v_pk_fma_f32 v[236:237], v[236:237], v[116:117], v[118:119]
  v_pk_fma_f32 v[238:239], v[238:239], v[116:117], v[118:119]
  v_pk_fma_f32 v[240:241], v[240:241], v[120:121], v[122:123]
  v_pk_fma_f32 v[242:243], v[242:243], v[120:121], v[122:123]
  v_pk_fma_f32 v[244:245], v[244:245], v[120:121], v[122:123]
  v_pk_fma_f32 v[246:247], v[246:247], v[120:121], v[122:123]
  v_pk_fma_f32 v[248:249], v[248:249], v[124:125], v[126:127]
  v_pk_fma_f32 v[250:251], v[250:251], v[124:125], v[126:127]
  v_pk_fma_f32 v[252:253], v[252:253], v[124:125], v[126:127]
  v_pk_fma_f32 v[254:255], v[254:255], v[124:125], v[126:127]
  v_lshrrev_b32 v52, 4, v2
  v_min_u32 v52, 1, v52
  v_and_b32 v54, 15, v2
  v_lshlrev_b32 v54, 6, v54
  v_lshl_add_u32 v54, v52, 15, v54
  v_lshrrev_b32 v1, 2, v2
  v_cmp_gt_u32 vcc, 56, v2
  v_and_b32 v3, 3, v2
  v_lshlrev_b32 v3, 8, v3
  v_cndmask_b32 v1, 15, v1, vcc
  v_lshl_add_u32 v1, v1, 12, v3
  v_and_b32 v3, 15, v2
  v_lshl_add_u32 v1, v3, 4, v1
  s_lshl_b32 s41, s3, 10
  v_add_u32 v64, s41, v1
  v_xor_b32 v65, 16, v64
  v_xor_b32 v66, 32, v64
  v_xor_b32 v67, 48, v64
  v_xor_b32 v68, 64, v64
  v_xor_b32 v69, 80, v64
  v_xor_b32 v70, 96, v64
  v_xor_b32 v71, 112, v64
  v_xor_b32 v72, 128, v64
  v_xor_b32 v73, 144, v64
  v_xor_b32 v74, 160, v64
  v_xor_b32 v75, 176, v64
  v_xor_b32 v76, 192, v64
  v_xor_b32 v77, 208, v64
  v_xor_b32 v78, 224, v64
  v_xor_b32 v79, 240, v64
  v_add_u32 v55, 57344, v53
  s_mov_b32 s60, 0x3db8aa3b
  s_mov_b32 s61, s60
  s_cmp_eq_u32 s3, 3
  s_cbranch_scc1 K1_PW
  s_lshl_b32 s59, s3, 8
  s_add_u32 s59, s59, s58
  s_sub_u32 s59, s59, 28
  s_cmp_lt_u32 s59, 56
  s_cbranch_scc0 K1_NM
  s_lshl_b64 vcc, 1, s59
  v_mov_b32 v1, 128
  v_mov_b32 v100, vcc_lo
  v_mov_b32 v101, vcc_hi
  s_mov_b64 exec, 1
  buffer_atomic_or_x2 v[100:101], v1, s[20:23], 0 offen sc1
  s_mov_b64 exec, -1
K1_NM:
  s_waitcnt vmcnt(16)
  ds_read_b64_tr_b16 a[224:225], v58 offset:0
  ds_read_b64_tr_b16 a[226:227], v58 offset:2048
  ds_read_b64_tr_b16 a[228:229], v58 offset:4096
  ds_read_b64_tr_b16 a[230:231], v58 offset:6144
  ds_read_b64_tr_b16 a[232:233], v58 offset:8
  ds_read_b64_tr_b16 a[234:235], v58 offset:2056
  ds_read_b64_tr_b16 a[236:237], v58 offset:4104
  ds_read_b64_tr_b16 a[238:239], v58 offset:6152
  ds_read_b64_tr_b16 a[240:241], v59 offset:0
  ds_read_b64_tr_b16 a[242:243], v59 offset:2048
  ds_read_b64_tr_b16 a[244:245], v59 offset:4096
  ds_read_b64_tr_b16 a[246:247], v59 offset:6144
  ds_read_b64_tr_b16 a[248:249], v59 offset:8
  ds_read_b64_tr_b16 a[250:251], v59 offset:2056
  ds_read_b64_tr_b16 a[252:253], v59 offset:4104
  ds_read_b64_tr_b16 a[254:255], v59 offset:6152
  s_waitcnt vmcnt(8)
  ds_read_b64_tr_b16 a[96:97], v58 offset:32768
  ds_read_b64_tr_b16 a[98:99], v58 offset:34816
  ds_read_b64_tr_b16 a[100:101], v58 offset:36864
  ds_read_b64_tr_b16 a[102:103], v58 offset:38912
  ds_read_b64_tr_b16 a[104:105], v58 offset:32776
  ds_read_b64_tr_b16 a[106:107], v58 offset:34824
  ds_read_b64_tr_b16 a[108:109], v58 offset:36872
  ds_read_b64_tr_b16 a[110:111], v58 offset:38920
  ds_read_b64_tr_b16 a[112:113], v59 offset:32768
  ds_read_b64_tr_b16 a[114:115], v59 offset:34816
  ds_read_b64_tr_b16 a[116:117], v59 offset:36864
  ds_read_b64_tr_b16 a[118:119], v59 offset:38912
  ds_read_b64_tr_b16 a[120:121], v59 offset:32776
  ds_read_b64_tr_b16 a[122:123], v59 offset:34824
  ds_read_b64_tr_b16 a[124:125], v59 offset:36872
  ds_read_b64_tr_b16 a[126:127], v59 offset:38920
  s_waitcnt vmcnt(0)
  ds_read_b64_tr_b16 a[192:193], v60 offset:0
  ds_read_b64_tr_b16 a[194:195], v60 offset:2048
  ds_read_b64_tr_b16 a[196:197], v60 offset:4096
  ds_read_b64_tr_b16 a[198:199], v60 offset:6144
  ds_read_b64_tr_b16 a[200:201], v60 offset:8
  ds_read_b64_tr_b16 a[202:203], v60 offset:2056
  ds_read_b64_tr_b16 a[204:205], v60 offset:4104
  ds_read_b64_tr_b16 a[206:207], v60 offset:6152
  ds_read_b64_tr_b16 a[208:209], v61 offset:0
  ds_read_b64_tr_b16 a[210:211], v61 offset:2048
  ds_read_b64_tr_b16 a[212:213], v61 offset:4096
  ds_read_b64_tr_b16 a[214:215], v61 offset:6144
  ds_read_b64_tr_b16 a[216:217], v61 offset:8
  ds_read_b64_tr_b16 a[218:219], v61 offset:2056
  ds_read_b64_tr_b16 a[220:221], v61 offset:4104
  ds_read_b64_tr_b16 a[222:223], v61 offset:6152
  s_branch K1_GOT
K1_PW:
  v_lshrrev_b32 v1, 3, v2
  v_lshlrev_b32 v1, 4, v1
  buffer_load_dwordx4 v[96:99], v1, s[20:23], 0 offen sc1
  buffer_load_dwordx4 v[80:83], v53, s[28:31], 0 offen offset:0 sc1
  buffer_load_dwordx4 v[84:87], v53, s[28:31], 0 offen offset:1024 sc1
  buffer_load_dwordx4 v[88:91], v53, s[28:31], 0 offen offset:2048 sc1
  buffer_load_dwordx4 v[92:95], v53, s[28:31], 0 offen offset:3072 sc1
  v_lshlrev_b32 v3, 3, v2
  v_add_u32 v3, 57344, v3
  v_add_u32 v47, 1024, v3
  v_lshlrev_b32 v52, 26, v2
  s_brev_b32 s59, 1
  s_mov_b32 s33, 16384
  s_waitcnt vmcnt(21)
  ds_read_b64_tr_b16 a[224:225], v58 offset:0
  ds_read_b64_tr_b16 a[226:227], v58 offset:2048
  ds_read_b64_tr_b16 a[228:229], v58 offset:4096
  ds_read_b64_tr_b16 a[230:231], v58 offset:6144
  ds_read_b64_tr_b16 a[232:233], v58 offset:8
  ds_read_b64_tr_b16 a[234:235], v58 offset:2056
  ds_read_b64_tr_b16 a[236:237], v58 offset:4104
  ds_read_b64_tr_b16 a[238:239], v58 offset:6152
  ds_read_b64_tr_b16 a[240:241], v59 offset:0
  ds_read_b64_tr_b16 a[242:243], v59 offset:2048
  ds_read_b64_tr_b16 a[244:245], v59 offset:4096
  ds_read_b64_tr_b16 a[246:247], v59 offset:6144
  ds_read_b64_tr_b16 a[248:249], v59 offset:8
  ds_read_b64_tr_b16 a[250:251], v59 offset:2056
  ds_read_b64_tr_b16 a[252:253], v59 offset:4104
  ds_read_b64_tr_b16 a[254:255], v59 offset:6152
  s_waitcnt vmcnt(13)
  ds_read_b64_tr_b16 a[96:97], v58 offset:32768
  ds_read_b64_tr_b16 a[98:99], v58 offset:34816
  ds_read_b64_tr_b16 a[100:101], v58 offset:36864
  ds_read_b64_tr_b16 a[102:103], v58 offset:38912
  ds_read_b64_tr_b16 a[104:105], v58 offset:32776
  ds_read_b64_tr_b16 a[106:107], v58 offset:34824
  ds_read_b64_tr_b16 a[108:109], v58 offset:36872
  ds_read_b64_tr_b16 a[110:111], v58 offset:38920
  ds_read_b64_tr_b16 a[112:113], v59 offset:32768
  ds_read_b64_tr_b16 a[114:115], v59 offset:34816
  ds_read_b64_tr_b16 a[116:117], v59 offset:36864
  ds_read_b64_tr_b16 a[118:119], v59 offset:38912
  ds_read_b64_tr_b16 a[120:121], v59 offset:32776
  ds_read_b64_tr_b16 a[122:123], v59 offset:34824
  ds_read_b64_tr_b16 a[124:125], v59 offset:36872
  ds_read_b64_tr_b16 a[126:127], v59 offset:38920
  s_waitcnt vmcnt(5)
  ds_read_b64_tr_b16 a[192:193], v60 offset:0
  ds_read_b64_tr_b16 a[194:195], v60 offset:2048
  ds_read_b64_tr_b16 a[196:197], v60 offset:4096
  ds_read_b64_tr_b16 a[198:199], v60 offset:6144
  ds_read_b64_tr_b16 a[200:201], v60 offset:8
  ds_read_b64_tr_b16 a[202:203], v60 offset:2056
  ds_read_b64_tr_b16 a[204:205], v60 offset:4104
  ds_read_b64_tr_b16 a[206:207], v60 offset:6152
  ds_read_b64_tr_b16 a[208:209], v61 offset:0
  ds_read_b64_tr_b16 a[210:211], v61 offset:2048
  ds_read_b64_tr_b16 a[212:213], v61 offset:4096
  ds_read_b64_tr_b16 a[214:215], v61 offset:6144
  ds_read_b64_tr_b16 a[216:217], v61 offset:8
  ds_read_b64_tr_b16 a[218:219], v61 offset:2056
  ds_read_b64_tr_b16 a[220:221], v61 offset:4104
  ds_read_b64_tr_b16 a[222:223], v61 offset:6152
  s_branch K1_PCK
K1_POLL:
  buffer_load_dwordx4 v[96:99], v1, s[20:23], 0 offen sc1
  buffer_load_dwordx4 v[80:83], v53, s[28:31], 0 offen offset:0 sc1
  buffer_load_dwordx4 v[84:87], v53, s[28:31], 0 offen offset:1024 sc1
  buffer_load_dwordx4 v[88:91], v53, s[28:31], 0 offen offset:2048 sc1
  buffer_load_dwordx4 v[92:95], v53, s[28:31], 0 offen offset:3072 sc1
K1_PCK:
  s_sub_u32 s33, s33, 1
  s_cbranch_scc1 K1_TMO
  s_waitcnt vmcnt(0)
  ds_write2_b32 v3, v80, v82 offset0:0 offset1:1
  ds_write2_b32 v3, v84, v86 offset0:128 offset1:129
  ds_write2_b32 v47, v88, v90 offset0:0 offset1:1
  ds_write2_b32 v47, v92, v94 offset0:128 offset1:129
  v_xor_b32 v100, v81, v96
  v_bitop3_b32 v100, v100, v83, v96 bitop3:0xf6
  v_bitop3_b32 v100, v100, v85, v97 bitop3:0xf6
  v_bitop3_b32 v100, v100, v87, v97 bitop3:0xf6
  v_bitop3_b32 v100, v100, v89, v98 bitop3:0xf6
  v_bitop3_b32 v100, v100, v91, v98 bitop3:0xf6
  v_bitop3_b32 v100, v100, v93, v99 bitop3:0xf6
  v_bitop3_b32 v100, v100, v95, v99 bitop3:0xf6
  v_or_b32 v101, v99, v52
  v_bitop3_b32 v102, v96, v97, v98 bitop3:0x80
  v_and_b32 v101, v101, v102
  v_bitop3_b32 v100, v100, v101, s59 bitop3:0xf2
  v_cmp_ne_u32 vcc, 0, v100
  s_cbranch_vccnz K1_POLL
  s_waitcnt lgkmcnt(0)
K1_GOT:
  s_barrier
  ds_read_b128 v[96:99], v55 offset:896
  ds_read_b128 v[100:103], v55
  s_add_u32 s41, s7, 0
  buffer_load_dword v46, v54, s[8:11], s41 offen
  s_add_u32 s41, s7, 0
  buffer_load_dword v46, v54, s[12:15], s41 offen
  s_waitcnt lgkmcnt(1)
  v_readlane_b32 s59, v96, 56
  v_lshlrev_b32 v80, 16, v96
  v_and_b32 v81, 0xffff0000, v96
  v_lshlrev_b32 v82, 16, v97
  v_and_b32 v83, 0xffff0000, v97
  v_lshlrev_b32 v84, 16, v98
  v_and_b32 v85, 0xffff0000, v98
  v_lshlrev_b32 v86, 16, v99
  v_and_b32 v87, 0xffff0000, v99
  s_waitcnt lgkmcnt(0)
  s_cmp_lg_u32 s59, 0
  s_cbranch_scc1 K1_LOC
  v_lshlrev_b32 v88, 16, v100
  v_and_b32 v89, 0xffff0000, v100
  v_lshlrev_b32 v90, 16, v101
  v_and_b32 v91, 0xffff0000, v101
  v_lshlrev_b32 v92, 16, v102
  v_and_b32 v93, 0xffff0000, v102
  v_lshlrev_b32 v94, 16, v103
  v_and_b32 v95, 0xffff0000, v103
  v_pk_mul_f32 v[88:89], v[88:89], s[60:61]
  v_pk_mul_f32 v[90:91], v[90:91], s[60:61]
  v_pk_mul_f32 v[92:93], v[92:93], s[60:61]
  v_pk_mul_f32 v[94:95], v[94:95], s[60:61]
  v_pk_fma_f32 v[128:129], v[128:129], v[80:81], v[88:89]
  v_pk_fma_f32 v[130:131], v[130:131], v[82:83], v[90:91]
  v_pk_fma_f32 v[132:133], v[132:133], v[84:85], v[92:93]
  v_pk_fma_f32 v[134:135], v[134:135], v[86:87], v[94:95]
  v_cvt_pk_bf16_f32 v104, v128, v129
  v_cvt_pk_bf16_f32 v105, v130, v131
  v_cvt_pk_bf16_f32 v106, v132, v133
  v_cvt_pk_bf16_f32 v107, v134, v135
  ds_write_b128 v64, v[104:107]
  s_mov_b32 s40, 1572864
  s_add_u32 m0, s32, 65536
  s_nop 0
  buffer_load_dwordx4 v48, s[16:19], s40 offen lds
  v_pk_fma_f32 v[136:137], v[136:137], v[80:81], v[88:89]
  v_pk_fma_f32 v[138:139], v[138:139], v[82:83], v[90:91]
  v_pk_fma_f32 v[140:141], v[140:141], v[84:85], v[92:93]
  v_pk_fma_f32 v[142:143], v[142:143], v[86:87], v[94:95]
  v_cvt_pk_bf16_f32 v108, v136, v137
  v_cvt_pk_bf16_f32 v109, v138, v139
  v_cvt_pk_bf16_f32 v110, v140, v141
  v_cvt_pk_bf16_f32 v111, v142, v143
  ds_write_b128 v65, v[108:111]
  v_pk_fma_f32 v[144:145], v[144:145], v[80:81], v[88:89]
  v_pk_fma_f32 v[146:147], v[146:147], v[82:83], v[90:91]
  v_pk_fma_f32 v[148:149], v[148:149], v[84:85], v[92:93]
  v_pk_fma_f32 v[150:151], v[150:151], v[86:87], v[94:95]
  v_cvt_pk_bf16_f32 v112, v144, v145
  v_cvt_pk_bf16_f32 v113, v146, v147
  v_cvt_pk_bf16_f32 v114, v148, v149
  v_cvt_pk_bf16_f32 v115, v150, v151
  ds_write_b128 v66, v[112:115]
  buffer_load_dwordx4 v49, s[16:19], s40 offen offset:1024 lds
  v_pk_fma_f32 v[152:153], v[152:153], v[80:81], v[88:89]
  v_pk_fma_f32 v[154:155], v[154:155], v[82:83], v[90:91]
  v_pk_fma_f32 v[156:157], v[156:157], v[84:85], v[92:93]
  v_pk_fma_f32 v[158:159], v[158:159], v[86:87], v[94:95]
  v_cvt_pk_bf16_f32 v116, v152, v153
  v_cvt_pk_bf16_f32 v117, v154, v155
  v_cvt_pk_bf16_f32 v118, v156, v157
  v_cvt_pk_bf16_f32 v119, v158, v159
  ds_write_b128 v67, v[116:119]
  v_pk_fma_f32 v[160:161], v[160:161], v[80:81], v[88:89]
  v_pk_fma_f32 v[162:163], v[162:163], v[82:83], v[90:91]
  v_pk_fma_f32 v[164:165], v[164:165], v[84:85], v[92:93]
  v_pk_fma_f32 v[166:167], v[166:167], v[86:87], v[94:95]
  v_cvt_pk_bf16_f32 v104, v160, v161
  v_cvt_pk_bf16_f32 v105, v162, v163
  v_cvt_pk_bf16_f32 v106, v164, v165
  v_cvt_pk_bf16_f32 v107, v166, v167
  ds_write_b128 v68, v[104:107]
  buffer_load_dwordx4 v50, s[16:19], s40 offen offset:2048 lds
  v_pk_fma_f32 v[168:169], v[168:169], v[80:81], v[88:89]
  v_pk_fma_f32 v[170:171], v[170:171], v[82:83], v[90:91]
  v_pk_fma_f32 v[172:173], v[172:173], v[84:85], v[92:93]
  v_pk_fma_f32 v[174:175], v[174:175], v[86:87], v[94:95]
  v_cvt_pk_bf16_f32 v108, v168, v169
  v_cvt_pk_bf16_f32 v109, v170, v171
  v_cvt_pk_bf16_f32 v110, v172, v173
  v_cvt_pk_bf16_f32 v111, v174, v175
  ds_write_b128 v69, v[108:111]
  v_pk_fma_f32 v[176:177], v[176:177], v[80:81], v[88:89]
  v_pk_fma_f32 v[178:179], v[178:179], v[82:83], v[90:91]
  v_pk_fma_f32 v[180:181], v[180:181], v[84:85], v[92:93]
  v_pk_fma_f32 v[182:183], v[182:183], v[86:87], v[94:95]
  v_cvt_pk_bf16_f32 v112, v176, v177
  v_cvt_pk_bf16_f32 v113, v178, v179
  v_cvt_pk_bf16_f32 v114, v180, v181
  v_cvt_pk_bf16_f32 v115, v182, v183
  ds_write_b128 v70, v[112:115]
  buffer_load_dwordx4 v51, s[16:19], s40 offen offset:3072 lds
  v_pk_fma_f32 v[184:185], v[184:185], v[80:81], v[88:89]
  v_pk_fma_f32 v[186:187], v[186:187], v[82:83], v[90:91]
  v_pk_fma_f32 v[188:189], v[188:189], v[84:85], v[92:93]
  v_pk_fma_f32 v[190:191], v[190:191], v[86:87], v[94:95]
  v_cvt_pk_bf16_f32 v116, v184, v185
  v_cvt_pk_bf16_f32 v117, v186, v187
  v_cvt_pk_bf16_f32 v118, v188, v189
  v_cvt_pk_bf16_f32 v119, v190, v191
  ds_write_b128 v71, v[116:119]
  v_pk_fma_f32 v[192:193], v[192:193], v[80:81], v[88:89]
  v_pk_fma_f32 v[194:195], v[194:195], v[82:83], v[90:91]
  v_pk_fma_f32 v[196:197], v[196:197], v[84:85], v[92:93]
  v_pk_fma_f32 v[198:199], v[198:199], v[86:87], v[94:95]
  v_cvt_pk_bf16_f32 v104, v192, v193
  v_cvt_pk_bf16_f32 v105, v194, v195
  v_cvt_pk_bf16_f32 v106, v196, v197
  v_cvt_pk_bf16_f32 v107, v198, v199
  ds_write_b128 v72, v[104:107]
  s_mov_b32 s40, 1835008
  s_add_u32 m0, s32, 69632
  s_nop 0
  buffer_load_dwordx4 v48, s[16:19], s40 offen lds
  v_pk_fma_f32 v[200:201], v[200:201], v[80:81], v[88:89]
  v_pk_fma_f32 v[202:203], v[202:203], v[82:83], v[90:91]
  v_pk_fma_f32 v[204:205], v[204:205], v[84:85], v[92:93]
  v_pk_fma_f32 v[206:207], v[206:207], v[86:87], v[94:95]
  v_cvt_pk_bf16_f32 v108, v200, v201
  v_cvt_pk_bf16_f32 v109, v202, v203
  v_cvt_pk_bf16_f32 v110, v204, v205
  v_cvt_pk_bf16_f32 v111, v206, v207
  ds_write_b128 v73, v[108:111]
  v_pk_fma_f32 v[208:209], v[208:209], v[80:81], v[88:89]
  v_pk_fma_f32 v[210:211], v[210:211], v[82:83], v[90:91]
  v_pk_fma_f32 v[212:213], v[212:213], v[84:85], v[92:93]
  v_pk_fma_f32 v[214:215], v[214:215], v[86:87], v[94:95]
  v_cvt_pk_bf16_f32 v112, v208, v209
  v_cvt_pk_bf16_f32 v113, v210, v211
  v_cvt_pk_bf16_f32 v114, v212, v213
  v_cvt_pk_bf16_f32 v115, v214, v215
  ds_write_b128 v74, v[112:115]
  buffer_load_dwordx4 v49, s[16:19], s40 offen offset:1024 lds
  v_pk_fma_f32 v[216:217], v[216:217], v[80:81], v[88:89]
  v_pk_fma_f32 v[218:219], v[218:219], v[82:83], v[90:91]
  v_pk_fma_f32 v[220:221], v[220:221], v[84:85], v[92:93]
  v_pk_fma_f32 v[222:223], v[222:223], v[86:87], v[94:95]
  v_cvt_pk_bf16_f32 v116, v216, v217
  v_cvt_pk_bf16_f32 v117, v218, v219
  v_cvt_pk_bf16_f32 v118, v220, v221
  v_cvt_pk_bf16_f32 v119, v222, v223
  ds_write_b128 v75, v[116:119]
  v_pk_fma_f32 v[224:225], v[224:225], v[80:81], v[88:89]
  v_pk_fma_f32 v[226:227], v[226:227], v[82:83], v[90:91]
  v_pk_fma_f32 v[228:229], v[228:229], v[84:85], v[92:93]
  v_pk_fma_f32 v[230:231], v[230:231], v[86:87], v[94:95]
  v_cvt_pk_bf16_f32 v104, v224, v225
  v_cvt_pk_bf16_f32 v105, v226, v227
  v_cvt_pk_bf16_f32 v106, v228, v229
  v_cvt_pk_bf16_f32 v107, v230, v231
  ds_write_b128 v76, v[104:107]
  buffer_load_dwordx4 v50, s[16:19], s40 offen offset:2048 lds
  v_pk_fma_f32 v[232:233], v[232:233], v[80:81], v[88:89]
  v_pk_fma_f32 v[234:235], v[234:235], v[82:83], v[90:91]
  v_pk_fma_f32 v[236:237], v[236:237], v[84:85], v[92:93]
  v_pk_fma_f32 v[238:239], v[238:239], v[86:87], v[94:95]
  v_cvt_pk_bf16_f32 v108, v232, v233
  v_cvt_pk_bf16_f32 v109, v234, v235
  v_cvt_pk_bf16_f32 v110, v236, v237
  v_cvt_pk_bf16_f32 v111, v238, v239
  ds_write_b128 v77, v[108:111]
  v_pk_fma_f32 v[240:241], v[240:241], v[80:81], v[88:89]
  v_pk_fma_f32 v[242:243], v[242:243], v[82:83], v[90:91]
  v_pk_fma_f32 v[244:245], v[244:245], v[84:85], v[92:93]
  v_pk_fma_f32 v[246:247], v[246:247], v[86:87], v[94:95]
  v_cvt_pk_bf16_f32 v112, v240, v241
  v_cvt_pk_bf16_f32 v113, v242, v243
  v_cvt_pk_bf16_f32 v114, v244, v245
  v_cvt_pk_bf16_f32 v115, v246, v247
  ds_write_b128 v78, v[112:115]
  buffer_load_dwordx4 v51, s[16:19], s40 offen offset:3072 lds
  v_pk_fma_f32 v[248:249], v[248:249], v[80:81], v[88:89]
  v_pk_fma_f32 v[250:251], v[250:251], v[82:83], v[90:91]
  v_pk_fma_f32 v[252:253], v[252:253], v[84:85], v[92:93]
  v_pk_fma_f32 v[254:255], v[254:255], v[86:87], v[94:95]
  v_cvt_pk_bf16_f32 v116, v248, v249
  v_cvt_pk_bf16_f32 v117, v250, v251
  v_cvt_pk_bf16_f32 v118, v252, v253
  v_cvt_pk_bf16_f32 v119, v254, v255
  ds_write_b128 v79, v[116:119]
  s_waitcnt lgkmcnt(0)
  s_barrier
  ds_read_b128 a[0:3], v4 offset:0
  ds_read_b128 a[4:7], v4 offset:1024
  ds_read_b128 a[8:11], v4 offset:2048
  ds_read_b128 a[12:15], v4 offset:3072
  ds_read_b128 a[16:19], v5 offset:4096
  ds_read_b128 a[20:23], v5 offset:5120
  ds_read_b128 a[24:27], v5 offset:6144
  ds_read_b128 a[28:31], v5 offset:7168
  s_waitcnt lgkmcnt(0)
  v_mfma_f32_16x16x32_bf16 v[128:131], a[224:227], a[0:3], 0
  v_mfma_f32_16x16x32_bf16 v[128:131], a[228:231], a[16:19], v[128:131]
  ds_read_b128 a[64:67], v6 offset:8192
  ds_read_b128 a[68:71], v6 offset:9216
  v_mfma_f32_16x16x32_bf16 v[136:139], a[224:227], a[4:7], 0
  ds_read_b128 a[72:75], v6 offset:10240
  ds_read_b128 a[76:79], v6 offset:11264
  v_mfma_f32_16x16x32_bf16 v[136:139], a[228:231], a[20:23], v[136:139]
  ds_read_b128 a[80:83], v7 offset:12288
  ds_read_b128 a[84:87], v7 offset:13312
  v_mfma_f32_16x16x32_bf16 v[144:147], a[224:227], a[8:11], 0
  s_mov_b32 s40, 2097152
  s_add_u32 m0, s32, 98304
  v_mfma_f32_16x16x32_bf16 v[144:147], a[228:231], a[24:27], v[144:147]
  buffer_load_dwordx4 v48, s[16:19], s40 offen lds
  v_mfma_f32_16x16x32_bf16 v[152:155], a[224:227], a[12:15], 0
  ds_read_b128 a[88:91], v7 offset:14336
  ds_read_b128 a[92:95], v7 offset:15360
  v_mfma_f32_16x16x32_bf16 v[152:155], a[228:231], a[28:31], v[152:155]
  ds_read_b128 a[128:131], v4 offset:16384
  v_mfma_f32_16x16x32_bf16 v[132:135], a[232:235], a[0:3], 0
  buffer_load_dwordx4 v49, s[16:19], s40 offen offset:1024 lds
  v_mfma_f32_16x16x32_bf16 v[132:135], a[236:239], a[16:19], v[132:135]
  ds_read_b128 a[132:135], v4 offset:17408
  ds_read_b128 a[136:139], v4 offset:18432
  v_mfma_f32_16x16x32_bf16 v[140:143], a[232:235], a[4:7], 0
  ds_read_b128 a[140:143], v4 offset:19456
  ds_read_b128 a[144:147], v5 offset:20480
  v_mfma_f32_16x16x32_bf16 v[140:143], a[236:239], a[20:23], v[140:143]
  ds_read_b128 a[148:151], v5 offset:21504
  ds_read_b128 a[152:155], v5 offset:22528
  v_mfma_f32_16x16x32_bf16 v[148:151], a[232:235], a[8:11], 0
  buffer_load_dwordx4 v50, s[16:19], s40 offen offset:2048 lds
  v_mfma_f32_16x16x32_bf16 v[148:151], a[236:239], a[24:27], v[148:151]
  ds_read_b128 a[156:159], v5 offset:23552
  ds_read_b128 a[160:163], v6 offset:24576
  v_mfma_f32_16x16x32_bf16 v[156:159], a[232:235], a[12:15], 0
  ds_read_b128 a[164:167], v6 offset:25600
  ds_read_b128 a[168:171], v6 offset:26624
  v_mfma_f32_16x16x32_bf16 v[156:159], a[236:239], a[28:31], v[156:159]
  ds_read_b128 a[172:175], v6 offset:27648
  v_mfma_f32_16x16x32_bf16 v[160:163], a[240:243], a[0:3], 0
  buffer_load_dwordx4 v51, s[16:19], s40 offen offset:3072 lds
  s_mov_b32 s40, 2359296
  v_mfma_f32_16x16x32_bf16 v[160:163], a[244:247], a[16:19], v[160:163]
  s_add_u32 m0, s32, 102400
  ds_read_b128 a[176:179], v7 offset:28672
  v_mfma_f32_16x16x32_bf16 v[168:171], a[240:243], a[4:7], 0
  ds_read_b128 a[180:183], v7 offset:29696
  ds_read_b128 a[184:187], v7 offset:30720
  v_mfma_f32_16x16x32_bf16 v[168:171], a[244:247], a[20:23], v[168:171]
  buffer_load_dwordx4 v48, s[16:19], s40 offen lds
  v_mfma_f32_16x16x32_bf16 v[176:179], a[240:243], a[8:11], 0
  ds_read_b128 a[188:191], v7 offset:31744
  ds_read_b128 a[32:35], v4 offset:32768
  v_mfma_f32_16x16x32_bf16 v[176:179], a[244:247], a[24:27], v[176:179]
  ds_read_b128 a[36:39], v4 offset:33792
  ds_read_b128 a[40:43], v4 offset:34816
  v_mfma_f32_16x16x32_bf16 v[184:187], a[240:243], a[12:15], 0
  ds_read_b128 a[44:47], v4 offset:35840
  ds_read_b128 a[48:51], v5 offset:36864
  v_mfma_f32_16x16x32_bf16 v[184:187], a[244:247], a[28:31], v[184:187]
  ds_read_b128 a[52:55], v5 offset:37888
  v_mfma_f32_16x16x32_bf16 v[164:167], a[248:251], a[0:3], 0
  buffer_load_dwordx4 v49, s[16:19], s40 offen offset:1024 lds
  v_mfma_f32_16x16x32_bf16 v[164:167], a[252:255], a[16:19], v[164:167]
  ds_read_b128 a[56:59], v5 offset:38912
  ds_read_b128 a[60:63], v5 offset:39936
  v_mfma_f32_16x16x32_bf16 v[172:175], a[248:251], a[4:7], 0
  ds_read_b128 v[96:99], v6 offset:40960
  ds_read_b128 v[100:103], v6 offset:41984
  v_mfma_f32_16x16x32_bf16 v[172:175], a[252:255], a[20:23], v[172:175]
  buffer_load_dwordx4 v50, s[16:19], s40 offen offset:2048 lds
  v_mfma_f32_16x16x32_bf16 v[180:183], a[248:251], a[8:11], 0
  ds_read_b128 v[104:107], v6 offset:43008
  ds_read_b128 v[108:111], v6 offset:44032
  v_mfma_f32_16x16x32_bf16 v[180:183], a[252:255], a[24:27], v[180:183]
  ds_read_b128 v[112:115], v7 offset:45056
  ds_read_b128 v[116:119], v7 offset:46080
  v_mfma_f32_16x16x32_bf16 v[188:191], a[248:251], a[12:15], 0
  ds_read_b128 v[120:123], v7 offset:47104
  ds_read_b128 v[124:127], v7 offset:48128
  v_mfma_f32_16x16x32_bf16 v[188:191], a[252:255], a[28:31], v[188:191]
  ds_read_b128 v[64:67], v4 offset:49152
  s_waitcnt lgkmcnt(15)
  v_mfma_f32_16x16x32_bf16 v[128:131], a[96:99], a[64:67], v[128:131]
  buffer_load_dwordx4 v51, s[16:19], s40 offen offset:3072 lds
  v_mfma_f32_16x16x32_bf16 v[128:131], a[100:103], a[80:83], v[128:131]
  ds_read_b128 v[68:71], v4 offset:50176
  ds_read_b128 v[72:75], v4 offset:51200
  v_mfma_f32_16x16x32_bf16 v[136:139], a[96:99], a[68:71], v[136:139]
  ds_read_b128 v[76:79], v4 offset:52224
  ds_read_b128 v[80:83], v5 offset:53248
  v_mfma_f32_16x16x32_bf16 v[136:139], a[100:103], a[84:87], v[136:139]
  s_mov_b32 s40, 2621440
  s_add_u32 m0, s32, 131072
  v_mfma_f32_16x16x32_bf16 v[144:147], a[96:99], a[72:75], v[144:147]
  buffer_load_dwordx4 v48, s[16:19], s40 offen lds
  v_mfma_f32_16x16x32_bf16 v[144:147], a[100:103], a[88:91], v[144:147]
  ds_read_b128 v[84:87], v5 offset:54272
  ds_read_b128 v[88:91], v5 offset:55296
  v_mfma_f32_16x16x32_bf16 v[152:155], a[96:99], a[76:79], v[152:155]
  ds_read_b128 v[92:95], v5 offset:56320
  v_mfma_f32_16x16x32_bf16 v[152:155], a[100:103], a[92:95], v[152:155]
  v_mfma_f32_16x16x32_bf16 v[132:135], a[104:107], a[64:67], v[132:135]
  buffer_load_dwordx4 v49, s[16:19], s40 offen offset:1024 lds
  v_mfma_f32_16x16x32_bf16 v[132:135], a[108:111], a[80:83], v[132:135]
  v_mfma_f32_16x16x32_bf16 v[140:143], a[104:107], a[68:71], v[140:143]
  v_mfma_f32_16x16x32_bf16 v[140:143], a[108:111], a[84:87], v[140:143]
  buffer_load_dwordx4 v50, s[16:19], s40 offen offset:2048 lds
  v_mfma_f32_16x16x32_bf16 v[148:151], a[104:107], a[72:75], v[148:151]
  s_waitcnt lgkmcnt(0)
  s_barrier
  v_mfma_f32_16x16x32_bf16 v[148:151], a[108:111], a[88:91], v[148:151]
  v_mfma_f32_16x16x32_bf16 v[156:159], a[104:107], a[76:79], v[156:159]
  v_mfma_f32_16x16x32_bf16 v[156:159], a[108:111], a[92:95], v[156:159]
  v_mfma_f32_16x16x32_bf16 v[160:163], a[112:115], a[64:67], v[160:163]
  buffer_load_dwordx4 v51, s[16:19], s40 offen offset:3072 lds
  s_mov_b32 s40, 2883584
  v_mfma_f32_16x16x32_bf16 v[160:163], a[116:119], a[80:83], v[160:163]
  s_add_u32 m0, s32, 135168
  v_mfma_f32_16x16x32_bf16 v[168:171], a[112:115], a[68:71], v[168:171]
  v_mfma_f32_16x16x32_bf16 v[168:171], a[116:119], a[84:87], v[168:171]
  buffer_load_dwordx4 v48, s[16:19], s40 offen lds
  v_mfma_f32_16x16x32_bf16 v[176:179], a[112:115], a[72:75], v[176:179]
  v_mfma_f32_16x16x32_bf16 v[176:179], a[116:119], a[88:91], v[176:179]
  v_mfma_f32_16x16x32_bf16 v[184:187], a[112:115], a[76:79], v[184:187]
  v_mfma_f32_16x16x32_bf16 v[184:187], a[116:119], a[92:95], v[184:187]
  v_mfma_f32_16x16x32_bf16 v[164:167], a[120:123], a[64:67], v[164:167]
  buffer_load_dwordx4 v49, s[16:19], s40 offen offset:1024 lds
  v_mfma_f32_16x16x32_bf16 v[164:167], a[124:127], a[80:83], v[164:167]
  v_mfma_f32_16x16x32_bf16 v[172:175], a[120:123], a[68:71], v[172:175]
  v_mfma_f32_16x16x32_bf16 v[172:175], a[124:127], a[84:87], v[172:175]
  buffer_load_dwordx4 v50, s[16:19], s40 offen offset:2048 lds
  v_mfma_f32_16x16x32_bf16 v[180:183], a[120:123], a[72:75], v[180:183]
  v_mfma_f32_16x16x32_bf16 v[180:183], a[124:127], a[88:91], v[180:183]
  v_mfma_f32_16x16x32_bf16 v[188:191], a[120:123], a[76:79], v[188:191]
  v_mfma_f32_16x16x32_bf16 v[188:191], a[124:127], a[92:95], v[188:191]
  v_mfma_f32_16x16x32_bf16 v[128:131], a[192:195], a[128:131], v[128:131]
  buffer_load_dwordx4 v51, s[16:19], s40 offen offset:3072 lds
  v_mfma_f32_16x16x32_bf16 v[128:131], a[196:199], a[144:147], v[128:131]
  v_mfma_f32_16x16x32_bf16 v[136:139], a[192:195], a[132:135], v[136:139]
  v_mfma_f32_16x16x32_bf16 v[136:139], a[196:199], a[148:151], v[136:139]
  s_mov_b32 s40, 3145728
  s_add_u32 m0, s32, 32768
  v_mfma_f32_16x16x32_bf16 v[144:147], a[192:195], a[136:139], v[144:147]
  buffer_load_dwordx4 v48, s[16:19], s40 offen lds
  v_mfma_f32_16x16x32_bf16 v[144:147], a[196:199], a[152:155], v[144:147]
  v_mfma_f32_16x16x32_bf16 v[152:155], a[192:195], a[140:143], v[152:155]
  v_mfma_f32_16x16x32_bf16 v[152:155], a[196:199], a[156:159], v[152:155]
  v_mfma_f32_16x16x32_bf16 v[132:135], a[200:203], a[128:131], v[132:135]
  buffer_load_dwordx4 v49, s[16:19], s40 offen offset:1024 lds
  v_mfma_f32_16x16x32_bf16 v[132:135], a[204:207], a[144:147], v[132:135]
  v_mfma_f32_16x16x32_bf16 v[140:143], a[200:203], a[132:135], v[140:143]
  v_mfma_f32_16x16x32_bf16 v[140:143], a[204:207], a[148:151], v[140:143]
  buffer_load_dwordx4 v50, s[16:19], s40 offen offset:2048 lds
  v_mfma_f32_16x16x32_bf16 v[148:151], a[200:203], a[136:139], v[148:151]
  v_mfma_f32_16x16x32_bf16 v[148:151], a[204:207], a[152:155], v[148:151]
  v_mfma_f32_16x16x32_bf16 v[156:159], a[200:203], a[140:143], v[156:159]
  v_mfma_f32_16x16x32_bf16 v[156:159], a[204:207], a[156:159], v[156:159]
  v_mfma_f32_16x16x32_bf16 v[160:163], a[208:211], a[128:131], v[160:163]
  s_waitcnt vmcnt(19)
  ds_read_b64_tr_b16 a[224:225], v58 offset:0
  ds_read_b64_tr_b16 a[226:227], v58 offset:2048
  v_mfma_f32_16x16x32_bf16 v[160:163], a[212:215], a[144:147], v[160:163]
  buffer_load_dwordx4 v51, s[16:19], s40 offen offset:3072 lds
  s_mov_b32 s40, 3407872
  v_mfma_f32_16x16x32_bf16 v[168:171], a[208:211], a[132:135], v[168:171]
  ds_read_b64_tr_b16 a[228:229], v58 offset:4096
  ds_read_b64_tr_b16 a[230:231], v58 offset:6144
  s_add_u32 m0, s32, 36864
  v_mfma_f32_16x16x32_bf16 v[168:171], a[212:215], a[148:151], v[168:171]
  v_mfma_f32_16x16x32_bf16 v[176:179], a[208:211], a[136:139], v[176:179]
  buffer_load_dwordx4 v48, s[16:19], s40 offen lds
  v_mfma_f32_16x16x32_bf16 v[176:179], a[212:215], a[152:155], v[176:179]
  v_mfma_f32_16x16x32_bf16 v[184:187], a[208:211], a[140:143], v[184:187]
  v_mfma_f32_16x16x32_bf16 v[184:187], a[212:215], a[156:159], v[184:187]
  v_mfma_f32_16x16x32_bf16 v[164:167], a[216:219], a[128:131], v[164:167]
  ds_read_b64_tr_b16 a[232:233], v58 offset:8
  ds_read_b64_tr_b16 a[234:235], v58 offset:2056
  v_mfma_f32_16x16x32_bf16 v[164:167], a[220:223], a[144:147], v[164:167]
  buffer_load_dwordx4 v49, s[16:19], s40 offen offset:1024 lds
  v_mfma_f32_16x16x32_bf16 v[172:175], a[216:219], a[132:135], v[172:175]
  ds_read_b64_tr_b16 a[236:237], v58 offset:4104
  ds_read_b64_tr_b16 a[238:239], v58 offset:6152
  v_mfma_f32_16x16x32_bf16 v[172:175], a[220:223], a[148:151], v[172:175]
  v_mfma_f32_16x16x32_bf16 v[180:183], a[216:219], a[136:139], v[180:183]
  buffer_load_dwordx4 v50, s[16:19], s40 offen offset:2048 lds
  v_mfma_f32_16x16x32_bf16 v[180:183], a[220:223], a[152:155], v[180:183]
  v_mfma_f32_16x16x32_bf16 v[188:191], a[216:219], a[140:143], v[188:191]
  v_mfma_f32_16x16x32_bf16 v[188:191], a[220:223], a[156:159], v[188:191]
  s_waitcnt lgkmcnt(4)
  v_mfma_f32_16x16x32_bf16 v[128:131], a[224:227], a[160:163], v[128:131]
  ds_read_b64_tr_b16 a[240:241], v59 offset:0
  ds_read_b64_tr_b16 a[242:243], v59 offset:2048
  v_mfma_f32_16x16x32_bf16 v[128:131], a[228:231], a[176:179], v[128:131]
  buffer_load_dwordx4 v51, s[16:19], s40 offen offset:3072 lds
  v_mfma_f32_16x16x32_bf16 v[136:139], a[224:227], a[164:167], v[136:139]
  ds_read_b64_tr_b16 a[244:245], v59 offset:4096
  ds_read_b64_tr_b16 a[246:247], v59 offset:6144
  v_mfma_f32_16x16x32_bf16 v[136:139], a[228:231], a[180:183], v[136:139]
  v_mfma_f32_16x16x32_bf16 v[144:147], a[224:227], a[168:171], v[144:147]
  s_mov_b32 s40, 128
  s_add_u32 m0, s32, 0
  v_mfma_f32_16x16x32_bf16 v[144:147], a[228:231], a[184:187], v[144:147]
  buffer_load_dwordx4 v48, s[16:19], s40 offen lds
  v_mfma_f32_16x16x32_bf16 v[152:155], a[224:227], a[172:175], v[152:155]
  v_mfma_f32_16x16x32_bf16 v[152:155], a[228:231], a[188:191], v[152:155]
  s_waitcnt lgkmcnt(4)
  v_mfma_f32_16x16x32_bf16 v[132:135], a[232:235], a[160:163], v[132:135]
  ds_read_b64_tr_b16 a[248:249], v59 offset:8
  ds_read_b64_tr_b16 a[250:251], v59 offset:2056
  v_mfma_f32_16x16x32_bf16 v[132:135], a[236:239], a[176:179], v[132:135]
  buffer_load_dwordx4 v49, s[16:19], s40 offen offset:1024 lds
  v_mfma_f32_16x16x32_bf16 v[140:143], a[232:235], a[164:167], v[140:143]
  ds_read_b64_tr_b16 a[252:253], v59 offset:4104
  ds_read_b64_tr_b16 a[254:255], v59 offset:6152
  v_mfma_f32_16x16x32_bf16 v[140:143], a[236:239], a[180:183], v[140:143]
  v_mfma_f32_16x16x32_bf16 v[148:151], a[232:235], a[168:171], v[148:151]
  buffer_load_dwordx4 v50, s[16:19], s40 offen offset:2048 lds
  v_mfma_f32_16x16x32_bf16 v[148:151], a[236:239], a[184:187], v[148:151]
  v_mfma_f32_16x16x32_bf16 v[156:159], a[232:235], a[172:175], v[156:159]
  v_mfma_f32_16x16x32_bf16 v[156:159], a[236:239], a[188:191], v[156:159]
  s_waitcnt lgkmcnt(4)
  v_mfma_f32_16x16x32_bf16 v[160:163], a[240:243], a[160:163], v[160:163]
  s_waitcnt vmcnt(19)
  ds_read_b64_tr_b16 a[224:225], v58 offset:32768
  ds_read_b64_tr_b16 a[226:227], v58 offset:34816
  v_mfma_f32_16x16x32_bf16 v[160:163], a[244:247], a[176:179], v[160:163]
  buffer_load_dwordx4 v51, s[16:19], s40 offen offset:3072 lds
  s_mov_b32 s40, 262272
  v_mfma_f32_16x16x32_bf16 v[168:171], a[240:243], a[164:167], v[168:171]
  ds_read_b64_tr_b16 a[228:229], v58 offset:36864
  ds_read_b64_tr_b16 a[230:231], v58 offset:38912
  s_add_u32 m0, s32, 4096
  v_mfma_f32_16x16x32_bf16 v[168:171], a[244:247], a[180:183], v[168:171]
  v_mfma_f32_16x16x32_bf16 v[176:179], a[240:243], a[168:171], v[176:179]
  buffer_load_dwordx4 v48, s[16:19], s40 offen lds
  v_mfma_f32_16x16x32_bf16 v[176:179], a[244:247], a[184:187], v[176:179]
  v_mfma_f32_16x16x32_bf16 v[184:187], a[240:243], a[172:175], v[184:187]
  v_mfma_f32_16x16x32_bf16 v[184:187], a[244:247], a[188:191], v[184:187]
  s_waitcnt lgkmcnt(4)
  v_mfma_f32_16x16x32_bf16 v[164:167], a[248:251], a[160:163], v[164:167]
  ds_read_b64_tr_b16 a[232:233], v58 offset:32776
  ds_read_b64_tr_b16 a[234:235], v58 offset:34824
  v_mfma_f32_16x16x32_bf16 v[164:167], a[252:255], a[176:179], v[164:167]
  buffer_load_dwordx4 v49, s[16:19], s40 offen offset:1024 lds
  v_mfma_f32_16x16x32_bf16 v[172:175], a[248:251], a[164:167], v[172:175]
  ds_read_b64_tr_b16 a[236:237], v58 offset:36872
  ds_read_b64_tr_b16 a[238:239], v58 offset:38920
  v_mfma_f32_16x16x32_bf16 v[172:175], a[252:255], a[180:183], v[172:175]
  v_mfma_f32_16x16x32_bf16 v[180:183], a[248:251], a[168:171], v[180:183]
  buffer_load_dwordx4 v50, s[16:19], s40 offen offset:2048 lds
  v_mfma_f32_16x16x32_bf16 v[180:183], a[252:255], a[184:187], v[180:183]
  v_mfma_f32_16x16x32_bf16 v[188:191], a[248:251], a[172:175], v[188:191]
  v_mfma_f32_16x16x32_bf16 v[188:191], a[252:255], a[188:191], v[188:191]
  s_waitcnt lgkmcnt(4)
  v_mfma_f32_16x16x32_bf16 v[128:131], a[224:227], a[32:35], v[128:131]
  ds_read_b64_tr_b16 a[240:241], v59 offset:32768
  ds_read_b64_tr_b16 a[242:243], v59 offset:34816
  v_mfma_f32_16x16x32_bf16 v[128:131], a[228:231], a[48:51], v[128:131]
  buffer_load_dwordx4 v51, s[16:19], s40 offen offset:3072 lds
  v_mfma_f32_16x16x32_bf16 v[136:139], a[224:227], a[36:39], v[136:139]
  ds_read_b64_tr_b16 a[244:245], v59 offset:36864
  ds_read_b64_tr_b16 a[246:247], v59 offset:38912
  v_mfma_f32_16x16x32_bf16 v[136:139], a[228:231], a[52:55], v[136:139]
  v_mfma_f32_16x16x32_bf16 v[144:147], a[224:227], a[40:43], v[144:147]
  s_mov_b32 s40, 524416
  s_add_u32 m0, s32, 65536
  v_mfma_f32_16x16x32_bf16 v[144:147], a[228:231], a[56:59], v[144:147]
  buffer_load_dwordx4 v48, s[16:19], s40 offen lds
  v_mfma_f32_16x16x32_bf16 v[152:155], a[224:227], a[44:47], v[152:155]
  v_mfma_f32_16x16x32_bf16 v[152:155], a[228:231], a[60:63], v[152:155]
  s_waitcnt lgkmcnt(4)
  v_mfma_f32_16x16x32_bf16 v[132:135], a[232:235], a[32:35], v[132:135]
  ds_read_b64_tr_b16 a[248:249], v59 offset:32776
  ds_read_b64_tr_b16 a[250:251], v59 offset:34824
  v_mfma_f32_16x16x32_bf16 v[132:135], a[236:239], a[48:51], v[132:135]
  buffer_load_dwordx4 v49, s[16:19], s40 offen offset:1024 lds
  v_mfma_f32_16x16x32_bf16 v[140:143], a[232:235], a[36:39], v[140:143]
  ds_read_b64_tr_b16 a[252:253], v59 offset:36872
  ds_read_b64_tr_b16 a[254:255], v59 offset:38920
  v_mfma_f32_16x16x32_bf16 v[140:143], a[236:239], a[52:55], v[140:143]
  v_mfma_f32_16x16x32_bf16 v[148:151], a[232:235], a[40:43], v[148:151]
  buffer_load_dwordx4 v50, s[16:19], s40 offen offset:2048 lds
  v_mfma_f32_16x16x32_bf16 v[148:151], a[236:239], a[56:59], v[148:151]
  v_mfma_f32_16x16x32_bf16 v[156:159], a[232:235], a[44:47], v[156:159]
  v_mfma_f32_16x16x32_bf16 v[156:159], a[236:239], a[60:63], v[156:159]
  s_waitcnt lgkmcnt(4)
  v_mfma_f32_16x16x32_bf16 v[160:163], a[240:243], a[32:35], v[160:163]
  s_waitcnt vmcnt(19)
  ds_read_b64_tr_b16 a[224:225], v60 offset:0
  ds_read_b64_tr_b16 a[226:227], v60 offset:2048
  v_mfma_f32_16x16x32_bf16 v[160:163], a[244:247], a[48:51], v[160:163]
  buffer_load_dwordx4 v51, s[16:19], s40 offen offset:3072 lds
  s_mov_b32 s40, 786560
  v_mfma_f32_16x16x32_bf16 v[168:171], a[240:243], a[36:39], v[168:171]
  ds_read_b64_tr_b16 a[228:229], v60 offset:4096
  ds_read_b64_tr_b16 a[230:231], v60 offset:6144
  s_add_u32 m0, s32, 69632
  v_mfma_f32_16x16x32_bf16 v[168:171], a[244:247], a[52:55], v[168:171]
  v_mfma_f32_16x16x32_bf16 v[176:179], a[240:243], a[40:43], v[176:179]
  buffer_load_dwordx4 v48, s[16:19], s40 offen lds
  v_mfma_f32_16x16x32_bf16 v[176:179], a[244:247], a[56:59], v[176:179]
  v_mfma_f32_16x16x32_bf16 v[184:187], a[240:243], a[44:47], v[184:187]
  v_mfma_f32_16x16x32_bf16 v[184:187], a[244:247], a[60:63], v[184:187]
  s_waitcnt lgkmcnt(4)
  v_mfma_f32_16x16x32_bf16 v[164:167], a[248:251], a[32:35], v[164:167]
  ds_read_b64_tr_b16 a[232:233], v60 offset:8
  ds_read_b64_tr_b16 a[234:235], v60 offset:2056
  v_mfma_f32_16x16x32_bf16 v[164:167], a[252:255], a[48:51], v[164:167]
  buffer_load_dwordx4 v49, s[16:19], s40 offen offset:1024 lds
  v_mfma_f32_16x16x32_bf16 v[172:175], a[248:251], a[36:39], v[172:175]
  ds_read_b64_tr_b16 a[236:237], v60 offset:4104
  ds_read_b64_tr_b16 a[238:239], v60 offset:6152
  v_mfma_f32_16x16x32_bf16 v[172:175], a[252:255], a[52:55], v[172:175]
  v_mfma_f32_16x16x32_bf16 v[180:183], a[248:251], a[40:43], v[180:183]
  buffer_load_dwordx4 v50, s[16:19], s40 offen offset:2048 lds
  v_mfma_f32_16x16x32_bf16 v[180:183], a[252:255], a[56:59], v[180:183]
  v_mfma_f32_16x16x32_bf16 v[188:191], a[248:251], a[44:47], v[188:191]
  v_mfma_f32_16x16x32_bf16 v[188:191], a[252:255], a[60:63], v[188:191]
  s_waitcnt lgkmcnt(4)
  v_mfma_f32_16x16x32_bf16 v[128:131], a[224:227], v[96:99], v[128:131]
  ds_read_b64_tr_b16 a[240:241], v61 offset:0
  ds_read_b64_tr_b16 a[242:243], v61 offset:2048
  v_mfma_f32_16x16x32_bf16 v[128:131], a[228:231], v[112:115], v[128:131]
  buffer_load_dwordx4 v51, s[16:19], s40 offen offset:3072 lds
  v_mfma_f32_16x16x32_bf16 v[136:139], a[224:227], v[100:103], v[136:139]
  ds_read_b64_tr_b16 a[244:245], v61 offset:4096
  ds_read_b64_tr_b16 a[246:247], v61 offset:6144
  v_mfma_f32_16x16x32_bf16 v[136:139], a[228:231], v[116:119], v[136:139]
  v_mfma_f32_16x16x32_bf16 v[144:147], a[224:227], v[104:107], v[144:147]
  s_mov_b32 s40, 1048704
  s_add_u32 m0, s32, 98304
  v_mfma_f32_16x16x32_bf16 v[144:147], a[228:231], v[120:123], v[144:147]
  buffer_load_dwordx4 v48, s[16:19], s40 offen lds
  v_mfma_f32_16x16x32_bf16 v[152:155], a[224:227], v[108:111], v[152:155]
  v_mfma_f32_16x16x32_bf16 v[152:155], a[228:231], v[124:127], v[152:155]
  s_waitcnt lgkmcnt(4)
  v_mfma_f32_16x16x32_bf16 v[132:135], a[232:235], v[96:99], v[132:135]
  ds_read_b64_tr_b16 a[248:249], v61 offset:8
  ds_read_b64_tr_b16 a[250:251], v61 offset:2056
  v_mfma_f32_16x16x32_bf16 v[132:135], a[236:239], v[112:115], v[132:135]
  buffer_load_dwordx4 v49, s[16:19], s40 offen offset:1024 lds
  v_mfma_f32_16x16x32_bf16 v[140:143], a[232:235], v[100:103], v[140:143]
  ds_read_b64_tr_b16 a[252:253], v61 offset:4104
  ds_read_b64_tr_b16 a[254:255], v61 offset:6152
  v_mfma_f32_16x16x32_bf16 v[140:143], a[236:239], v[116:119], v[140:143]
  v_mfma_f32_16x16x32_bf16 v[148:151], a[232:235], v[104:107], v[148:151]
  buffer_load_dwordx4 v50, s[16:19], s40 offen offset:2048 lds
  v_mfma_f32_16x16x32_bf16 v[148:151], a[236:239], v[120:123], v[148:151]
  v_mfma_f32_16x16x32_bf16 v[156:159], a[232:235], v[108:111], v[156:159]
  v_mfma_f32_16x16x32_bf16 v[156:159], a[236:239], v[124:127], v[156:159]
  s_waitcnt lgkmcnt(4)
  v_mfma_f32_16x16x32_bf16 v[160:163], a[240:243], v[96:99], v[160:163]
  s_waitcnt vmcnt(19)
  ds_read_b64_tr_b16 a[224:225], v56 offset:32768
  ds_read_b64_tr_b16 a[226:227], v56 offset:34816
  v_mfma_f32_16x16x32_bf16 v[160:163], a[244:247], v[112:115], v[160:163]
  buffer_load_dwordx4 v51, s[16:19], s40 offen offset:3072 lds
  s_mov_b32 s40, 1310848
  v_mfma_f32_16x16x32_bf16 v[168:171], a[240:243], v[100:103], v[168:171]
  ds_read_b64_tr_b16 a[228:229], v56 offset:36864
  ds_read_b64_tr_b16 a[230:231], v56 offset:38912
  s_add_u32 m0, s32, 102400
  v_mfma_f32_16x16x32_bf16 v[168:171], a[244:247], v[116:119], v[168:171]
  v_mfma_f32_16x16x32_bf16 v[176:179], a[240:243], v[104:107], v[176:179]
  buffer_load_dwordx4 v48, s[16:19], s40 offen lds
  v_mfma_f32_16x16x32_bf16 v[176:179], a[244:247], v[120:123], v[176:179]
  v_mfma_f32_16x16x32_bf16 v[184:187], a[240:243], v[108:111], v[184:187]
  v_mfma_f32_16x16x32_bf16 v[184:187], a[244:247], v[124:127], v[184:187]
  s_waitcnt lgkmcnt(4)
  v_mfma_f32_16x16x32_bf16 v[164:167], a[248:251], v[96:99], v[164:167]
  ds_read_b64_tr_b16 a[232:233], v56 offset:32776
  ds_read_b64_tr_b16 a[234:235], v56 offset:34824
  v_mfma_f32_16x16x32_bf16 v[164:167], a[252:255], v[112:115], v[164:167]
  buffer_load_dwordx4 v49, s[16:19], s40 offen offset:1024 lds
  v_mfma_f32_16x16x32_bf16 v[172:175], a[248:251], v[100:103], v[172:175]
  ds_read_b64_tr_b16 a[236:237], v56 offset:36872
  ds_read_b64_tr_b16 a[238:239], v56 offset:38920
  v_mfma_f32_16x16x32_bf16 v[172:175], a[252:255], v[116:119], v[172:175]
  v_mfma_f32_16x16x32_bf16 v[180:183], a[248:251], v[104:107], v[180:183]
  buffer_load_dwordx4 v50, s[16:19], s40 offen offset:2048 lds
  v_mfma_f32_16x16x32_bf16 v[180:183], a[252:255], v[120:123], v[180:183]
  v_mfma_f32_16x16x32_bf16 v[188:191], a[248:251], v[108:111], v[188:191]
  v_mfma_f32_16x16x32_bf16 v[188:191], a[252:255], v[124:127], v[188:191]
  s_waitcnt lgkmcnt(4)
  v_mfma_f32_16x16x32_bf16 v[128:131], a[224:227], v[64:67], v[128:131]
  ds_read_b64_tr_b16 a[240:241], v57 offset:32768
  ds_read_b64_tr_b16 a[242:243], v57 offset:34816
  v_mfma_f32_16x16x32_bf16 v[128:131], a[228:231], v[80:83], v[128:131]
  buffer_load_dwordx4 v51, s[16:19], s40 offen offset:3072 lds
  v_mfma_f32_16x16x32_bf16 v[136:139], a[224:227], v[68:71], v[136:139]
  ds_read_b64_tr_b16 a[244:245], v57 offset:36864
  ds_read_b64_tr_b16 a[246:247], v57 offset:38912
  v_mfma_f32_16x16x32_bf16 v[136:139], a[228:231], v[84:87], v[136:139]
  v_mfma_f32_16x16x32_bf16 v[144:147], a[224:227], v[72:75], v[144:147]
  s_mov_b32 s40, 1572992
  s_add_u32 m0, s32, 131072
  v_mfma_f32_16x16x32_bf16 v[144:147], a[228:231], v[88:91], v[144:147]
  buffer_load_dwordx4 v48, s[16:19], s40 offen lds
  v_mfma_f32_16x16x32_bf16 v[152:155], a[224:227], v[76:79], v[152:155]
  v_mfma_f32_16x16x32_bf16 v[152:155], a[228:231], v[92:95], v[152:155]
  s_waitcnt lgkmcnt(4)
  v_mfma_f32_16x16x32_bf16 v[132:135], a[232:235], v[64:67], v[132:135]
  ds_read_b64_tr_b16 a[248:249], v57 offset:32776
  ds_read_b64_tr_b16 a[250:251], v57 offset:34824
  v_mfma_f32_16x16x32_bf16 v[132:135], a[236:239], v[80:83], v[132:135]
  buffer_load_dwordx4 v49, s[16:19], s40 offen offset:1024 lds
  v_mfma_f32_16x16x32_bf16 v[140:143], a[232:235], v[68:71], v[140:143]
  ds_read_b64_tr_b16 a[252:253], v57 offset:36872
  ds_read_b64_tr_b16 a[254:255], v57 offset:38920
  v_mfma_f32_16x16x32_bf16 v[140:143], a[236:239], v[84:87], v[140:143]
  v_mfma_f32_16x16x32_bf16 v[148:151], a[232:235], v[72:75], v[148:151]
  buffer_load_dwordx4 v50, s[16:19], s40 offen offset:2048 lds
  v_mfma_f32_16x16x32_bf16 v[148:151], a[236:239], v[88:91], v[148:151]
  v_mfma_f32_16x16x32_bf16 v[156:159], a[232:235], v[76:79], v[156:159]
  v_cvt_pk_bf16_f32 v128, v128, v129
  v_cvt_pk_bf16_f32 v129, v130, v131
  v_mfma_f32_16x16x32_bf16 v[156:159], a[236:239], v[92:95], v[156:159]
  v_cvt_pk_bf16_f32 v130, v132, v133
  s_waitcnt lgkmcnt(4)
  v_mfma_f32_16x16x32_bf16 v[160:163], a[240:243], v[64:67], v[160:163]
  s_waitcnt vmcnt(19)
  ds_read_b64_tr_b16 a[224:225], v56 offset:0
  ds_read_b64_tr_b16 a[226:227], v56 offset:2048
  v_mfma_f32_16x16x32_bf16 v[160:163], a[244:247], v[80:83], v[160:163]
  buffer_load_dwordx4 v51, s[16:19], s40 offen offset:3072 lds
  s_mov_b32 s40, 1835136
  v_mfma_f32_16x16x32_bf16 v[168:171], a[240:243], v[68:71], v[168:171]
  ds_read_b64_tr_b16 a[228:229], v56 offset:4096
  ds_read_b64_tr_b16 a[230:231], v56 offset:6144
  s_add_u32 m0, s32, 135168
  v_mfma_f32_16x16x32_bf16 v[168:171], a[244:247], v[84:87], v[168:171]
  v_cvt_pk_bf16_f32 v131, v134, v135
  v_cvt_pk_bf16_f32 v136, v136, v137
  v_mfma_f32_16x16x32_bf16 v[176:179], a[240:243], v[72:75], v[176:179]
  buffer_load_dwordx4 v48, s[16:19], s40 offen lds
  v_mfma_f32_16x16x32_bf16 v[176:179], a[244:247], v[88:91], v[176:179]
  v_cvt_pk_bf16_f32 v137, v138, v139
  v_cvt_pk_bf16_f32 v138, v140, v141
  v_mfma_f32_16x16x32_bf16 v[184:187], a[240:243], v[76:79], v[184:187]
  v_cvt_pk_bf16_f32 v139, v142, v143
  v_cvt_pk_bf16_f32 v144, v144, v145
  v_mfma_f32_16x16x32_bf16 v[184:187], a[244:247], v[92:95], v[184:187]
  v_cvt_pk_bf16_f32 v145, v146, v147
  s_waitcnt lgkmcnt(4)
  v_mfma_f32_16x16x32_bf16 v[164:167], a[248:251], v[64:67], v[164:167]
  ds_read_b64_tr_b16 a[232:233], v56 offset:8
  ds_read_b64_tr_b16 a[234:235], v56 offset:2056
  v_mfma_f32_16x16x32_bf16 v[164:167], a[252:255], v[80:83], v[164:167]
  buffer_load_dwordx4 v49, s[16:19], s40 offen offset:1024 lds
  v_mfma_f32_16x16x32_bf16 v[172:175], a[248:251], v[68:71], v[172:175]
  ds_read_b64_tr_b16 a[236:237], v56 offset:4104
  ds_read_b64_tr_b16 a[238:239], v56 offset:6152
  v_mfma_f32_16x16x32_bf16 v[172:175], a[252:255], v[84:87], v[172:175]
  v_cvt_pk_bf16_f32 v146, v148, v149
  v_cvt_pk_bf16_f32 v147, v150, v151
  v_mfma_f32_16x16x32_bf16 v[180:183], a[248:251], v[72:75], v[180:183]
  buffer_load_dwordx4 v50, s[16:19], s40 offen offset:2048 lds
  v_mfma_f32_16x16x32_bf16 v[180:183], a[252:255], v[88:91], v[180:183]
  v_cvt_pk_bf16_f32 v152, v152, v153
  v_cvt_pk_bf16_f32 v153, v154, v155
  v_mfma_f32_16x16x32_bf16 v[188:191], a[248:251], v[76:79], v[188:191]
  v_cvt_pk_bf16_f32 v154, v156, v157
  v_cvt_pk_bf16_f32 v155, v158, v159
  v_mfma_f32_16x16x32_bf16 v[188:191], a[252:255], v[92:95], v[188:191]
  v_cvt_pk_bf16_f32 v160, v160, v161
  s_waitcnt lgkmcnt(4)
  v_mfma_f32_16x16x32_bf16 v[192:195], a[224:227], a[0:3], 0
  ds_read_b64_tr_b16 a[240:241], v57 offset:0
  ds_read_b64_tr_b16 a[242:243], v57 offset:2048
  v_mfma_f32_16x16x32_bf16 v[192:195], a[228:231], a[16:19], v[192:195]
  buffer_load_dwordx4 v51, s[16:19], s40 offen offset:3072 lds
  v_mfma_f32_16x16x32_bf16 v[200:203], a[224:227], a[4:7], 0
  ds_read_b64_tr_b16 a[244:245], v57 offset:4096
  ds_read_b64_tr_b16 a[246:247], v57 offset:6144
  v_mfma_f32_16x16x32_bf16 v[200:203], a[228:231], a[20:23], v[200:203]
  v_cvt_pk_bf16_f32 v161, v162, v163
  v_cvt_pk_bf16_f32 v162, v164, v165
  v_mfma_f32_16x16x32_bf16 v[208:211], a[224:227], a[8:11], 0
  s_mov_b32 s40, 2097280
  s_add_u32 m0, s32, 32768
  v_mfma_f32_16x16x32_bf16 v[208:211], a[228:231], a[24:27], v[208:211]
  buffer_load_dwordx4 v48, s[16:19], s40 offen lds
  v_mfma_f32_16x16x32_bf16 v[216:219], a[224:227], a[12:15], 0
  v_cvt_pk_bf16_f32 v163, v166, v167
  v_cvt_pk_bf16_f32 v168, v168, v169
  v_mfma_f32_16x16x32_bf16 v[216:219], a[228:231], a[28:31], v[216:219]
  v_cvt_pk_bf16_f32 v169, v170, v171
  s_waitcnt lgkmcnt(4)
  v_mfma_f32_16x16x32_bf16 v[196:199], a[232:235], a[0:3], 0
  ds_read_b64_tr_b16 a[248:249], v57 offset:8
  ds_read_b64_tr_b16 a[250:251], v57 offset:2056
  v_mfma_f32_16x16x32_bf16 v[196:199], a[236:239], a[16:19], v[196:199]
  buffer_load_dwordx4 v49, s[16:19], s40 offen offset:1024 lds
  v_mfma_f32_16x16x32_bf16 v[204:207], a[232:235], a[4:7], 0
  ds_read_b64_tr_b16 a[252:253], v57 offset:4104
  ds_read_b64_tr_b16 a[254:255], v57 offset:6152
  v_mfma_f32_16x16x32_bf16 v[204:207], a[236:239], a[20:23], v[204:207]
  v_cvt_pk_bf16_f32 v170, v172, v173
  v_cvt_pk_bf16_f32 v171, v174, v175
  v_mfma_f32_16x16x32_bf16 v[212:215], a[232:235], a[8:11], 0
  buffer_load_dwordx4 v50, s[16:19], s40 offen offset:2048 lds
  v_mfma_f32_16x16x32_bf16 v[212:215], a[236:239], a[24:27], v[212:215]
  v_cvt_pk_bf16_f32 v176, v176, v177
  v_cvt_pk_bf16_f32 v177, v178, v179
  v_mfma_f32_16x16x32_bf16 v[220:223], a[232:235], a[12:15], 0
  v_cvt_pk_bf16_f32 v178, v180, v181
  v_cvt_pk_bf16_f32 v179, v182, v183
  v_mfma_f32_16x16x32_bf16 v[220:223], a[236:239], a[28:31], v[220:223]
  v_cvt_pk_bf16_f32 v184, v184, v185
  s_waitcnt lgkmcnt(4)
  v_mfma_f32_16x16x32_bf16 v[224:227], a[240:243], a[0:3], 0
  s_waitcnt vmcnt(19)
  ds_read_b64_tr_b16 a[224:225], v58 offset:0
  ds_read_b64_tr_b16 a[226:227], v58 offset:2048
  v_mfma_f32_16x16x32_bf16 v[224:227], a[244:247], a[16:19], v[224:227]
  buffer_load_dwordx4 v51, s[16:19], s40 offen offset:3072 lds
  s_mov_b32 s40, 2359424
  v_mfma_f32_16x16x32_bf16 v[232:235], a[240:243], a[4:7], 0
  ds_read_b64_tr_b16 a[228:229], v58 offset:4096
  ds_read_b64_tr_b16 a[230:231], v58 offset:6144
  s_add_u32 m0, s32, 36864
  v_mfma_f32_16x16x32_bf16 v[232:235], a[244:247], a[20:23], v[232:235]
  v_cvt_pk_bf16_f32 v185, v186, v187
  v_cvt_pk_bf16_f32 v186, v188, v189
  v_mfma_f32_16x16x32_bf16 v[240:243], a[240:243], a[8:11], 0
  buffer_load_dwordx4 v48, s[16:19], s40 offen lds
  v_mfma_f32_16x16x32_bf16 v[240:243], a[244:247], a[24:27], v[240:243]
  v_cvt_pk_bf16_f32 v187, v190, v191
  v_mfma_f32_16x16x32_bf16 v[248:251], a[240:243], a[12:15], 0
  v_mfma_f32_16x16x32_bf16 v[248:251], a[244:247], a[28:31], v[248:251]
  s_waitcnt lgkmcnt(4)
  v_mfma_f32_16x16x32_bf16 v[228:231], a[248:251], a[0:3], 0
  ds_read_b64_tr_b16 a[232:233], v58 offset:8
  ds_read_b64_tr_b16 a[234:235], v58 offset:2056
  v_mfma_f32_16x16x32_bf16 v[228:231], a[252:255], a[16:19], v[228:231]
  buffer_load_dwordx4 v49, s[16:19], s40 offen offset:1024 lds
  v_mfma_f32_16x16x32_bf16 v[236:239], a[248:251], a[4:7], 0
  ds_read_b64_tr_b16 a[236:237], v58 offset:4104
  ds_read_b64_tr_b16 a[238:239], v58 offset:6152
  v_mfma_f32_16x16x32_bf16 v[236:239], a[252:255], a[20:23], v[236:239]
  v_mfma_f32_16x16x32_bf16 v[244:247], a[248:251], a[8:11], 0
  buffer_load_dwordx4 v50, s[16:19], s40 offen offset:2048 lds
  v_mfma_f32_16x16x32_bf16 v[244:247], a[252:255], a[24:27], v[244:247]
  v_mfma_f32_16x16x32_bf16 v[252:255], a[248:251], a[12:15], 0
  v_mfma_f32_16x16x32_bf16 v[252:255], a[252:255], a[28:31], v[252:255]
  s_waitcnt lgkmcnt(4)
  v_mfma_f32_16x16x32_bf16 v[192:195], a[224:227], a[64:67], v[192:195]
  ds_read_b64_tr_b16 a[240:241], v59 offset:0
  ds_read_b64_tr_b16 a[242:243], v59 offset:2048
  v_mfma_f32_16x16x32_bf16 v[192:195], a[228:231], a[80:83], v[192:195]
  buffer_load_dwordx4 v51, s[16:19], s40 offen offset:3072 lds
  v_mfma_f32_16x16x32_bf16 v[200:203], a[224:227], a[68:71], v[200:203]
  ds_read_b64_tr_b16 a[244:245], v59 offset:4096
  ds_read_b64_tr_b16 a[246:247], v59 offset:6144
  v_mfma_f32_16x16x32_bf16 v[200:203], a[228:231], a[84:87], v[200:203]
  v_mfma_f32_16x16x32_bf16 v[208:211], a[224:227], a[72:75], v[208:211]
  v_lshl_add_u32 v53, v2, 4, s32
  v_add_u32 v53, 98304, v53
  v_mfma_f32_16x16x32_bf16 v[208:211], a[228:231], a[88:91], v[208:211]
  v_xor_b32 v55, 0x2000, v53
  s_lshl_b32 s41, s3, 8
  v_mfma_f32_16x16x32_bf16 v[216:219], a[224:227], a[76:79], v[216:219]
  s_add_u32 s41, s41, 147456
  v_and_b32 v3, 15, v2
  v_mfma_f32_16x16x32_bf16 v[216:219], a[228:231], a[92:95], v[216:219]
  v_lshl_add_u32 v3, v3, 4, s41
  s_waitcnt lgkmcnt(4)
  v_mfma_f32_16x16x32_bf16 v[196:199], a[232:235], a[64:67], v[196:199]
  ds_read_b64_tr_b16 a[248:249], v59 offset:8
  ds_read_b64_tr_b16 a[250:251], v59 offset:2056
  v_mfma_f32_16x16x32_bf16 v[196:199], a[236:239], a[80:83], v[196:199]
  v_lshrrev_b32 v1, 4, v2
  v_lshl_add_u32 v1, v1, 2, v3
  v_mfma_f32_16x16x32_bf16 v[204:207], a[232:235], a[68:71], v[204:207]
  ds_read_b64_tr_b16 a[252:253], v59 offset:4104
  ds_read_b64_tr_b16 a[254:255], v59 offset:6152
  v_mfma_f32_16x16x32_bf16 v[204:207], a[236:239], a[84:87], v[204:207]
  v_xor_b32 v47, 0x100, v3
  v_mfma_f32_16x16x32_bf16 v[212:215], a[232:235], a[72:75], v[212:215]
  v_mfma_f32_16x16x32_bf16 v[212:215], a[236:239], a[88:91], v[212:215]
  v_mfma_f32_16x16x32_bf16 v[220:223], a[232:235], a[76:79], v[220:223]
  v_mfma_f32_16x16x32_bf16 v[220:223], a[236:239], a[92:95], v[220:223]
  s_waitcnt lgkmcnt(4)
  v_mfma_f32_16x16x32_bf16 v[224:227], a[240:243], a[64:67], v[224:227]
  s_waitcnt vmcnt(16)
  ds_read_b64_tr_b16 a[224:225], v58 offset:32768
  ds_read_b64_tr_b16 a[226:227], v58 offset:34816
  v_mfma_f32_16x16x32_bf16 v[224:227], a[244:247], a[80:83], v[224:227]
  v_mfma_f32_16x16x32_bf16 v[232:235], a[240:243], a[68:71], v[232:235]
  ds_read_b64_tr_b16 a[228:229], v58 offset:36864
  ds_read_b64_tr_b16 a[230:231], v58 offset:38912
  v_mfma_f32_16x16x32_bf16 v[232:235], a[244:247], a[84:87], v[232:235]
  v_mfma_f32_16x16x32_bf16 v[240:243], a[240:243], a[72:75], v[240:243]
  v_mfma_f32_16x16x32_bf16 v[240:243], a[244:247], a[88:91], v[240:243]
  v_mfma_f32_16x16x32_bf16 v[248:251], a[240:243], a[76:79], v[248:251]
  v_mfma_f32_16x16x32_bf16 v[248:251], a[244:247], a[92:95], v[248:251]
  s_waitcnt lgkmcnt(4)
  v_mfma_f32_16x16x32_bf16 v[228:231], a[248:251], a[64:67], v[228:231]
  ds_read_b64_tr_b16 a[232:233], v58 offset:32776
  ds_read_b64_tr_b16 a[234:235], v58 offset:34824
  v_mfma_f32_16x16x32_bf16 v[228:231], a[252:255], a[80:83], v[228:231]
  s_mov_b32 s40, 2621568
  s_add_u32 m0, s32, 65536
  v_mfma_f32_16x16x32_bf16 v[236:239], a[248:251], a[68:71], v[236:239]
  ds_read_b64_tr_b16 a[236:237], v58 offset:36872
  ds_read_b64_tr_b16 a[238:239], v58 offset:38920
  v_mfma_f32_16x16x32_bf16 v[236:239], a[252:255], a[84:87], v[236:239]
  buffer_load_dwordx4 v48, s[16:19], s40 offen lds
  v_mfma_f32_16x16x32_bf16 v[244:247], a[248:251], a[72:75], v[244:247]
  v_mfma_f32_16x16x32_bf16 v[244:247], a[252:255], a[88:91], v[244:247]
  v_mfma_f32_16x16x32_bf16 v[252:255], a[248:251], a[76:79], v[252:255]
  buffer_load_dwordx4 v49, s[16:19], s40 offen offset:1024 lds
  v_mfma_f32_16x16x32_bf16 v[252:255], a[252:255], a[92:95], v[252:255]
  s_waitcnt lgkmcnt(4)
  v_mfma_f32_16x16x32_bf16 v[192:195], a[224:227], a[128:131], v[192:195]
  ds_read_b64_tr_b16 a[240:241], v59 offset:32768
  ds_read_b64_tr_b16 a[242:243], v59 offset:34816
  v_mfma_f32_16x16x32_bf16 v[192:195], a[228:231], a[144:147], v[192:195]
  v_mfma_f32_16x16x32_bf16 v[200:203], a[224:227], a[132:135], v[200:203]
  ds_read_b64_tr_b16 a[244:245], v59 offset:36864
  ds_read_b64_tr_b16 a[246:247], v59 offset:38912
  v_mfma_f32_16x16x32_bf16 v[200:203], a[228:231], a[148:151], v[200:203]
  buffer_load_dwordx4 v50, s[16:19], s40 offen offset:2048 lds
  v_mfma_f32_16x16x32_bf16 v[208:211], a[224:227], a[136:139], v[208:211]
  v_mfma_f32_16x16x32_bf16 v[208:211], a[228:231], a[152:155], v[208:211]
  v_mfma_f32_16x16x32_bf16 v[216:219], a[224:227], a[140:143], v[216:219]
  buffer_load_dwordx4 v51, s[16:19], s40 offen offset:3072 lds
  s_mov_b32 s40, 2883712
  v_mfma_f32_16x16x32_bf16 v[216:219], a[228:231], a[156:159], v[216:219]
  s_add_u32 m0, s32, 69632
  s_waitcnt lgkmcnt(4)
  v_mfma_f32_16x16x32_bf16 v[196:199], a[232:235], a[128:131], v[196:199]
  ds_read_b64_tr_b16 a[248:249], v59 offset:32776
  ds_read_b64_tr_b16 a[250:251], v59 offset:34824
  v_mfma_f32_16x16x32_bf16 v[196:199], a[236:239], a[144:147], v[196:199]
  v_mfma_f32_16x16x32_bf16 v[204:207], a[232:235], a[132:135], v[204:207]
  ds_read_b64_tr_b16 a[252:253], v59 offset:36872
  ds_read_b64_tr_b16 a[254:255], v59 offset:38920
  v_mfma_f32_16x16x32_bf16 v[204:207], a[236:239], a[148:151], v[204:207]
  buffer_load_dwordx4 v48, s[16:19], s40 offen lds
  v_mfma_f32_16x16x32_bf16 v[212:215], a[232:235], a[136:139], v[212:215]
  v_mfma_f32_16x16x32_bf16 v[212:215], a[236:239], a[152:155], v[212:215]
  v_mfma_f32_16x16x32_bf16 v[220:223], a[232:235], a[140:143], v[220:223]
  buffer_load_dwordx4 v49, s[16:19], s40 offen offset:1024 lds
  v_mfma_f32_16x16x32_bf16 v[220:223], a[236:239], a[156:159], v[220:223]
  s_waitcnt lgkmcnt(4)
  v_mfma_f32_16x16x32_bf16 v[224:227], a[240:243], a[128:131], v[224:227]
  s_waitcnt vmcnt(14)
  ds_read_b64_tr_b16 a[224:225], v60 offset:0
  ds_read_b64_tr_b16 a[226:227], v60 offset:2048
  v_mfma_f32_16x16x32_bf16 v[224:227], a[244:247], a[144:147], v[224:227]
  v_mfma_f32_16x16x32_bf16 v[232:235], a[240:243], a[132:135], v[232:235]
  ds_read_b64_tr_b16 a[228:229], v60 offset:4096
  ds_read_b64_tr_b16 a[230:231], v60 offset:6144
  v_mfma_f32_16x16x32_bf16 v[232:235], a[244:247], a[148:151], v[232:235]
  buffer_load_dwordx4 v50, s[16:19], s40 offen offset:2048 lds
  v_mfma_f32_16x16x32_bf16 v[240:243], a[240:243], a[136:139], v[240:243]
  v_mfma_f32_16x16x32_bf16 v[240:243], a[244:247], a[152:155], v[240:243]
  v_mfma_f32_16x16x32_bf16 v[248:251], a[240:243], a[140:143], v[248:251]
  buffer_load_dwordx4 v51, s[16:19], s40 offen offset:3072 lds
  v_mfma_f32_16x16x32_bf16 v[248:251], a[244:247], a[156:159], v[248:251]
  s_waitcnt lgkmcnt(4)
  v_mfma_f32_16x16x32_bf16 v[228:231], a[248:251], a[128:131], v[228:231]
  ds_read_b64_tr_b16 a[232:233], v60 offset:8
  ds_read_b64_tr_b16 a[234:235], v60 offset:2056
  v_mfma_f32_16x16x32_bf16 v[228:231], a[252:255], a[144:147], v[228:231]
  s_mov_b32 s40, 3145856
  s_add_u32 m0, s32, 98304
  v_mfma_f32_16x16x32_bf16 v[236:239], a[248:251], a[132:135], v[236:239]
  ds_read_b64_tr_b16 a[236:237], v60 offset:4104
  ds_read_b64_tr_b16 a[238:239], v60 offset:6152
  v_mfma_f32_16x16x32_bf16 v[236:239], a[252:255], a[148:151], v[236:239]
  buffer_load_dwordx4 v48, s[16:19], s40 offen lds
  v_mfma_f32_16x16x32_bf16 v[244:247], a[248:251], a[136:139], v[244:247]
  v_mfma_f32_16x16x32_bf16 v[244:247], a[252:255], a[152:155], v[244:247]
  v_mfma_f32_16x16x32_bf16 v[252:255], a[248:251], a[140:143], v[252:255]
  buffer_load_dwordx4 v49, s[16:19], s40 offen offset:1024 lds
  v_mfma_f32_16x16x32_bf16 v[252:255], a[252:255], a[156:159], v[252:255]
  s_waitcnt lgkmcnt(4)
  v_mfma_f32_16x16x32_bf16 v[192:195], a[224:227], a[160:163], v[192:195]
  ds_read_b64_tr_b16 a[240:241], v61 offset:0
  ds_read_b64_tr_b16 a[242:243], v61 offset:2048
  v_mfma_f32_16x16x32_bf16 v[192:195], a[228:231], a[176:179], v[192:195]
  v_mfma_f32_16x16x32_bf16 v[200:203], a[224:227], a[164:167], v[200:203]
  ds_read_b64_tr_b16 a[244:245], v61 offset:4096
  ds_read_b64_tr_b16 a[246:247], v61 offset:6144
  v_mfma_f32_16x16x32_bf16 v[200:203], a[228:231], a[180:183], v[200:203]
  buffer_load_dwordx4 v50, s[16:19], s40 offen offset:2048 lds
  v_mfma_f32_16x16x32_bf16 v[208:211], a[224:227], a[168:171], v[208:211]
  v_mfma_f32_16x16x32_bf16 v[208:211], a[228:231], a[184:187], v[208:211]
  v_mfma_f32_16x16x32_bf16 v[216:219], a[224:227], a[172:175], v[216:219]
  buffer_load_dwordx4 v51, s[16:19], s40 offen offset:3072 lds
  s_mov_b32 s40, 3408000
  v_mfma_f32_16x16x32_bf16 v[216:219], a[228:231], a[188:191], v[216:219]
  s_add_u32 m0, s32, 102400
  s_waitcnt lgkmcnt(4)
  v_mfma_f32_16x16x32_bf16 v[196:199], a[232:235], a[160:163], v[196:199]
  ds_read_b64_tr_b16 a[248:249], v61 offset:8
  ds_read_b64_tr_b16 a[250:251], v61 offset:2056
  v_mfma_f32_16x16x32_bf16 v[196:199], a[236:239], a[176:179], v[196:199]
  v_mfma_f32_16x16x32_bf16 v[204:207], a[232:235], a[164:167], v[204:207]
  ds_read_b64_tr_b16 a[252:253], v61 offset:4104
  ds_read_b64_tr_b16 a[254:255], v61 offset:6152
  v_mfma_f32_16x16x32_bf16 v[204:207], a[236:239], a[180:183], v[204:207]
  buffer_load_dwordx4 v48, s[16:19], s40 offen lds
  v_mfma_f32_16x16x32_bf16 v[212:215], a[232:235], a[168:171], v[212:215]
  v_mfma_f32_16x16x32_bf16 v[212:215], a[236:239], a[184:187], v[212:215]
  v_mfma_f32_16x16x32_bf16 v[220:223], a[232:235], a[172:175], v[220:223]
  buffer_load_dwordx4 v49, s[16:19], s40 offen offset:1024 lds
  v_mfma_f32_16x16x32_bf16 v[220:223], a[236:239], a[188:191], v[220:223]
  s_waitcnt lgkmcnt(4)
  v_mfma_f32_16x16x32_bf16 v[224:227], a[240:243], a[160:163], v[224:227]
  s_waitcnt vmcnt(14)
  ds_read_b64_tr_b16 a[224:225], v56 offset:32768
  ds_read_b64_tr_b16 a[226:227], v56 offset:34816
  v_mfma_f32_16x16x32_bf16 v[224:227], a[244:247], a[176:179], v[224:227]
  v_mfma_f32_16x16x32_bf16 v[232:235], a[240:243], a[164:167], v[232:235]
  ds_read_b64_tr_b16 a[228:229], v56 offset:36864
  ds_read_b64_tr_b16 a[230:231], v56 offset:38912
  v_mfma_f32_16x16x32_bf16 v[232:235], a[244:247], a[180:183], v[232:235]
  buffer_load_dwordx4 v50, s[16:19], s40 offen offset:2048 lds
  v_mfma_f32_16x16x32_bf16 v[240:243], a[240:243], a[168:171], v[240:243]
  v_mfma_f32_16x16x32_bf16 v[240:243], a[244:247], a[184:187], v[240:243]
  v_mfma_f32_16x16x32_bf16 v[248:251], a[240:243], a[172:175], v[248:251]
  buffer_load_dwordx4 v51, s[16:19], s40 offen offset:3072 lds
  v_mfma_f32_16x16x32_bf16 v[248:251], a[244:247], a[188:191], v[248:251]
  s_waitcnt lgkmcnt(4)
  v_mfma_f32_16x16x32_bf16 v[228:231], a[248:251], a[160:163], v[228:231]
  ds_read_b64_tr_b16 a[232:233], v56 offset:32776
  ds_read_b64_tr_b16 a[234:235], v56 offset:34824
  v_mfma_f32_16x16x32_bf16 v[228:231], a[252:255], a[176:179], v[228:231]
  s_add_u32 m0, s32, 0
  v_mfma_f32_16x16x32_bf16 v[236:239], a[248:251], a[164:167], v[236:239]
  ds_read_b64_tr_b16 a[236:237], v56 offset:36872
  ds_read_b64_tr_b16 a[238:239], v56 offset:38920
  v_mfma_f32_16x16x32_bf16 v[236:239], a[252:255], a[180:183], v[236:239]
  buffer_load_dwordx4 v34, s[8:11], s34 offen lds
  v_mfma_f32_16x16x32_bf16 v[244:247], a[248:251], a[168:171], v[244:247]
  ds_write_b128 v53, v[128:131] offset:32768
  v_mfma_f32_16x16x32_bf16 v[244:247], a[252:255], a[184:187], v[244:247]
  v_mfma_f32_16x16x32_bf16 v[252:255], a[248:251], a[172:175], v[252:255]
  buffer_load_dwordx4 v35, s[8:11], s34 offen offset:1024 lds
  v_mfma_f32_16x16x32_bf16 v[252:255], a[252:255], a[188:191], v[252:255]
  s_waitcnt lgkmcnt(5)
  v_mfma_f32_16x16x32_bf16 v[192:195], a[224:227], a[32:35], v[192:195]
  ds_read_b64_tr_b16 a[240:241], v57 offset:32768
  ds_read_b64_tr_b16 a[242:243], v57 offset:34816
  v_mfma_f32_16x16x32_bf16 v[192:195], a[228:231], a[48:51], v[192:195]
  ds_write_b128 v53, v[136:139] offset:33792
  v_mfma_f32_16x16x32_bf16 v[200:203], a[224:227], a[36:39], v[200:203]
  ds_read_b64_tr_b16 a[244:245], v57 offset:36864
  ds_read_b64_tr_b16 a[246:247], v57 offset:38912
  v_mfma_f32_16x16x32_bf16 v[200:203], a[228:231], a[52:55], v[200:203]
  buffer_load_dwordx4 v36, s[8:11], s34 offen offset:2048 lds
  v_mfma_f32_16x16x32_bf16 v[208:211], a[224:227], a[40:43], v[208:211]
  ds_write_b128 v53, v[144:147] offset:34816
  v_mfma_f32_16x16x32_bf16 v[208:211], a[228:231], a[56:59], v[208:211]
  v_mfma_f32_16x16x32_bf16 v[216:219], a[224:227], a[44:47], v[216:219]
  buffer_load_dwordx4 v37, s[8:11], s34 offen offset:3072 lds
  s_add_u32 m0, s32, 4096
  v_mfma_f32_16x16x32_bf16 v[216:219], a[228:231], a[60:63], v[216:219]
  s_waitcnt lgkmcnt(7)
  v_mfma_f32_16x16x32_bf16 v[196:199], a[232:235], a[32:35], v[196:199]
  ds_read_b64_tr_b16 a[248:249], v57 offset:32776
  ds_read_b64_tr_b16 a[250:251], v57 offset:34824
  v_mfma_f32_16x16x32_bf16 v[196:199], a[236:239], a[48:51], v[196:199]
  ds_write_b128 v53, v[152:155] offset:35840
  v_mfma_f32_16x16x32_bf16 v[204:207], a[232:235], a[36:39], v[204:207]
  ds_read_b64_tr_b16 a[252:253], v57 offset:36872
  ds_read_b64_tr_b16 a[254:255], v57 offset:38920
  v_mfma_f32_16x16x32_bf16 v[204:207], a[236:239], a[52:55], v[204:207]
  buffer_load_dwordx4 v34, s[8:11], s35 offen lds
  v_mfma_f32_16x16x32_bf16 v[212:215], a[232:235], a[40:43], v[212:215]
  ds_write_b128 v53, v[160:163] offset:36864
  v_mfma_f32_16x16x32_bf16 v[212:215], a[236:239], a[56:59], v[212:215]
  v_mfma_f32_16x16x32_bf16 v[220:223], a[232:235], a[44:47], v[220:223]
  buffer_load_dwordx4 v35, s[8:11], s35 offen offset:1024 lds
  v_mfma_f32_16x16x32_bf16 v[220:223], a[236:239], a[60:63], v[220:223]
  s_waitcnt lgkmcnt(7)
  v_mfma_f32_16x16x32_bf16 v[224:227], a[240:243], a[32:35], v[224:227]
  s_waitcnt vmcnt(14)
  ds_read_b64_tr_b16 a[224:225], v58 offset:0
  ds_read_b64_tr_b16 a[226:227], v58 offset:2048
  v_mfma_f32_16x16x32_bf16 v[224:227], a[244:247], a[48:51], v[224:227]
  ds_write_b128 v53, v[168:171] offset:37888
  v_mfma_f32_16x16x32_bf16 v[232:235], a[240:243], a[36:39], v[232:235]
  ds_read_b64_tr_b16 a[228:229], v58 offset:4096
  ds_read_b64_tr_b16 a[230:231], v58 offset:6144
  v_mfma_f32_16x16x32_bf16 v[232:235], a[244:247], a[52:55], v[232:235]
  buffer_load_dwordx4 v36, s[8:11], s35 offen offset:2048 lds
  v_mfma_f32_16x16x32_bf16 v[240:243], a[240:243], a[40:43], v[240:243]
  ds_write_b128 v53, v[176:179] offset:38912
  v_mfma_f32_16x16x32_bf16 v[240:243], a[244:247], a[56:59], v[240:243]
  v_mfma_f32_16x16x32_bf16 v[248:251], a[240:243], a[44:47], v[248:251]
  buffer_load_dwordx4 v37, s[8:11], s35 offen offset:3072 lds
  v_mfma_f32_16x16x32_bf16 v[248:251], a[244:247], a[60:63], v[248:251]
  s_waitcnt lgkmcnt(7)
  v_mfma_f32_16x16x32_bf16 v[228:231], a[248:251], a[32:35], v[228:231]
  ds_read_b64_tr_b16 a[232:233], v58 offset:8
  ds_read_b64_tr_b16 a[234:235], v58 offset:2056
  v_mfma_f32_16x16x32_bf16 v[228:231], a[252:255], a[48:51], v[228:231]
  s_add_u32 m0, s32, 32768
  v_mfma_f32_16x16x32_bf16 v[236:239], a[248:251], a[36:39], v[236:239]
  ds_read_b64_tr_b16 a[236:237], v58 offset:4104
  ds_read_b64_tr_b16 a[238:239], v58 offset:6152
  v_mfma_f32_16x16x32_bf16 v[236:239], a[252:255], a[52:55], v[236:239]
  buffer_load_dwordx4 v34, s[8:11], s36 offen lds
  v_mfma_f32_16x16x32_bf16 v[244:247], a[248:251], a[40:43], v[244:247]
  ds_write_b128 v53, v[184:187] offset:39936
  v_mfma_f32_16x16x32_bf16 v[244:247], a[252:255], a[56:59], v[244:247]
  ds_read_b128 a[0:3], v53 offset:32768
  ds_read_b128 a[4:7], v53 offset:33792
  v_mfma_f32_16x16x32_bf16 v[252:255], a[248:251], a[44:47], v[252:255]
  buffer_load_dwordx4 v35, s[8:11], s36 offen offset:1024 lds
  v_mfma_f32_16x16x32_bf16 v[252:255], a[252:255], a[60:63], v[252:255]
  ds_read_b128 a[8:11], v53 offset:34816
  s_waitcnt lgkmcnt(9)
  v_mfma_f32_16x16x32_bf16 v[192:195], a[224:227], v[96:99], v[192:195]
  ds_read_b64_tr_b16 a[240:241], v59 offset:0
  ds_read_b64_tr_b16 a[242:243], v59 offset:2048
  v_mfma_f32_16x16x32_bf16 v[192:195], a[228:231], v[112:115], v[192:195]
  ds_read_b128 a[12:15], v53 offset:35840
  ds_read_b128 a[16:19], v53 offset:36864
  v_mfma_f32_16x16x32_bf16 v[200:203], a[224:227], v[100:103], v[200:203]
  ds_read_b64_tr_b16 a[244:245], v59 offset:4096
  ds_read_b64_tr_b16 a[246:247], v59 offset:6144
  v_mfma_f32_16x16x32_bf16 v[200:203], a[228:231], v[116:119], v[200:203]
  buffer_load_dwordx4 v36, s[8:11], s36 offen offset:2048 lds
  v_mfma_f32_16x16x32_bf16 v[208:211], a[224:227], v[104:107], v[208:211]
  ds_read_b128 a[20:23], v53 offset:37888
  ds_read_b128 a[24:27], v53 offset:38912
  v_mfma_f32_16x16x32_bf16 v[208:211], a[228:231], v[120:123], v[208:211]
  ds_read_b128 a[28:31], v53 offset:39936
  v_mfma_f32_16x16x32_bf16 v[216:219], a[224:227], v[108:111], v[216:219]
  buffer_load_dwordx4 v37, s[8:11], s36 offen offset:3072 lds
  s_add_u32 m0, s32, 36864
  v_mfma_f32_16x16x32_bf16 v[216:219], a[228:231], v[124:127], v[216:219]
  s_waitcnt lgkmcnt(13)
  v_mfma_f32_16x16x32_bf16 v[196:199], a[232:235], v[96:99], v[196:199]
  ds_read_b64_tr_b16 a[248:249], v59 offset:8
  ds_read_b64_tr_b16 a[250:251], v59 offset:2056
  s_waitcnt vmcnt(4) lgkmcnt(14)
  s_barrier
  v_mfma_f32_16x16x32_bf16 v[196:199], a[236:239], v[112:115], v[196:199]
  ds_read_b128 a[64:67], v55 offset:32768
  ds_read_b128 a[68:71], v55 offset:33792
  v_mfma_f32_16x16x32_bf16 v[204:207], a[232:235], v[100:103], v[204:207]
  ds_read_b64_tr_b16 a[252:253], v59 offset:4104
  ds_read_b64_tr_b16 a[254:255], v59 offset:6152
  v_mfma_f32_16x16x32_bf16 v[204:207], a[236:239], v[116:119], v[204:207]
  buffer_load_dwordx4 v34, s[8:11], s37 offen lds
  v_mfma_f32_16x16x32_bf16 v[212:215], a[232:235], v[104:107], v[212:215]
  ds_read_b128 a[72:75], v55 offset:34816
  ds_read_b128 a[76:79], v55 offset:35840
  v_mfma_f32_16x16x32_bf16 v[212:215], a[236:239], v[120:123], v[212:215]
  ds_read_b128 a[80:83], v55 offset:36864
  ds_read_b128 a[84:87], v55 offset:37888
  v_mfma_f32_16x16x32_bf16 v[220:223], a[232:235], v[108:111], v[220:223]
  buffer_load_dwordx4 v35, s[8:11], s37 offen offset:1024 lds
  v_mfma_f32_16x16x32_bf16 v[220:223], a[236:239], v[124:127], v[220:223]
  ds_read_b128 a[88:91], v55 offset:38912
  s_waitcnt lgkmcnt(14)
  v_mfma_f32_16x16x32_bf16 v[224:227], a[240:243], v[96:99], v[224:227]
  ds_read_b64_tr_b16 a[224:225], v58 offset:32768
  ds_read_b64_tr_b16 a[226:227], v58 offset:34816
  v_mfma_f32_16x16x32_bf16 v[224:227], a[244:247], v[112:115], v[224:227]
  ds_read_b128 a[92:95], v55 offset:39936
  ds_read_b128 a[128:131], v8 offset:0
  v_mfma_f32_16x16x32_bf16 v[232:235], a[240:243], v[100:103], v[232:235]
  ds_read_b64_tr_b16 a[228:229], v58 offset:36864
  ds_read_b64_tr_b16 a[230:231], v58 offset:38912
  v_mfma_f32_16x16x32_bf16 v[232:235], a[244:247], v[116:119], v[232:235]
  buffer_load_dwordx4 v36, s[8:11], s37 offen offset:2048 lds
  v_mfma_f32_16x16x32_bf16 v[240:243], a[240:243], v[104:107], v[240:243]
  ds_read_b128 a[132:135], v9 offset:0
  ds_read_b128 a[144:147], v12 offset:0
  v_mfma_f32_16x16x32_bf16 v[240:243], a[244:247], v[120:123], v[240:243]
  ds_read_b128 a[148:151], v13 offset:0
  ds_read_b128 a[136:139], v10 offset:0
  v_mfma_f32_16x16x32_bf16 v[248:251], a[240:243], v[108:111], v[248:251]
  buffer_load_dwordx4 v37, s[8:11], s37 offen offset:3072 lds
  v_mfma_f32_16x16x32_bf16 v[248:251], a[244:247], v[124:127], v[248:251]
  ds_read_b128 a[140:143], v11 offset:0
  s_waitcnt lgkmcnt(15)
  v_mfma_f32_16x16x32_bf16 v[228:231], a[248:251], v[96:99], v[228:231]
  ds_read_b64_tr_b16 a[232:233], v58 offset:32776
  ds_read_b64_tr_b16 a[234:235], v58 offset:34824
  v_mfma_f32_16x16x32_bf16 v[228:231], a[252:255], v[112:115], v[228:231]
  s_add_u32 m0, s32, 65536
  ds_read_b128 a[152:155], v14 offset:0
  v_mfma_f32_16x16x32_bf16 v[236:239], a[248:251], v[100:103], v[236:239]
  ds_read_b64_tr_b16 a[236:237], v58 offset:36872
  ds_read_b64_tr_b16 a[238:239], v58 offset:38920
  v_mfma_f32_16x16x32_bf16 v[236:239], a[252:255], v[116:119], v[236:239]
  buffer_load_dwordx4 v38, s[12:15], s34 offen lds
  v_mfma_f32_16x16x32_bf16 v[244:247], a[248:251], v[104:107], v[244:247]
  ds_read_b128 a[156:159], v15 offset:0
  ds_read_b128 a[160:163], v8 offset:8192
  v_mfma_f32_16x16x32_bf16 v[244:247], a[252:255], v[120:123], v[244:247]
  ds_read_b128 a[164:167], v9 offset:8192
  ds_read_b128 a[176:179], v12 offset:8192
  v_mfma_f32_16x16x32_bf16 v[252:255], a[248:251], v[108:111], v[252:255]
  buffer_load_dwordx4 v39, s[12:15], s34 offen offset:1024 lds
  v_mfma_f32_16x16x32_bf16 v[252:255], a[252:255], v[124:127], v[252:255]
  ds_read_b128 a[180:183], v13 offset:8192
  s_waitcnt lgkmcnt(15)
  v_mfma_f32_16x16x32_bf16 v[192:195], a[224:227], v[64:67], v[192:195]
  ds_read_b64_tr_b16 a[240:241], v59 offset:32768
  ds_read_b64_tr_b16 a[242:243], v59 offset:34816
  v_mfma_f32_16x16x32_bf16 v[192:195], a[228:231], v[80:83], v[192:195]
  ds_read_b128 a[168:171], v10 offset:8192
  ds_read_b128 a[172:175], v11 offset:8192
  v_mfma_f32_16x16x32_bf16 v[200:203], a[224:227], v[68:71], v[200:203]
  ds_read_b64_tr_b16 a[244:245], v59 offset:36864
  ds_read_b64_tr_b16 a[246:247], v59 offset:38912
  v_mfma_f32_16x16x32_bf16 v[200:203], a[228:231], v[84:87], v[200:203]
  buffer_load_dwordx4 v40, s[12:15], s34 offen offset:2048 lds
  v_mfma_f32_16x16x32_bf16 v[208:211], a[224:227], v[72:75], v[208:211]
  ds_read_b128 a[184:187], v14 offset:8192
  ds_read_b128 a[188:191], v15 offset:8192
  v_mfma_f32_16x16x32_bf16 v[208:211], a[228:231], v[88:91], v[208:211]
  v_mfma_f32_16x16x32_bf16 v[216:219], a[224:227], v[76:79], v[216:219]
  buffer_load_dwordx4 v41, s[12:15], s34 offen offset:3072 lds
  s_add_u32 m0, s32, 69632
  v_mfma_f32_16x16x32_bf16 v[216:219], a[228:231], v[92:95], v[216:219]
  s_waitcnt lgkmcnt(13)
  v_mfma_f32_16x16x32_bf16 v[196:199], a[232:235], v[64:67], v[196:199]
  ds_read_b64_tr_b16 a[248:249], v59 offset:32776
  ds_read_b64_tr_b16 a[250:251], v59 offset:34824
  v_mfma_f32_16x16x32_bf16 v[196:199], a[236:239], v[80:83], v[196:199]
  v_mfma_f32_16x16x32_bf16 v[204:207], a[232:235], v[68:71], v[204:207]
  ds_read_b64_tr_b16 a[252:253], v59 offset:36872
  ds_read_b64_tr_b16 a[254:255], v59 offset:38920
  v_mfma_f32_16x16x32_bf16 v[204:207], a[236:239], v[84:87], v[204:207]
  buffer_load_dwordx4 v38, s[12:15], s35 offen lds
  v_mfma_f32_16x16x32_bf16 v[212:215], a[232:235], v[72:75], v[212:215]
  v_mfma_f32_16x16x32_bf16 v[212:215], a[236:239], v[88:91], v[212:215]
  v_mfma_f32_16x16x32_bf16 v[220:223], a[232:235], v[76:79], v[220:223]
  buffer_load_dwordx4 v39, s[12:15], s35 offen offset:1024 lds
  v_cvt_pk_bf16_f32 v192, v192, v193
  v_mfma_f32_16x16x32_bf16 v[220:223], a[236:239], v[92:95], v[220:223]
  v_cvt_pk_bf16_f32 v193, v194, v195
  v_cvt_pk_bf16_f32 v194, v196, v197
  s_waitcnt lgkmcnt(6)
  v_mfma_f32_16x16x32_bf16 v[224:227], a[240:243], v[64:67], v[224:227]
  v_cvt_pk_bf16_f32 v195, v198, v199
  v_cvt_pk_bf16_f32 v200, v200, v201
  v_cvt_pk_bf16_f32 v201, v202, v203
  v_mfma_f32_16x16x32_bf16 v[224:227], a[244:247], v[80:83], v[224:227]
  v_cvt_pk_bf16_f32 v202, v204, v205
  v_cvt_pk_bf16_f32 v203, v206, v207
  v_mfma_f32_16x16x32_bf16 v[232:235], a[240:243], v[68:71], v[232:235]
  buffer_load_dwordx4 v40, s[12:15], s35 offen offset:2048 lds
  v_cvt_pk_bf16_f32 v208, v208, v209
  v_mfma_f32_16x16x32_bf16 v[232:235], a[244:247], v[84:87], v[232:235]
  v_cvt_pk_bf16_f32 v209, v210, v211
  v_cvt_pk_bf16_f32 v210, v212, v213
  v_cvt_pk_bf16_f32 v211, v214, v215
  v_mfma_f32_16x16x32_bf16 v[240:243], a[240:243], v[72:75], v[240:243]
  v_cvt_pk_bf16_f32 v216, v216, v217
  v_cvt_pk_bf16_f32 v217, v218, v219
  v_cvt_pk_bf16_f32 v218, v220, v221
  v_mfma_f32_16x16x32_bf16 v[240:243], a[244:247], v[88:91], v[240:243]
  v_cvt_pk_bf16_f32 v219, v222, v223
  v_mfma_f32_16x16x32_bf16 v[248:251], a[240:243], v[76:79], v[248:251]
  buffer_load_dwordx4 v41, s[12:15], s35 offen offset:3072 lds
  v_mfma_f32_16x16x32_bf16 v[248:251], a[244:247], v[92:95], v[248:251]
  s_waitcnt lgkmcnt(0)
  v_mfma_f32_16x16x32_bf16 v[228:231], a[248:251], v[64:67], v[228:231]
  v_mfma_f32_16x16x32_bf16 v[228:231], a[252:255], v[80:83], v[228:231]
  ds_write_b128 v53, v[192:195] offset:0
  v_mfma_f32_16x16x32_bf16 v[236:239], a[248:251], v[68:71], v[236:239]
  ds_write_b128 v53, v[200:203] offset:1024
  v_mfma_f32_16x16x32_bf16 v[236:239], a[252:255], v[84:87], v[236:239]
  ds_write_b128 v53, v[208:211] offset:2048
  v_mfma_f32_16x16x32_bf16 v[244:247], a[248:251], v[72:75], v[244:247]
  ds_write_b128 v53, v[216:219] offset:3072
  v_mfma_f32_16x16x32_bf16 v[244:247], a[252:255], v[88:91], v[244:247]
  v_mfma_f32_16x16x32_bf16 v[252:255], a[248:251], v[76:79], v[252:255]
  v_cvt_pk_bf16_f32 v224, v224, v225
  v_cvt_pk_bf16_f32 v225, v226, v227
  v_cvt_pk_bf16_f32 v226, v228, v229
  v_mfma_f32_16x16x32_bf16 v[252:255], a[252:255], v[92:95], v[252:255]
  v_cvt_pk_bf16_f32 v227, v230, v231
  v_mfma_f32_16x16x32_bf16 v[64:67], a[128:131], a[0:3], 0
  ds_write_b128 v53, v[224:227] offset:4096
  v_cvt_pk_bf16_f32 v232, v232, v233
  v_mfma_f32_16x16x32_bf16 v[64:67], a[132:135], a[16:19], v[64:67]
  v_cvt_pk_bf16_f32 v233, v234, v235
  v_cvt_pk_bf16_f32 v234, v236, v237
  v_cvt_pk_bf16_f32 v235, v238, v239
  v_mfma_f32_16x16x32_bf16 v[68:71], a[128:131], a[4:7], 0
  ds_write_b128 v53, v[232:235] offset:5120
  v_cvt_pk_bf16_f32 v240, v240, v241
  v_mfma_f32_16x16x32_bf16 v[68:71], a[132:135], a[20:23], v[68:71]
  v_cvt_pk_bf16_f32 v241, v242, v243
  v_cvt_pk_bf16_f32 v242, v244, v245
  v_cvt_pk_bf16_f32 v243, v246, v247
  v_mfma_f32_16x16x32_bf16 v[72:75], a[128:131], a[8:11], 0
  ds_write_b128 v53, v[240:243] offset:6144
  v_cvt_pk_bf16_f32 v248, v248, v249
  v_mfma_f32_16x16x32_bf16 v[72:75], a[132:135], a[24:27], v[72:75]
  v_cvt_pk_bf16_f32 v249, v250, v251
  v_cvt_pk_bf16_f32 v250, v252, v253
  v_cvt_pk_bf16_f32 v251, v254, v255
  v_mfma_f32_16x16x32_bf16 v[76:79], a[128:131], a[12:15], 0
  ds_write_b128 v53, v[248:251] offset:7168
  v_mfma_f32_16x16x32_bf16 v[76:79], a[132:135], a[28:31], v[76:79]
  v_mfma_f32_16x16x32_bf16 v[64:67], a[144:147], a[64:67], v[64:67]
  v_mfma_f32_16x16x32_bf16 v[64:67], a[148:151], a[80:83], v[64:67]
  s_waitcnt lgkmcnt(0)
  s_barrier
  v_mfma_f32_16x16x32_bf16 v[68:71], a[144:147], a[68:71], v[68:71]
  ds_read_b128 a[96:99], v55 offset:0
  ds_read_b128 a[100:103], v55 offset:1024
  v_mfma_f32_16x16x32_bf16 v[68:71], a[148:151], a[84:87], v[68:71]
  ds_read_b128 a[104:107], v55 offset:2048
  ds_read_b128 a[108:111], v55 offset:3072
  v_mfma_f32_16x16x32_bf16 v[72:75], a[144:147], a[72:75], v[72:75]
  ds_read_b128 a[112:115], v55 offset:4096
  ds_read_b128 a[116:119], v55 offset:5120
  v_mfma_f32_16x16x32_bf16 v[72:75], a[148:151], a[88:91], v[72:75]
  ds_read_b128 a[120:123], v55 offset:6144
  ds_read_b128 a[124:127], v55 offset:7168
  v_mfma_f32_16x16x32_bf16 v[76:79], a[144:147], a[76:79], v[76:79]
  ds_read_b128 a[32:35], v53 offset:0
  ds_read_b128 a[36:39], v53 offset:1024
  v_mfma_f32_16x16x32_bf16 v[76:79], a[148:151], a[92:95], v[76:79]
  ds_read_b128 a[40:43], v53 offset:2048
  ds_read_b128 a[44:47], v53 offset:3072
  v_mfma_f32_16x16x32_bf16 v[64:67], a[136:139], v[192:195], v[64:67]
  ds_read_b128 a[48:51], v53 offset:4096
  ds_read_b128 a[52:55], v53 offset:5120
  v_mfma_f32_16x16x32_bf16 v[64:67], a[140:143], v[224:227], v[64:67]
  ds_read_b128 a[56:59], v53 offset:6144
  ds_read_b128 a[60:63], v53 offset:7168
  v_mfma_f32_16x16x32_bf16 v[68:71], a[136:139], v[200:203], v[68:71]
  v_mfma_f32_16x16x32_bf16 v[68:71], a[140:143], v[232:235], v[68:71]
  v_mfma_f32_16x16x32_bf16 v[72:75], a[136:139], v[208:211], v[72:75]
  v_mfma_f32_16x16x32_bf16 v[72:75], a[140:143], v[240:243], v[72:75]
  v_mfma_f32_16x16x32_bf16 v[76:79], a[136:139], v[216:219], v[76:79]
  v_mfma_f32_16x16x32_bf16 v[76:79], a[140:143], v[248:251], v[76:79]
  s_waitcnt lgkmcnt(8)
  v_mfma_f32_16x16x32_bf16 v[64:67], a[152:155], a[96:99], v[64:67]
  v_mfma_f32_16x16x32_bf16 v[64:67], a[156:159], a[112:115], v[64:67]
  v_mfma_f32_16x16x32_bf16 v[68:71], a[152:155], a[100:103], v[68:71]
  v_mfma_f32_16x16x32_bf16 v[68:71], a[156:159], a[116:119], v[68:71]
  v_mfma_f32_16x16x32_bf16 v[72:75], a[152:155], a[104:107], v[72:75]
  v_mfma_f32_16x16x32_bf16 v[72:75], a[156:159], a[120:123], v[72:75]
  v_mfma_f32_16x16x32_bf16 v[76:79], a[152:155], a[108:111], v[76:79]
  s_nop 2
  v_max3_f32 v4, v64, v65, v66
  v_max_f32 v4, v4, v67
  v_mfma_f32_16x16x32_bf16 v[76:79], a[156:159], a[124:127], v[76:79]
  v_mfma_f32_16x16x32_bf16 v[80:83], a[160:163], a[0:3], 0
  v_max3_f32 v5, v68, v69, v70
  v_max_f32 v5, v5, v71
  v_mfma_f32_16x16x32_bf16 v[80:83], a[164:167], a[16:19], v[80:83]
  v_mfma_f32_16x16x32_bf16 v[84:87], a[160:163], a[4:7], 0
  v_max3_f32 v6, v72, v73, v74
  v_max_f32 v6, v6, v75
  v_mfma_f32_16x16x32_bf16 v[84:87], a[164:167], a[20:23], v[84:87]
  v_mfma_f32_16x16x32_bf16 v[88:91], a[160:163], a[8:11], 0
  v_max3_f32 v7, v76, v77, v78
  v_max_f32 v7, v7, v79
  s_nop 0
  v_mfma_f32_16x16x32_bf16 v[88:91], a[164:167], a[24:27], v[88:91]
  v_permlane16_swap_b32 v4, v5
  v_permlane16_swap_b32 v6, v7
  v_max_f32 v4, v4, v5
  v_mfma_f32_16x16x32_bf16 v[92:95], a[160:163], a[12:15], 0
  v_max_f32 v6, v6, v7
  s_nop 1
  v_permlane32_swap_b32 v4, v6
  v_mfma_f32_16x16x32_bf16 v[92:95], a[164:167], a[28:31], v[92:95]
  v_max_f32 v4, v4, v6
  ds_write_b32 v1, v4
  v_mfma_f32_16x16x32_bf16 v[80:83], a[176:179], a[64:67], v[80:83]
  s_waitcnt vmcnt(8) lgkmcnt(0)
  s_barrier
K1_J:
  ds_read_b128 v[112:115], v3
  v_mfma_f32_16x16x32_bf16 v[80:83], a[180:183], a[80:83], v[80:83]
  ds_read_b128 v[116:119], v47
  ds_read_b128 a[128:131], v8 offset:32768
  v_mfma_f32_16x16x32_bf16 v[84:87], a[176:179], a[68:71], v[84:87]
  ds_read_b128 a[132:135], v9 offset:32768
  ds_read_b128 a[136:139], v10 offset:32768
  v_mfma_f32_16x16x32_bf16 v[84:87], a[180:183], a[84:87], v[84:87]
  ds_read_b128 a[140:143], v11 offset:32768
  ds_read_b128 a[144:147], v12 offset:32768
  v_mfma_f32_16x16x32_bf16 v[88:91], a[176:179], a[72:75], v[88:91]
  ds_read_b128 a[148:151], v13 offset:32768
  ds_read_b128 a[152:155], v14 offset:32768
  v_mfma_f32_16x16x32_bf16 v[88:91], a[180:183], a[88:91], v[88:91]
  ds_read_b128 a[156:159], v15 offset:32768
  v_mov_b32 v4, 0
  v_mfma_f32_16x16x32_bf16 v[92:95], a[176:179], a[76:79], v[92:95]
  v_mov_b32 v5, 0
  v_mov_b32 v6, 0
  v_mov_b32 v7, 0
  v_mfma_f32_16x16x32_bf16 v[92:95], a[180:183], a[92:95], v[92:95]
  s_waitcnt lgkmcnt(8)
  v_min_f32 v48, -v112, -v116
  v_mfma_f32_16x16x32_bf16 v[80:83], a[168:171], a[32:35], v[80:83]
  v_min_f32 v49, -v112, -v116
  v_pk_add_f32 v[64:65], v[64:65], v[48:49]
  v_pk_add_f32 v[66:67], v[66:67], v[48:49]
  v_mfma_f32_16x16x32_bf16 v[80:83], a[172:175], a[48:51], v[80:83]
  v_exp_f32 v64, v64
  v_min_f32 v52, -v113, -v117
  v_mfma_f32_16x16x32_bf16 v[84:87], a[168:171], a[36:39], v[84:87]
  s_add_u32 s34, s34, 65536
  v_exp_f32 v65, v65
  v_mfma_f32_16x16x32_bf16 v[84:87], a[172:175], a[52:55], v[84:87]
  v_min_f32 v53, -v113, -v117
  v_add_f32 v4, v4, v64
  v_mfma_f32_16x16x32_bf16 v[88:91], a[168:171], a[40:43], v[88:91]
  v_exp_f32 v66, v66
  v_pk_add_f32 v[68:69], v[68:69], v[52:53]
  v_mfma_f32_16x16x32_bf16 v[88:91], a[172:175], a[56:59], v[88:91]
  v_add_f32 v4, v4, v65
  v_cvt_pk_bf16_f32 v96, v64, v65
  s_and_b32 s34, s34, 0xfffff
  v_mfma_f32_16x16x32_bf16 v[92:95], a[168:171], a[44:47], v[92:95]
  v_exp_f32 v67, v67
  v_pk_add_f32 v[70:71], v[70:71], v[52:53]
  v_mfma_f32_16x16x32_bf16 v[92:95], a[172:175], a[60:63], v[92:95]
  v_add_f32 v4, v4, v66
  v_mfma_f32_16x16x32_bf16 v[80:83], a[184:187], a[96:99], v[80:83]
  v_exp_f32 v68, v68
  v_min_f32 v56, -v114, -v118
  v_mfma_f32_16x16x32_bf16 v[80:83], a[188:191], a[112:115], v[80:83]
  v_add_f32 v4, v4, v67
  v_cvt_pk_bf16_f32 v97, v66, v67
  s_add_u32 m0, s32, 0
  v_mfma_f32_16x16x32_bf16 v[84:87], a[184:187], a[100:103], v[84:87]
  v_exp_f32 v69, v69
  v_min_f32 v57, -v114, -v118
  v_mfma_f32_16x16x32_bf16 v[84:87], a[188:191], a[116:119], v[84:87]
  v_add_f32 v5, v5, v68
  v_exp_f32 v70, v70
  v_mfma_f32_16x16x32_bf16 v[88:91], a[184:187], a[104:107], v[88:91]
  v_pk_add_f32 v[72:73], v[72:73], v[56:57]
  v_add_f32 v5, v5, v69
  v_cvt_pk_bf16_f32 v100, v68, v69
  v_mfma_f32_16x16x32_bf16 v[88:91], a[188:191], a[120:123], v[88:91]
  s_add_u32 s35, s34, 4096
  v_exp_f32 v71, v71
  v_mfma_f32_16x16x32_bf16 v[92:95], a[184:187], a[108:111], v[92:95]
  v_pk_add_f32 v[74:75], v[74:75], v[56:57]
  v_add_f32 v5, v5, v70
  v_mfma_f32_16x16x32_bf16 v[92:95], a[188:191], a[124:127], v[92:95]
  v_exp_f32 v72, v72
  v_min_f32 v60, -v115, -v119
  v_add_f32 v5, v5, v71
  v_cvt_pk_bf16_f32 v101, v70, v71
  buffer_load_dwordx4 v34, s[8:11], s34 offen lds
  v_exp_f32 v73, v73
  v_min_f32 v61, -v115, -v119
  v_add_f32 v6, v6, v72
  v_exp_f32 v74, v74
  v_pk_add_f32 v[76:77], v[76:77], v[60:61]
  v_add_f32 v6, v6, v73
  v_cvt_pk_bf16_f32 v104, v72, v73
  buffer_load_dwordx4 v35, s[8:11], s34 offen offset:1024 lds
  v_exp_f32 v75, v75
  v_pk_add_f32 v[78:79], v[78:79], v[60:61]
  v_add_f32 v6, v6, v74
  v_exp_f32 v76, v76
  v_pk_add_f32 v[80:81], v[80:81], v[48:49]
  v_add_f32 v6, v6, v75
  v_cvt_pk_bf16_f32 v105, v74, v75
  buffer_load_dwordx4 v36, s[8:11], s34 offen offset:2048 lds
  v_exp_f32 v77, v77
  v_pk_add_f32 v[82:83], v[82:83], v[48:49]
  v_pk_add_f32 v[84:85], v[84:85], v[52:53]
  v_add_f32 v7, v7, v76
  v_exp_f32 v78, v78
  v_pk_add_f32 v[86:87], v[86:87], v[52:53]
  v_pk_add_f32 v[88:89], v[88:89], v[56:57]
  v_add_f32 v7, v7, v77
  v_cvt_pk_bf16_f32 v108, v76, v77
  buffer_load_dwordx4 v37, s[8:11], s34 offen offset:3072 lds
  v_exp_f32 v79, v79
  v_pk_add_f32 v[90:91], v[90:91], v[56:57]
  v_pk_add_f32 v[92:93], v[92:93], v[60:61]
  v_add_f32 v7, v7, v78
  v_exp_f32 v80, v80
  v_pk_add_f32 v[94:95], v[94:95], v[60:61]
  v_min_f32 v50, -v112, -v116
  v_add_f32 v7, v7, v79
  v_cvt_pk_bf16_f32 v109, v78, v79
  s_add_u32 m0, s32, 4096
  v_exp_f32 v81, v81
  v_min_f32 v51, -v112, -v116
  v_min_f32 v54, -v113, -v117
  v_add_f32 v4, v4, v80
  v_exp_f32 v82, v82
  v_min_f32 v55, -v113, -v117
  v_min_f32 v58, -v114, -v118
  v_add_f32 v4, v4, v81
  v_cvt_pk_bf16_f32 v98, v80, v81
  buffer_load_dwordx4 v34, s[8:11], s35 offen lds
  v_exp_f32 v83, v83
  v_min_f32 v59, -v114, -v118
  v_min_f32 v62, -v115, -v119
  v_add_f32 v4, v4, v82
  v_exp_f32 v84, v84
  v_min_f32 v63, -v115, -v119
  v_add_f32 v4, v4, v83
  v_cvt_pk_bf16_f32 v99, v82, v83
  v_exp_f32 v85, v85
  v_add_f32 v5, v5, v84
  ds_write_b64 v32, v[96:97] offset:0
  v_exp_f32 v86, v86
  v_add_f32 v5, v5, v85
  v_cvt_pk_bf16_f32 v102, v84, v85
  v_exp_f32 v87, v87
  v_add_f32 v5, v5, v86
  ds_write_b64 v32, v[98:99] offset:512
  v_exp_f32 v88, v88
  v_add_f32 v5, v5, v87
  v_cvt_pk_bf16_f32 v103, v86, v87
  v_exp_f32 v89, v89
  v_add_f32 v6, v6, v88
  v_exp_f32 v90, v90
  v_add_f32 v6, v6, v89
  v_cvt_pk_bf16_f32 v106, v88, v89
  ds_write_b64 v32, v[100:101] offset:1024
  v_exp_f32 v91, v91
  v_add_f32 v6, v6, v90
  ds_write_b64 v32, v[102:103] offset:1536
  v_exp_f32 v92, v92
  v_add_f32 v6, v6, v91
  v_cvt_pk_bf16_f32 v107, v90, v91
  ds_write_b64 v32, v[104:105] offset:2048
  s_nop 0
  v_add_f32 v7, v7, v92
  ds_write_b64 v32, v[106:107] offset:2560
  s_waitcnt lgkmcnt(0)
  s_waitcnt lgkmcnt(4)
  v_mfma_f32_16x16x32_bf16 v[64:67], a[128:131], a[0:3], v[48:51]
  v_exp_f32 v93, v93
  v_mfma_f32_16x16x32_bf16 v[64:67], a[132:135], a[16:19], v[64:67]
  v_add_f32 v7, v7, v93
  v_cvt_pk_bf16_f32 v110, v92, v93
  v_mfma_f32_16x16x32_bf16 v[64:67], a[136:139], a[32:35], v[64:67]
  ds_read_b128 a[160:163], v8 offset:40960
  ds_read_b128 a[164:167], v9 offset:40960
  v_mfma_f32_16x16x32_bf16 v[64:67], a[140:143], a[48:51], v[64:67]
  buffer_load_dwordx4 v35, s[8:11], s35 offen offset:1024 lds
  v_mfma_f32_16x16x32_bf16 v[64:67], a[144:147], a[64:67], v[64:67]
  v_exp_f32 v94, v94
  v_mfma_f32_16x16x32_bf16 v[64:67], a[148:151], a[80:83], v[64:67]
  v_add_f32 v7, v7, v94
  v_mfma_f32_16x16x32_bf16 v[64:67], a[152:155], a[96:99], v[64:67]
  ds_read_b128 a[168:171], v10 offset:40960
  ds_read_b128 a[172:175], v11 offset:40960
  v_mfma_f32_16x16x32_bf16 v[64:67], a[156:159], a[112:115], v[64:67]
  ds_write_b64 v32, v[108:109] offset:3072
  v_mfma_f32_16x16x32_bf16 v[68:71], a[128:131], a[4:7], v[52:55]
  v_exp_f32 v95, v95
  v_mfma_f32_16x16x32_bf16 v[68:71], a[132:135], a[20:23], v[68:71]
  v_add_f32 v7, v7, v95
  v_cvt_pk_bf16_f32 v111, v94, v95
  v_mfma_f32_16x16x32_bf16 v[68:71], a[136:139], a[36:39], v[68:71]
  ds_read_b128 a[176:179], v12 offset:40960
  ds_read_b128 a[180:183], v13 offset:40960
  v_mfma_f32_16x16x32_bf16 v[68:71], a[140:143], a[52:55], v[68:71]
  buffer_load_dwordx4 v36, s[8:11], s35 offen offset:2048 lds
  v_mfma_f32_16x16x32_bf16 v[68:71], a[144:147], a[68:71], v[68:71]
  v_exp_f32 v64, v64
  v_mfma_f32_16x16x32_bf16 v[68:71], a[148:151], a[84:87], v[68:71]
  v_add_f32 v4, v4, v64
  v_mfma_f32_16x16x32_bf16 v[68:71], a[152:155], a[100:103], v[68:71]
  ds_read_b128 a[184:187], v14 offset:40960
  ds_read_b128 a[188:191], v15 offset:40960
  v_mfma_f32_16x16x32_bf16 v[68:71], a[156:159], a[116:119], v[68:71]
  ds_write_b64 v32, v[110:111] offset:3584
  v_mfma_f32_16x16x32_bf16 v[72:75], a[128:131], a[8:11], v[56:59]
  v_exp_f32 v65, v65
  v_mfma_f32_16x16x32_bf16 v[72:75], a[132:135], a[24:27], v[72:75]
  v_add_f32 v4, v4, v65
  v_cvt_pk_bf16_f32 v112, v64, v65
  v_mfma_f32_16x16x32_bf16 v[72:75], a[136:139], a[40:43], v[72:75]
  v_mfma_f32_16x16x32_bf16 v[72:75], a[140:143], a[56:59], v[72:75]
  buffer_load_dwordx4 v37, s[8:11], s35 offen offset:3072 lds
  v_mfma_f32_16x16x32_bf16 v[72:75], a[144:147], a[72:75], v[72:75]
  v_exp_f32 v66, v66
  v_mfma_f32_16x16x32_bf16 v[72:75], a[148:151], a[88:91], v[72:75]
  v_add_f32 v4, v4, v66
  s_add_u32 m0, s32, 98304
  v_mfma_f32_16x16x32_bf16 v[72:75], a[152:155], a[104:107], v[72:75]
  v_mfma_f32_16x16x32_bf16 v[72:75], a[156:159], a[120:123], v[72:75]
  s_waitcnt vmcnt(8) lgkmcnt(0)
  s_barrier
  v_mfma_f32_16x16x32_bf16 v[76:79], a[128:131], a[12:15], v[60:63]
  v_exp_f32 v67, v67
  v_mfma_f32_16x16x32_bf16 v[76:79], a[132:135], a[28:31], v[76:79]
  v_add_f32 v4, v4, v67
  v_cvt_pk_bf16_f32 v113, v66, v67
  s_lshl2_add_u32 s40, s6, s3
  v_mfma_f32_16x16x32_bf16 v[76:79], a[136:139], a[44:47], v[76:79]
  ds_read2st64_b64 a[192:195], v33 offset0:0 offset1:1
  v_mfma_f32_16x16x32_bf16 v[76:79], a[140:143], a[60:63], v[76:79]
  buffer_load_dwordx4 v38, s[12:15], s36 offen lds
  s_mul_i32 s40, s40, 3584
  v_mfma_f32_16x16x32_bf16 v[76:79], a[144:147], a[76:79], v[76:79]
  v_exp_f32 v68, v68
  v_mfma_f32_16x16x32_bf16 v[76:79], a[148:151], a[92:95], v[76:79]
  v_add_f32 v5, v5, v68
  s_mul_i32 s41, s4, 458752
  v_mfma_f32_16x16x32_bf16 v[76:79], a[152:155], a[108:111], v[76:79]
  ds_read2st64_b64 a[196:199], v33 offset0:2 offset1:3
  v_mfma_f32_16x16x32_bf16 v[76:79], a[156:159], a[124:127], v[76:79]
  s_add_u32 s40, s40, s41
  v_mfma_f32_16x16x32_bf16 v[80:83], a[160:163], a[0:3], v[48:51]
  v_exp_f32 v69, v69
  v_mfma_f32_16x16x32_bf16 v[80:83], a[164:167], a[16:19], v[80:83]
  v_add_f32 v5, v5, v69
  v_cvt_pk_bf16_f32 v116, v68, v69
  v_lshlrev_b32 v1, 6, v2
  v_min_u32 v1, 3520, v1
  v_mfma_f32_16x16x32_bf16 v[80:83], a[168:171], a[32:35], v[80:83]
  ds_read_b64_tr_b16 a[128:129], v16 offset:0
  ds_read_b64_tr_b16 a[130:131], v16 offset:8192
  v_mfma_f32_16x16x32_bf16 v[80:83], a[172:175], a[48:51], v[80:83]
  buffer_load_dwordx4 v39, s[12:15], s36 offen offset:1024 lds
  s_mov_b32 s80, s54
  s_and_b32 s81, s55, 0xffff
  s_mov_b32 s82, 3670016
  s_mov_b32 s83, 0x20000
  v_mfma_f32_16x16x32_bf16 v[80:83], a[176:179], a[64:67], v[80:83]
  v_exp_f32 v70, v70
  v_mfma_f32_16x16x32_bf16 v[80:83], a[180:183], a[80:83], v[80:83]
  v_add_f32 v5, v5, v70
  buffer_load_dword v47, v1, s[80:83], s40 offen
  v_mfma_f32_16x16x32_bf16 v[80:83], a[184:187], a[96:99], v[80:83]
  ds_read_b64_tr_b16 a[132:133], v24 offset:0
  ds_read_b64_tr_b16 a[134:135], v24 offset:8192
  v_mfma_f32_16x16x32_bf16 v[80:83], a[188:191], a[112:115], v[80:83]
  ds_read2st64_b64 a[200:203], v33 offset0:4 offset1:5
  s_lshl2_add_u32 s40, s2, s3
  v_mfma_f32_16x16x32_bf16 v[84:87], a[160:163], a[4:7], v[52:55]
  v_exp_f32 v71, v71
  v_mfma_f32_16x16x32_bf16 v[84:87], a[164:167], a[20:23], v[84:87]
  v_add_f32 v5, v5, v71
  v_cvt_pk_bf16_f32 v117, v70, v71
  s_mul_i32 s40, s40, 1600
  v_mfma_f32_16x16x32_bf16 v[84:87], a[168:171], a[36:39], v[84:87]
  ds_read_b64_tr_b16 a[136:137], v17 offset:0
  ds_read_b64_tr_b16 a[138:139], v17 offset:8192
  v_mfma_f32_16x16x32_bf16 v[84:87], a[172:175], a[52:55], v[84:87]
  buffer_load_dwordx4 v40, s[12:15], s36 offen offset:2048 lds
  v_min_u32 v1, 1536, v1
  v_mfma_f32_16x16x32_bf16 v[84:87], a[176:179], a[68:71], v[84:87]
  v_exp_f32 v72, v72
  v_mfma_f32_16x16x32_bf16 v[84:87], a[180:183], a[84:87], v[84:87]
  v_add_f32 v6, v6, v72
  v_add_u32 v1, s40, v1
  v_mfma_f32_16x16x32_bf16 v[84:87], a[184:187], a[100:103], v[84:87]
  ds_read_b64_tr_b16 a[140:141], v25 offset:0
  ds_read_b64_tr_b16 a[142:143], v25 offset:8192
  v_mfma_f32_16x16x32_bf16 v[84:87], a[188:191], a[116:119], v[84:87]
  ds_read2st64_b64 a[204:207], v33 offset0:6 offset1:7
  s_mov_b32 s80, s96
  s_and_b32 s81, s97, 0xffff
  s_mov_b32 s82, 1605632
  s_mov_b32 s83, 0x20000
  v_mfma_f32_16x16x32_bf16 v[88:91], a[160:163], a[8:11], v[56:59]
  v_exp_f32 v73, v73
  v_mfma_f32_16x16x32_bf16 v[88:91], a[164:167], a[24:27], v[88:91]
  v_add_f32 v6, v6, v73
  v_cvt_pk_bf16_f32 v120, v72, v73
  buffer_load_dword v47, v1, s[80:83], 0 offen
  v_mfma_f32_16x16x32_bf16 v[88:91], a[168:171], a[40:43], v[88:91]
  ds_read_b64_tr_b16 a[144:145], v18 offset:0
  ds_read_b64_tr_b16 a[146:147], v18 offset:8192
  v_mfma_f32_16x16x32_bf16 v[88:91], a[172:175], a[56:59], v[88:91]
  buffer_load_dwordx4 v41, s[12:15], s36 offen offset:3072 lds
  s_mov_b32 s80, s98
  s_and_b32 s81, s99, 0xffff
  s_mov_b32 s82, 1605632
  s_mov_b32 s83, 0x20000
  v_mfma_f32_16x16x32_bf16 v[88:91], a[176:179], a[72:75], v[88:91]
  v_exp_f32 v74, v74
  v_mfma_f32_16x16x32_bf16 v[88:91], a[180:183], a[88:91], v[88:91]
  v_add_f32 v6, v6, v74
  s_add_u32 m0, s32, 102400
  buffer_load_dword v47, v1, s[80:83], 0 offen
  v_mfma_f32_16x16x32_bf16 v[88:91], a[184:187], a[104:107], v[88:91]
  ds_read_b64_tr_b16 a[148:149], v26 offset:0
  ds_read_b64_tr_b16 a[150:151], v26 offset:8192
  v_mfma_f32_16x16x32_bf16 v[88:91], a[188:191], a[120:123], v[88:91]
  s_add_u32 s36, s36, 65536
  s_and_b32 s36, s36, 0xfffff
  s_mov_b32 s80, s100
  s_and_b32 s81, s101, 0xffff
  s_mov_b32 s82, 1605632
  s_mov_b32 s83, 0x20000
  v_mfma_f32_16x16x32_bf16 v[92:95], a[160:163], a[12:15], v[60:63]
  v_exp_f32 v75, v75
  v_mfma_f32_16x16x32_bf16 v[92:95], a[164:167], a[28:31], v[92:95]
  v_add_f32 v6, v6, v75
  v_cvt_pk_bf16_f32 v121, v74, v75
  buffer_load_dword v47, v1, s[80:83], 0 offen
  v_mfma_f32_16x16x32_bf16 v[92:95], a[168:171], a[44:47], v[92:95]
  ds_read_b64_tr_b16 a[152:153], v19 offset:0
  ds_read_b64_tr_b16 a[154:155], v19 offset:8192
  v_mfma_f32_16x16x32_bf16 v[92:95], a[172:175], a[60:63], v[92:95]
  buffer_load_dwordx4 v38, s[12:15], s37 offen lds
  v_mfma_f32_16x16x32_bf16 v[92:95], a[176:179], a[76:79], v[92:95]
  v_exp_f32 v76, v76
  v_mfma_f32_16x16x32_bf16 v[92:95], a[180:183], a[92:95], v[92:95]
  v_add_f32 v7, v7, v76
  v_mfma_f32_16x16x32_bf16 v[92:95], a[184:187], a[108:111], v[92:95]
  ds_read_b64_tr_b16 a[156:157], v27 offset:0
  ds_read_b64_tr_b16 a[158:159], v27 offset:8192
  v_mfma_f32_16x16x32_bf16 v[92:95], a[188:191], a[124:127], v[92:95]
  s_waitcnt lgkmcnt(8)
  v_mfma_f32_16x16x32_bf16 v[128:131], a[128:131], v[96:99], 0
  v_exp_f32 v77, v77
  v_mfma_f32_16x16x32_bf16 v[128:131], a[132:135], a[192:195], v[128:131]
  v_add_f32 v7, v7, v77
  v_cvt_pk_bf16_f32 v124, v76, v77
  v_mfma_f32_16x16x32_bf16 v[132:135], a[128:131], v[100:103], 0
  ds_read_b64_tr_b16 a[160:161], v20 offset:0
  ds_read_b64_tr_b16 a[162:163], v20 offset:8192
  v_mfma_f32_16x16x32_bf16 v[132:135], a[132:135], a[196:199], v[132:135]
  buffer_load_dwordx4 v39, s[12:15], s37 offen offset:1024 lds
  v_mfma_f32_16x16x32_bf16 v[136:139], a[128:131], v[104:107], 0
  v_exp_f32 v78, v78
  v_mfma_f32_16x16x32_bf16 v[136:139], a[132:135], a[200:203], v[136:139]
  v_add_f32 v7, v7, v78
  v_mfma_f32_16x16x32_bf16 v[140:143], a[128:131], v[108:111], 0
  ds_read_b64_tr_b16 a[164:165], v28 offset:0
  ds_read_b64_tr_b16 a[166:167], v28 offset:8192
  v_mfma_f32_16x16x32_bf16 v[140:143], a[132:135], a[204:207], v[140:143]
  v_mfma_f32_16x16x32_bf16 v[144:147], a[136:139], v[96:99], 0
  v_exp_f32 v79, v79
  v_mfma_f32_16x16x32_bf16 v[144:147], a[140:143], a[192:195], v[144:147]
  v_add_f32 v7, v7, v79
  v_cvt_pk_bf16_f32 v125, v78, v79
  v_mfma_f32_16x16x32_bf16 v[148:151], a[136:139], v[100:103], 0
  ds_read_b64_tr_b16 a[168:169], v21 offset:0
  ds_read_b64_tr_b16 a[170:171], v21 offset:8192
  v_mfma_f32_16x16x32_bf16 v[148:151], a[140:143], a[196:199], v[148:151]
  buffer_load_dwordx4 v40, s[12:15], s37 offen offset:2048 lds
  v_mfma_f32_16x16x32_bf16 v[152:155], a[136:139], v[104:107], 0
  v_exp_f32 v80, v80
  v_mfma_f32_16x16x32_bf16 v[152:155], a[140:143], a[200:203], v[152:155]
  v_add_f32 v4, v4, v80
  v_mfma_f32_16x16x32_bf16 v[156:159], a[136:139], v[108:111], 0
  ds_read_b64_tr_b16 a[172:173], v29 offset:0
  ds_read_b64_tr_b16 a[174:175], v29 offset:8192
  v_mfma_f32_16x16x32_bf16 v[156:159], a[140:143], a[204:207], v[156:159]
  s_waitcnt lgkmcnt(12)
  v_mfma_f32_16x16x32_bf16 v[160:163], a[144:147], v[96:99], 0
  v_exp_f32 v81, v81
  v_mfma_f32_16x16x32_bf16 v[160:163], a[148:151], a[192:195], v[160:163]
  v_add_f32 v4, v4, v81
  v_cvt_pk_bf16_f32 v114, v80, v81
  v_mfma_f32_16x16x32_bf16 v[164:167], a[144:147], v[100:103], 0
  ds_read_b64_tr_b16 a[176:177], v22 offset:0
  ds_read_b64_tr_b16 a[178:179], v22 offset:8192
  v_mfma_f32_16x16x32_bf16 v[164:167], a[148:151], a[196:199], v[164:167]
  buffer_load_dwordx4 v41, s[12:15], s37 offen offset:3072 lds
  v_mfma_f32_16x16x32_bf16 v[168:171], a[144:147], v[104:107], 0
  v_exp_f32 v82, v82
  s_add_u32 m0, s32, 32768
  v_mfma_f32_16x16x32_bf16 v[168:171], a[148:151], a[200:203], v[168:171]
  v_add_f32 v4, v4, v82
  s_add_u32 s37, s36, 4096
  v_mfma_f32_16x16x32_bf16 v[172:175], a[144:147], v[108:111], 0
  ds_read_b64_tr_b16 a[180:181], v30 offset:0
  ds_read_b64_tr_b16 a[182:183], v30 offset:8192
  v_mfma_f32_16x16x32_bf16 v[172:175], a[148:151], a[204:207], v[172:175]
  s_waitcnt vmcnt(12) lgkmcnt(12)
  s_barrier
  v_mfma_f32_16x16x32_bf16 v[176:179], a[152:155], v[96:99], 0
  v_exp_f32 v83, v83
  v_mfma_f32_16x16x32_bf16 v[176:179], a[156:159], a[192:195], v[176:179]
  v_add_f32 v4, v4, v83
  v_cvt_pk_bf16_f32 v115, v82, v83
  v_mfma_f32_16x16x32_bf16 v[180:183], a[152:155], v[100:103], 0
  ds_read_b64_tr_b16 a[184:185], v23 offset:0
  ds_read_b64_tr_b16 a[186:187], v23 offset:8192
  v_mfma_f32_16x16x32_bf16 v[180:183], a[156:159], a[196:199], v[180:183]
  buffer_load_dwordx4 v34, s[8:11], s36 offen lds
  v_mfma_f32_16x16x32_bf16 v[184:187], a[152:155], v[104:107], 0
  v_exp_f32 v84, v84
  v_mfma_f32_16x16x32_bf16 v[184:187], a[156:159], a[200:203], v[184:187]
  v_add_f32 v5, v5, v84
  v_mfma_f32_16x16x32_bf16 v[188:191], a[152:155], v[108:111], 0
  ds_read_b64_tr_b16 a[188:189], v31 offset:0
  ds_read_b64_tr_b16 a[190:191], v31 offset:8192
  v_mfma_f32_16x16x32_bf16 v[188:191], a[156:159], a[204:207], v[188:191]
  ds_write_b64 v32, v[112:113] offset:0
  s_waitcnt lgkmcnt(9)
  v_mfma_f32_16x16x32_bf16 v[192:195], a[160:163], v[96:99], 0
  v_exp_f32 v85, v85
  v_mfma_f32_16x16x32_bf16 v[192:195], a[164:167], a[192:195], v[192:195]
  v_add_f32 v5, v5, v85
  v_cvt_pk_bf16_f32 v118, v84, v85
  v_mfma_f32_16x16x32_bf16 v[196:199], a[160:163], v[100:103], 0
  ds_read_b128 a[128:131], v8 offset:0
  ds_read_b128 a[132:135], v9 offset:0
  v_mfma_f32_16x16x32_bf16 v[196:199], a[164:167], a[196:199], v[196:199]
  buffer_load_dwordx4 v35, s[8:11], s36 offen offset:1024 lds
  v_mfma_f32_16x16x32_bf16 v[200:203], a[160:163], v[104:107], 0
  v_exp_f32 v86, v86
  v_mfma_f32_16x16x32_bf16 v[200:203], a[164:167], a[200:203], v[200:203]
  v_add_f32 v5, v5, v86
  v_mfma_f32_16x16x32_bf16 v[204:207], a[160:163], v[108:111], 0
  ds_read_b128 a[136:139], v10 offset:0
  ds_read_b128 a[140:143], v11 offset:0
  v_mfma_f32_16x16x32_bf16 v[204:207], a[164:167], a[204:207], v[204:207]
  ds_write_b64 v32, v[114:115] offset:512
  v_mfma_f32_16x16x32_bf16 v[208:211], a[168:171], v[96:99], 0
  v_exp_f32 v87, v87
  v_mfma_f32_16x16x32_bf16 v[208:211], a[172:175], a[192:195], v[208:211]
  v_add_f32 v5, v5, v87
  v_cvt_pk_bf16_f32 v119, v86, v87
  v_mfma_f32_16x16x32_bf16 v[212:215], a[168:171], v[100:103], 0
  ds_read_b128 a[144:147], v12 offset:0
  ds_read_b128 a[148:151], v13 offset:0
  v_mfma_f32_16x16x32_bf16 v[212:215], a[172:175], a[196:199], v[212:215]
  buffer_load_dwordx4 v36, s[8:11], s36 offen offset:2048 lds
  v_mfma_f32_16x16x32_bf16 v[216:219], a[168:171], v[104:107], 0
  v_exp_f32 v88, v88
  v_mfma_f32_16x16x32_bf16 v[216:219], a[172:175], a[200:203], v[216:219]
  v_add_f32 v6, v6, v88
  v_mfma_f32_16x16x32_bf16 v[220:223], a[168:171], v[108:111], 0
  ds_read_b128 a[152:155], v14 offset:0
  ds_read_b128 a[156:159], v15 offset:0
  v_mfma_f32_16x16x32_bf16 v[220:223], a[172:175], a[204:207], v[220:223]
  s_waitcnt lgkmcnt(10)
  v_mfma_f32_16x16x32_bf16 v[224:227], a[176:179], v[96:99], 0
  v_exp_f32 v89, v89
  v_mfma_f32_16x16x32_bf16 v[224:227], a[180:183], a[192:195], v[224:227]
  v_add_f32 v6, v6, v89
  v_cvt_pk_bf16_f32 v122, v88, v89
  v_mfma_f32_16x16x32_bf16 v[228:231], a[176:179], v[100:103], 0
  ds_write_b64 v32, v[116:117] offset:1024
  v_mfma_f32_16x16x32_bf16 v[228:231], a[180:183], a[196:199], v[228:231]
  buffer_load_dwordx4 v37, s[8:11], s36 offen offset:3072 lds
  v_mfma_f32_16x16x32_bf16 v[232:235], a[176:179], v[104:107], 0
  v_exp_f32 v90, v90
  v_mfma_f32_16x16x32_bf16 v[232:235], a[180:183], a[200:203], v[232:235]
  v_add_f32 v6, v6, v90
  s_add_u32 m0, s32, 36864
  v_mfma_f32_16x16x32_bf16 v[236:239], a[176:179], v[108:111], 0
  ds_write_b64 v32, v[118:119] offset:1536
  v_mfma_f32_16x16x32_bf16 v[236:239], a[180:183], a[204:207], v[236:239]
  v_mfma_f32_16x16x32_bf16 v[240:243], a[184:187], v[96:99], 0
  v_exp_f32 v91, v91
  v_mfma_f32_16x16x32_bf16 v[240:243], a[188:191], a[192:195], v[240:243]
  v_add_f32 v6, v6, v91
  v_cvt_pk_bf16_f32 v123, v90, v91
  v_mfma_f32_16x16x32_bf16 v[244:247], a[184:187], v[100:103], 0
  ds_write_b64 v32, v[120:121] offset:2048
  v_mfma_f32_16x16x32_bf16 v[244:247], a[188:191], a[196:199], v[244:247]
  buffer_load_dwordx4 v34, s[8:11], s37 offen lds
  v_mfma_f32_16x16x32_bf16 v[248:251], a[184:187], v[104:107], 0
  v_exp_f32 v92, v92
  v_mfma_f32_16x16x32_bf16 v[248:251], a[188:191], a[200:203], v[248:251]
  v_add_f32 v7, v7, v92
  v_mfma_f32_16x16x32_bf16 v[252:255], a[184:187], v[108:111], 0
  ds_write_b64 v32, v[122:123] offset:2560
  v_mfma_f32_16x16x32_bf16 v[252:255], a[188:191], a[204:207], v[252:255]
  s_mov_b32 s33, 14
  .p2align 3
K1_LOOP:
  s_waitcnt lgkmcnt(4)
  v_mfma_f32_16x16x32_bf16 v[64:67], a[128:131], a[0:3], v[48:51]
  v_exp_f32 v93, v93
  v_mfma_f32_16x16x32_bf16 v[64:67], a[132:135], a[16:19], v[64:67]
  v_add_f32 v7, v7, v93
  v_cvt_pk_bf16_f32 v126, v92, v93
  v_mfma_f32_16x16x32_bf16 v[64:67], a[136:139], a[32:35], v[64:67]
  ds_read_b128 a[160:163], v8 offset:8192
  ds_read_b128 a[164:167], v9 offset:8192
  v_mfma_f32_16x16x32_bf16 v[64:67], a[140:143], a[48:51], v[64:67]
  buffer_load_dwordx4 v35, s[8:11], s37 offen offset:1024 lds
  v_mfma_f32_16x16x32_bf16 v[64:67], a[144:147], a[64:67], v[64:67]
  v_exp_f32 v94, v94
  v_mfma_f32_16x16x32_bf16 v[64:67], a[148:151], a[80:83], v[64:67]
  v_add_f32 v7, v7, v94
  v_mfma_f32_16x16x32_bf16 v[64:67], a[152:155], a[96:99], v[64:67]
  ds_read_b128 a[168:171], v10 offset:8192
  ds_read_b128 a[172:175], v11 offset:8192
  v_mfma_f32_16x16x32_bf16 v[64:67], a[156:159], a[112:115], v[64:67]
  ds_write_b64 v32, v[124:125] offset:3072
  v_mfma_f32_16x16x32_bf16 v[68:71], a[128:131], a[4:7], v[52:55]
  v_exp_f32 v95, v95
  v_mfma_f32_16x16x32_bf16 v[68:71], a[132:135], a[20:23], v[68:71]
  v_add_f32 v7, v7, v95
  v_cvt_pk_bf16_f32 v127, v94, v95
  v_mfma_f32_16x16x32_bf16 v[68:71], a[136:139], a[36:39], v[68:71]
  ds_read_b128 a[176:179], v12 offset:8192
  ds_read_b128 a[180:183], v13 offset:8192
  v_mfma_f32_16x16x32_bf16 v[68:71], a[140:143], a[52:55], v[68:71]
  buffer_load_dwordx4 v36, s[8:11], s37 offen offset:2048 lds
  v_mfma_f32_16x16x32_bf16 v[68:71], a[144:147], a[68:71], v[68:71]
  v_exp_f32 v64, v64
  v_mfma_f32_16x16x32_bf16 v[68:71], a[148:151], a[84:87], v[68:71]
  v_add_f32 v4, v4, v64
  v_mfma_f32_16x16x32_bf16 v[68:71], a[152:155], a[100:103], v[68:71]
  ds_read_b128 a[184:187], v14 offset:8192
  ds_read_b128 a[188:191], v15 offset:8192
  v_mfma_f32_16x16x32_bf16 v[68:71], a[156:159], a[116:119], v[68:71]
  ds_write_b64 v32, v[126:127] offset:3584
  v_mfma_f32_16x16x32_bf16 v[72:75], a[128:131], a[8:11], v[56:59]
  v_exp_f32 v65, v65
  v_mfma_f32_16x16x32_bf16 v[72:75], a[132:135], a[24:27], v[72:75]
  v_add_f32 v4, v4, v65
  v_cvt_pk_bf16_f32 v96, v64, v65
  v_mfma_f32_16x16x32_bf16 v[72:75], a[136:139], a[40:43], v[72:75]
  v_mfma_f32_16x16x32_bf16 v[72:75], a[140:143], a[56:59], v[72:75]
  buffer_load_dwordx4 v37, s[8:11], s37 offen offset:3072 lds
  v_mfma_f32_16x16x32_bf16 v[72:75], a[144:147], a[72:75], v[72:75]
  v_exp_f32 v66, v66
  v_mfma_f32_16x16x32_bf16 v[72:75], a[148:151], a[88:91], v[72:75]
  v_add_f32 v4, v4, v66
  s_add_u32 m0, s32, 65536
  v_mfma_f32_16x16x32_bf16 v[72:75], a[152:155], a[104:107], v[72:75]
  v_mfma_f32_16x16x32_bf16 v[72:75], a[156:159], a[120:123], v[72:75]
  s_waitcnt vmcnt(8) lgkmcnt(0)
  s_barrier
  v_mfma_f32_16x16x32_bf16 v[76:79], a[128:131], a[12:15], v[60:63]
  v_exp_f32 v67, v67
  v_mfma_f32_16x16x32_bf16 v[76:79], a[132:135], a[28:31], v[76:79]
  v_add_f32 v4, v4, v67
  v_cvt_pk_bf16_f32 v97, v66, v67
  v_mfma_f32_16x16x32_bf16 v[76:79], a[136:139], a[44:47], v[76:79]
  ds_read2st64_b64 a[192:195], v33 offset0:0 offset1:1
  v_mfma_f32_16x16x32_bf16 v[76:79], a[140:143], a[60:63], v[76:79]
  buffer_load_dwordx4 v38, s[12:15], s34 offen lds
  v_mfma_f32_16x16x32_bf16 v[76:79], a[144:147], a[76:79], v[76:79]
  v_exp_f32 v68, v68
  v_mfma_f32_16x16x32_bf16 v[76:79], a[148:151], a[92:95], v[76:79]
  v_add_f32 v5, v5, v68
  v_mfma_f32_16x16x32_bf16 v[76:79], a[152:155], a[108:111], v[76:79]
  ds_read2st64_b64 a[196:199], v33 offset0:2 offset1:3
  v_mfma_f32_16x16x32_bf16 v[76:79], a[156:159], a[124:127], v[76:79]
  v_mfma_f32_16x16x32_bf16 v[80:83], a[160:163], a[0:3], v[48:51]
  v_exp_f32 v69, v69
  v_mfma_f32_16x16x32_bf16 v[80:83], a[164:167], a[16:19], v[80:83]
  v_add_f32 v5, v5, v69
  v_cvt_pk_bf16_f32 v100, v68, v69
  v_mfma_f32_16x16x32_bf16 v[80:83], a[168:171], a[32:35], v[80:83]
  ds_read_b64_tr_b16 a[128:129], v16 offset:32768
  ds_read_b64_tr_b16 a[130:131], v16 offset:40960
  v_mfma_f32_16x16x32_bf16 v[80:83], a[172:175], a[48:51], v[80:83]
  buffer_load_dwordx4 v39, s[12:15], s34 offen offset:1024 lds
  v_mfma_f32_16x16x32_bf16 v[80:83], a[176:179], a[64:67], v[80:83]
  v_exp_f32 v70, v70
  v_mfma_f32_16x16x32_bf16 v[80:83], a[180:183], a[80:83], v[80:83]
  v_add_f32 v5, v5, v70
  v_mfma_f32_16x16x32_bf16 v[80:83], a[184:187], a[96:99], v[80:83]
  ds_read_b64_tr_b16 a[132:133], v24 offset:32768
  ds_read_b64_tr_b16 a[134:135], v24 offset:40960
  v_mfma_f32_16x16x32_bf16 v[80:83], a[188:191], a[112:115], v[80:83]
  ds_read2st64_b64 a[200:203], v33 offset0:4 offset1:5
  v_mfma_f32_16x16x32_bf16 v[84:87], a[160:163], a[4:7], v[52:55]
  v_exp_f32 v71, v71
  v_mfma_f32_16x16x32_bf16 v[84:87], a[164:167], a[20:23], v[84:87]
  v_add_f32 v5, v5, v71
  v_cvt_pk_bf16_f32 v101, v70, v71
  v_mfma_f32_16x16x32_bf16 v[84:87], a[168:171], a[36:39], v[84:87]
  ds_read_b64_tr_b16 a[136:137], v17 offset:32768
  ds_read_b64_tr_b16 a[138:139], v17 offset:40960
  v_mfma_f32_16x16x32_bf16 v[84:87], a[172:175], a[52:55], v[84:87]
  buffer_load_dwordx4 v40, s[12:15], s34 offen offset:2048 lds
  v_mfma_f32_16x16x32_bf16 v[84:87], a[176:179], a[68:71], v[84:87]
  v_exp_f32 v72, v72
  v_mfma_f32_16x16x32_bf16 v[84:87], a[180:183], a[84:87], v[84:87]
  v_add_f32 v6, v6, v72
  v_mfma_f32_16x16x32_bf16 v[84:87], a[184:187], a[100:103], v[84:87]
  ds_read_b64_tr_b16 a[140:141], v25 offset:32768
  ds_read_b64_tr_b16 a[142:143], v25 offset:40960
  v_mfma_f32_16x16x32_bf16 v[84:87], a[188:191], a[116:119], v[84:87]
  ds_read2st64_b64 a[204:207], v33 offset0:6 offset1:7
  v_mfma_f32_16x16x32_bf16 v[88:91], a[160:163], a[8:11], v[56:59]
  v_exp_f32 v73, v73
  v_mfma_f32_16x16x32_bf16 v[88:91], a[164:167], a[24:27], v[88:91]
  v_add_f32 v6, v6, v73
  v_cvt_pk_bf16_f32 v104, v72, v73
  v_mfma_f32_16x16x32_bf16 v[88:91], a[168:171], a[40:43], v[88:91]
  ds_read_b64_tr_b16 a[144:145], v18 offset:32768
  ds_read_b64_tr_b16 a[146:147], v18 offset:40960
  v_mfma_f32_16x16x32_bf16 v[88:91], a[172:175], a[56:59], v[88:91]
  buffer_load_dwordx4 v41, s[12:15], s34 offen offset:3072 lds
  v_mfma_f32_16x16x32_bf16 v[88:91], a[176:179], a[72:75], v[88:91]
  v_exp_f32 v74, v74
  v_mfma_f32_16x16x32_bf16 v[88:91], a[180:183], a[88:91], v[88:91]
  v_add_f32 v6, v6, v74
  s_add_u32 m0, s32, 69632
  v_mfma_f32_16x16x32_bf16 v[88:91], a[184:187], a[104:107], v[88:91]
  ds_read_b64_tr_b16 a[148:149], v26 offset:32768
  ds_read_b64_tr_b16 a[150:151], v26 offset:40960
  v_mfma_f32_16x16x32_bf16 v[88:91], a[188:191], a[120:123], v[88:91]
  s_add_u32 s34, s34, 65536
  s_and_b32 s34, s34, 0xfffff
  v_mfma_f32_16x16x32_bf16 v[92:95], a[160:163], a[12:15], v[60:63]
  v_exp_f32 v75, v75
  v_mfma_f32_16x16x32_bf16 v[92:95], a[164:167], a[28:31], v[92:95]
  v_add_f32 v6, v6, v75
  v_cvt_pk_bf16_f32 v105, v74, v75
  v_mfma_f32_16x16x32_bf16 v[92:95], a[168:171], a[44:47], v[92:95]
  ds_read_b64_tr_b16 a[152:153], v19 offset:32768
  ds_read_b64_tr_b16 a[154:155], v19 offset:40960
  v_mfma_f32_16x16x32_bf16 v[92:95], a[172:175], a[60:63], v[92:95]
  buffer_load_dwordx4 v38, s[12:15], s35 offen lds
  v_mfma_f32_16x16x32_bf16 v[92:95], a[176:179], a[76:79], v[92:95]
  v_exp_f32 v76, v76
  v_mfma_f32_16x16x32_bf16 v[92:95], a[180:183], a[92:95], v[92:95]
  v_add_f32 v7, v7, v76
  v_mfma_f32_16x16x32_bf16 v[92:95], a[184:187], a[108:111], v[92:95]
  ds_read_b64_tr_b16 a[156:157], v27 offset:32768
  ds_read_b64_tr_b16 a[158:159], v27 offset:40960
  v_mfma_f32_16x16x32_bf16 v[92:95], a[188:191], a[124:127], v[92:95]
  s_waitcnt lgkmcnt(8)
  v_mfma_f32_16x16x32_bf16 v[128:131], a[128:131], v[112:115], v[128:131]
  v_exp_f32 v77, v77
  v_mfma_f32_16x16x32_bf16 v[128:131], a[132:135], a[192:195], v[128:131]
  v_add_f32 v7, v7, v77
  v_cvt_pk_bf16_f32 v108, v76, v77
  v_mfma_f32_16x16x32_bf16 v[132:135], a[128:131], v[116:119], v[132:135]
  ds_read_b64_tr_b16 a[160:161], v20 offset:32768
  ds_read_b64_tr_b16 a[162:163], v20 offset:40960
  v_mfma_f32_16x16x32_bf16 v[132:135], a[132:135], a[196:199], v[132:135]
  buffer_load_dwordx4 v39, s[12:15], s35 offen offset:1024 lds
  v_mfma_f32_16x16x32_bf16 v[136:139], a[128:131], v[120:123], v[136:139]
  v_exp_f32 v78, v78
  v_mfma_f32_16x16x32_bf16 v[136:139], a[132:135], a[200:203], v[136:139]
  v_add_f32 v7, v7, v78
  v_mfma_f32_16x16x32_bf16 v[140:143], a[128:131], v[124:127], v[140:143]
  ds_read_b64_tr_b16 a[164:165], v28 offset:32768
  ds_read_b64_tr_b16 a[166:167], v28 offset:40960
  v_mfma_f32_16x16x32_bf16 v[140:143], a[132:135], a[204:207], v[140:143]
  v_mfma_f32_16x16x32_bf16 v[144:147], a[136:139], v[112:115], v[144:147]
  v_exp_f32 v79, v79
  v_mfma_f32_16x16x32_bf16 v[144:147], a[140:143], a[192:195], v[144:147]
  v_add_f32 v7, v7, v79
  v_cvt_pk_bf16_f32 v109, v78, v79
  v_mfma_f32_16x16x32_bf16 v[148:151], a[136:139], v[116:119], v[148:151]
  ds_read_b64_tr_b16 a[168:169], v21 offset:32768
  ds_read_b64_tr_b16 a[170:171], v21 offset:40960
  v_mfma_f32_16x16x32_bf16 v[148:151], a[140:143], a[196:199], v[148:151]
  buffer_load_dwordx4 v40, s[12:15], s35 offen offset:2048 lds
  v_mfma_f32_16x16x32_bf16 v[152:155], a[136:139], v[120:123], v[152:155]
  v_exp_f32 v80, v80
  v_mfma_f32_16x16x32_bf16 v[152:155], a[140:143], a[200:203], v[152:155]
  v_add_f32 v4, v4, v80
  v_mfma_f32_16x16x32_bf16 v[156:159], a[136:139], v[124:127], v[156:159]
  ds_read_b64_tr_b16 a[172:173], v29 offset:32768
  ds_read_b64_tr_b16 a[174:175], v29 offset:40960
  v_mfma_f32_16x16x32_bf16 v[156:159], a[140:143], a[204:207], v[156:159]
  s_waitcnt lgkmcnt(12)
  v_mfma_f32_16x16x32_bf16 v[160:163], a[144:147], v[112:115], v[160:163]
  v_exp_f32 v81, v81
  v_mfma_f32_16x16x32_bf16 v[160:163], a[148:151], a[192:195], v[160:163]
  v_add_f32 v4, v4, v81
  v_cvt_pk_bf16_f32 v98, v80, v81
  v_mfma_f32_16x16x32_bf16 v[164:167], a[144:147], v[116:119], v[164:167]
  ds_read_b64_tr_b16 a[176:177], v22 offset:32768
  ds_read_b64_tr_b16 a[178:179], v22 offset:40960
  v_mfma_f32_16x16x32_bf16 v[164:167], a[148:151], a[196:199], v[164:167]
  buffer_load_dwordx4 v41, s[12:15], s35 offen offset:3072 lds
  v_mfma_f32_16x16x32_bf16 v[168:171], a[144:147], v[120:123], v[168:171]
  v_exp_f32 v82, v82
  s_add_u32 m0, s32, 0
  v_mfma_f32_16x16x32_bf16 v[168:171], a[148:151], a[200:203], v[168:171]
  v_add_f32 v4, v4, v82
  s_add_u32 s35, s34, 4096
  v_mfma_f32_16x16x32_bf16 v[172:175], a[144:147], v[124:127], v[172:175]
  ds_read_b64_tr_b16 a[180:181], v30 offset:32768
  ds_read_b64_tr_b16 a[182:183], v30 offset:40960
  v_mfma_f32_16x16x32_bf16 v[172:175], a[148:151], a[204:207], v[172:175]
  s_waitcnt vmcnt(8) lgkmcnt(12)
  s_barrier
  v_mfma_f32_16x16x32_bf16 v[176:179], a[152:155], v[112:115], v[176:179]
  v_exp_f32 v83, v83
  v_mfma_f32_16x16x32_bf16 v[176:179], a[156:159], a[192:195], v[176:179]
  v_add_f32 v4, v4, v83
  v_cvt_pk_bf16_f32 v99, v82, v83
  v_mfma_f32_16x16x32_bf16 v[180:183], a[152:155], v[116:119], v[180:183]
  ds_read_b64_tr_b16 a[184:185], v23 offset:32768
  ds_read_b64_tr_b16 a[186:187], v23 offset:40960
  v_mfma_f32_16x16x32_bf16 v[180:183], a[156:159], a[196:199], v[180:183]
  buffer_load_dwordx4 v34, s[8:11], s34 offen lds
  v_mfma_f32_16x16x32_bf16 v[184:187], a[152:155], v[120:123], v[184:187]
  v_exp_f32 v84, v84
  v_mfma_f32_16x16x32_bf16 v[184:187], a[156:159], a[200:203], v[184:187]
  v_add_f32 v5, v5, v84
  v_mfma_f32_16x16x32_bf16 v[188:191], a[152:155], v[124:127], v[188:191]
  ds_read_b64_tr_b16 a[188:189], v31 offset:32768
  ds_read_b64_tr_b16 a[190:191], v31 offset:40960
  v_mfma_f32_16x16x32_bf16 v[188:191], a[156:159], a[204:207], v[188:191]
  ds_write_b64 v32, v[96:97] offset:0
  s_waitcnt lgkmcnt(9)
  v_mfma_f32_16x16x32_bf16 v[192:195], a[160:163], v[112:115], v[192:195]
  v_exp_f32 v85, v85
  v_mfma_f32_16x16x32_bf16 v[192:195], a[164:167], a[192:195], v[192:195]
  v_add_f32 v5, v5, v85
  v_cvt_pk_bf16_f32 v102, v84, v85
  v_mfma_f32_16x16x32_bf16 v[196:199], a[160:163], v[116:119], v[196:199]
  ds_read_b128 a[128:131], v8 offset:32768
  ds_read_b128 a[132:135], v9 offset:32768
  v_mfma_f32_16x16x32_bf16 v[196:199], a[164:167], a[196:199], v[196:199]
  buffer_load_dwordx4 v35, s[8:11], s34 offen offset:1024 lds
  v_mfma_f32_16x16x32_bf16 v[200:203], a[160:163], v[120:123], v[200:203]
  v_exp_f32 v86, v86
  v_mfma_f32_16x16x32_bf16 v[200:203], a[164:167], a[200:203], v[200:203]
  v_add_f32 v5, v5, v86
  v_mfma_f32_16x16x32_bf16 v[204:207], a[160:163], v[124:127], v[204:207]
  ds_read_b128 a[136:139], v10 offset:32768
  ds_read_b128 a[140:143], v11 offset:32768
  v_mfma_f32_16x16x32_bf16 v[204:207], a[164:167], a[204:207], v[204:207]
  ds_write_b64 v32, v[98:99] offset:512
  v_mfma_f32_16x16x32_bf16 v[208:211], a[168:171], v[112:115], v[208:211]
  v_exp_f32 v87, v87
  v_mfma_f32_16x16x32_bf16 v[208:211], a[172:175], a[192:195], v[208:211]
  v_add_f32 v5, v5, v87
  v_cvt_pk_bf16_f32 v103, v86, v87
  v_mfma_f32_16x16x32_bf16 v[212:215], a[168:171], v[116:119], v[212:215]
  ds_read_b128 a[144:147], v12 offset:32768
  ds_read_b128 a[148:151], v13 offset:32768
  v_mfma_f32_16x16x32_bf16 v[212:215], a[172:175], a[196:199], v[212:215]
  buffer_load_dwordx4 v36, s[8:11], s34 offen offset:2048 lds
  v_mfma_f32_16x16x32_bf16 v[216:219], a[168:171], v[120:123], v[216:219]
  v_exp_f32 v88, v88
  v_mfma_f32_16x16x32_bf16 v[216:219], a[172:175], a[200:203], v[216:219]
  v_add_f32 v6, v6, v88
  v_mfma_f32_16x16x32_bf16 v[220:223], a[168:171], v[124:127], v[220:223]
  ds_read_b128 a[152:155], v14 offset:32768
  ds_read_b128 a[156:159], v15 offset:32768
  v_mfma_f32_16x16x32_bf16 v[220:223], a[172:175], a[204:207], v[220:223]
  s_waitcnt lgkmcnt(10)
  v_mfma_f32_16x16x32_bf16 v[224:227], a[176:179], v[112:115], v[224:227]
  v_exp_f32 v89, v89
  v_mfma_f32_16x16x32_bf16 v[224:227], a[180:183], a[192:195], v[224:227]
  v_add_f32 v6, v6, v89
  v_cvt_pk_bf16_f32 v106, v88, v89
  v_mfma_f32_16x16x32_bf16 v[228:231], a[176:179], v[116:119], v[228:231]
  ds_write_b64 v32, v[100:101] offset:1024
  v_mfma_f32_16x16x32_bf16 v[228:231], a[180:183], a[196:199], v[228:231]
  buffer_load_dwordx4 v37, s[8:11], s34 offen offset:3072 lds
  v_mfma_f32_16x16x32_bf16 v[232:235], a[176:179], v[120:123], v[232:235]
  v_exp_f32 v90, v90
  v_mfma_f32_16x16x32_bf16 v[232:235], a[180:183], a[200:203], v[232:235]
  v_add_f32 v6, v6, v90
  s_add_u32 m0, s32, 4096
  v_mfma_f32_16x16x32_bf16 v[236:239], a[176:179], v[124:127], v[236:239]
  ds_write_b64 v32, v[102:103] offset:1536
  v_mfma_f32_16x16x32_bf16 v[236:239], a[180:183], a[204:207], v[236:239]
  v_mfma_f32_16x16x32_bf16 v[240:243], a[184:187], v[112:115], v[240:243]
  v_exp_f32 v91, v91
  v_mfma_f32_16x16x32_bf16 v[240:243], a[188:191], a[192:195], v[240:243]
  v_add_f32 v6, v6, v91
  v_cvt_pk_bf16_f32 v107, v90, v91
  v_mfma_f32_16x16x32_bf16 v[244:247], a[184:187], v[116:119], v[244:247]
  ds_write_b64 v32, v[104:105] offset:2048
  v_mfma_f32_16x16x32_bf16 v[244:247], a[188:191], a[196:199], v[244:247]
  buffer_load_dwordx4 v34, s[8:11], s35 offen lds
  v_mfma_f32_16x16x32_bf16 v[248:251], a[184:187], v[120:123], v[248:251]
  v_exp_f32 v92, v92
  v_mfma_f32_16x16x32_bf16 v[248:251], a[188:191], a[200:203], v[248:251]
  v_add_f32 v7, v7, v92
  v_mfma_f32_16x16x32_bf16 v[252:255], a[184:187], v[124:127], v[252:255]
  ds_write_b64 v32, v[106:107] offset:2560
  v_mfma_f32_16x16x32_bf16 v[252:255], a[188:191], a[204:207], v[252:255]
  s_waitcnt lgkmcnt(4)
  v_mfma_f32_16x16x32_bf16 v[64:67], a[128:131], a[0:3], v[48:51]
  v_exp_f32 v93, v93
  v_mfma_f32_16x16x32_bf16 v[64:67], a[132:135], a[16:19], v[64:67]
  v_add_f32 v7, v7, v93
  v_cvt_pk_bf16_f32 v110, v92, v93
  v_mfma_f32_16x16x32_bf16 v[64:67], a[136:139], a[32:35], v[64:67]
  ds_read_b128 a[160:163], v8 offset:40960
  ds_read_b128 a[164:167], v9 offset:40960
  v_mfma_f32_16x16x32_bf16 v[64:67], a[140:143], a[48:51], v[64:67]
  buffer_load_dwordx4 v35, s[8:11], s35 offen offset:1024 lds
  v_mfma_f32_16x16x32_bf16 v[64:67], a[144:147], a[64:67], v[64:67]
  v_exp_f32 v94, v94
  v_mfma_f32_16x16x32_bf16 v[64:67], a[148:151], a[80:83], v[64:67]
  v_add_f32 v7, v7, v94
  v_mfma_f32_16x16x32_bf16 v[64:67], a[152:155], a[96:99], v[64:67]
  ds_read_b128 a[168:171], v10 offset:40960
  ds_read_b128 a[172:175], v11 offset:40960
  v_mfma_f32_16x16x32_bf16 v[64:67], a[156:159], a[112:115], v[64:67]
  ds_write_b64 v32, v[108:109] offset:3072
  v_mfma_f32_16x16x32_bf16 v[68:71], a[128:131], a[4:7], v[52:55]
  v_exp_f32 v95, v95
  v_mfma_f32_16x16x32_bf16 v[68:71], a[132:135], a[20:23], v[68:71]
  v_add_f32 v7, v7, v95
  v_cvt_pk_bf16_f32 v111, v94, v95
  v_mfma_f32_16x16x32_bf16 v[68:71], a[136:139], a[36:39], v[68:71]
  ds_read_b128 a[176:179], v12 offset:40960
  ds_read_b128 a[180:183], v13 offset:40960
  v_mfma_f32_16x16x32_bf16 v[68:71], a[140:143], a[52:55], v[68:71]
  buffer_load_dwordx4 v36, s[8:11], s35 offen offset:2048 lds
  v_mfma_f32_16x16x32_bf16 v[68:71], a[144:147], a[68:71], v[68:71]
  v_exp_f32 v64, v64
  v_mfma_f32_16x16x32_bf16 v[68:71], a[148:151], a[84:87], v[68:71]
  v_add_f32 v4, v4, v64
  v_mfma_f32_16x16x32_bf16 v[68:71], a[152:155], a[100:103], v[68:71]
  ds_read_b128 a[184:187], v14 offset:40960
  ds_read_b128 a[188:191], v15 offset:40960
  v_mfma_f32_16x16x32_bf16 v[68:71], a[156:159], a[116:119], v[68:71]
  ds_write_b64 v32, v[110:111] offset:3584
  v_mfma_f32_16x16x32_bf16 v[72:75], a[128:131], a[8:11], v[56:59]
  v_exp_f32 v65, v65
  v_mfma_f32_16x16x32_bf16 v[72:75], a[132:135], a[24:27], v[72:75]
  v_add_f32 v4, v4, v65
  v_cvt_pk_bf16_f32 v112, v64, v65
  v_mfma_f32_16x16x32_bf16 v[72:75], a[136:139], a[40:43], v[72:75]
  v_mfma_f32_16x16x32_bf16 v[72:75], a[140:143], a[56:59], v[72:75]
  buffer_load_dwordx4 v37, s[8:11], s35 offen offset:3072 lds
  v_mfma_f32_16x16x32_bf16 v[72:75], a[144:147], a[72:75], v[72:75]
  v_exp_f32 v66, v66
  v_mfma_f32_16x16x32_bf16 v[72:75], a[148:151], a[88:91], v[72:75]
  v_add_f32 v4, v4, v66
  s_add_u32 m0, s32, 98304
  v_mfma_f32_16x16x32_bf16 v[72:75], a[152:155], a[104:107], v[72:75]
  v_mfma_f32_16x16x32_bf16 v[72:75], a[156:159], a[120:123], v[72:75]
  s_waitcnt vmcnt(8) lgkmcnt(0)
  s_barrier
  v_mfma_f32_16x16x32_bf16 v[76:79], a[128:131], a[12:15], v[60:63]
  v_exp_f32 v67, v67
  v_mfma_f32_16x16x32_bf16 v[76:79], a[132:135], a[28:31], v[76:79]
  v_add_f32 v4, v4, v67
  v_cvt_pk_bf16_f32 v113, v66, v67
  v_mfma_f32_16x16x32_bf16 v[76:79], a[136:139], a[44:47], v[76:79]
  ds_read2st64_b64 a[192:195], v33 offset0:0 offset1:1
  v_mfma_f32_16x16x32_bf16 v[76:79], a[140:143], a[60:63], v[76:79]
  buffer_load_dwordx4 v38, s[12:15], s36 offen lds
  v_mfma_f32_16x16x32_bf16 v[76:79], a[144:147], a[76:79], v[76:79]
  v_exp_f32 v68, v68
  v_mfma_f32_16x16x32_bf16 v[76:79], a[148:151], a[92:95], v[76:79]
  v_add_f32 v5, v5, v68
  v_mfma_f32_16x16x32_bf16 v[76:79], a[152:155], a[108:111], v[76:79]
  ds_read2st64_b64 a[196:199], v33 offset0:2 offset1:3
  v_mfma_f32_16x16x32_bf16 v[76:79], a[156:159], a[124:127], v[76:79]
  v_mfma_f32_16x16x32_bf16 v[80:83], a[160:163], a[0:3], v[48:51]
  v_exp_f32 v69, v69
  v_mfma_f32_16x16x32_bf16 v[80:83], a[164:167], a[16:19], v[80:83]
  v_add_f32 v5, v5, v69
  v_cvt_pk_bf16_f32 v116, v68, v69
  v_mfma_f32_16x16x32_bf16 v[80:83], a[168:171], a[32:35], v[80:83]
  ds_read_b64_tr_b16 a[128:129], v16 offset:0
  ds_read_b64_tr_b16 a[130:131], v16 offset:8192
  v_mfma_f32_16x16x32_bf16 v[80:83], a[172:175], a[48:51], v[80:83]
  buffer_load_dwordx4 v39, s[12:15], s36 offen offset:1024 lds
  v_mfma_f32_16x16x32_bf16 v[80:83], a[176:179], a[64:67], v[80:83]
  v_exp_f32 v70, v70
  v_mfma_f32_16x16x32_bf16 v[80:83], a[180:183], a[80:83], v[80:83]
  v_add_f32 v5, v5, v70
  v_mfma_f32_16x16x32_bf16 v[80:83], a[184:187], a[96:99], v[80:83]
  ds_read_b64_tr_b16 a[132:133], v24 offset:0
  ds_read_b64_tr_b16 a[134:135], v24 offset:8192
  v_mfma_f32_16x16x32_bf16 v[80:83], a[188:191], a[112:115], v[80:83]
  ds_read2st64_b64 a[200:203], v33 offset0:4 offset1:5
  v_mfma_f32_16x16x32_bf16 v[84:87], a[160:163], a[4:7], v[52:55]
  v_exp_f32 v71, v71
  v_mfma_f32_16x16x32_bf16 v[84:87], a[164:167], a[20:23], v[84:87]
  v_add_f32 v5, v5, v71
  v_cvt_pk_bf16_f32 v117, v70, v71
  v_mfma_f32_16x16x32_bf16 v[84:87], a[168:171], a[36:39], v[84:87]
  ds_read_b64_tr_b16 a[136:137], v17 offset:0
  ds_read_b64_tr_b16 a[138:139], v17 offset:8192
  v_mfma_f32_16x16x32_bf16 v[84:87], a[172:175], a[52:55], v[84:87]
  buffer_load_dwordx4 v40, s[12:15], s36 offen offset:2048 lds
  v_mfma_f32_16x16x32_bf16 v[84:87], a[176:179], a[68:71], v[84:87]
  v_exp_f32 v72, v72
  v_mfma_f32_16x16x32_bf16 v[84:87], a[180:183], a[84:87], v[84:87]
  v_add_f32 v6, v6, v72
  v_mfma_f32_16x16x32_bf16 v[84:87], a[184:187], a[100:103], v[84:87]
  ds_read_b64_tr_b16 a[140:141], v25 offset:0
  ds_read_b64_tr_b16 a[142:143], v25 offset:8192
  v_mfma_f32_16x16x32_bf16 v[84:87], a[188:191], a[116:119], v[84:87]
  ds_read2st64_b64 a[204:207], v33 offset0:6 offset1:7
  v_mfma_f32_16x16x32_bf16 v[88:91], a[160:163], a[8:11], v[56:59]
  v_exp_f32 v73, v73
  v_mfma_f32_16x16x32_bf16 v[88:91], a[164:167], a[24:27], v[88:91]
  v_add_f32 v6, v6, v73
  v_cvt_pk_bf16_f32 v120, v72, v73
  v_mfma_f32_16x16x32_bf16 v[88:91], a[168:171], a[40:43], v[88:91]
  ds_read_b64_tr_b16 a[144:145], v18 offset:0
  ds_read_b64_tr_b16 a[146:147], v18 offset:8192
  v_mfma_f32_16x16x32_bf16 v[88:91], a[172:175], a[56:59], v[88:91]
  buffer_load_dwordx4 v41, s[12:15], s36 offen offset:3072 lds
  v_mfma_f32_16x16x32_bf16 v[88:91], a[176:179], a[72:75], v[88:91]
  v_exp_f32 v74, v74
  v_mfma_f32_16x16x32_bf16 v[88:91], a[180:183], a[88:91], v[88:91]
  v_add_f32 v6, v6, v74
  s_add_u32 m0, s32, 102400
  v_mfma_f32_16x16x32_bf16 v[88:91], a[184:187], a[104:107], v[88:91]
  ds_read_b64_tr_b16 a[148:149], v26 offset:0
  ds_read_b64_tr_b16 a[150:151], v26 offset:8192
  v_mfma_f32_16x16x32_bf16 v[88:91], a[188:191], a[120:123], v[88:91]
  s_add_u32 s36, s36, 65536
  s_and_b32 s36, s36, 0xfffff
  v_mfma_f32_16x16x32_bf16 v[92:95], a[160:163], a[12:15], v[60:63]
  v_exp_f32 v75, v75
  v_mfma_f32_16x16x32_bf16 v[92:95], a[164:167], a[28:31], v[92:95]
  v_add_f32 v6, v6, v75
  v_cvt_pk_bf16_f32 v121, v74, v75
  v_mfma_f32_16x16x32_bf16 v[92:95], a[168:171], a[44:47], v[92:95]
  ds_read_b64_tr_b16 a[152:153], v19 offset:0
  ds_read_b64_tr_b16 a[154:155], v19 offset:8192
  v_mfma_f32_16x16x32_bf16 v[92:95], a[172:175], a[60:63], v[92:95]
  buffer_load_dwordx4 v38, s[12:15], s37 offen lds
  v_mfma_f32_16x16x32_bf16 v[92:95], a[176:179], a[76:79], v[92:95]
  v_exp_f32 v76, v76
  v_mfma_f32_16x16x32_bf16 v[92:95], a[180:183], a[92:95], v[92:95]
  v_add_f32 v7, v7, v76
  v_mfma_f32_16x16x32_bf16 v[92:95], a[184:187], a[108:111], v[92:95]
  ds_read_b64_tr_b16 a[156:157], v27 offset:0
  ds_read_b64_tr_b16 a[158:159], v27 offset:8192
  v_mfma_f32_16x16x32_bf16 v[92:95], a[188:191], a[124:127], v[92:95]
  s_waitcnt lgkmcnt(8)
  v_mfma_f32_16x16x32_bf16 v[128:131], a[128:131], v[96:99], v[128:131]
  v_exp_f32 v77, v77
  v_mfma_f32_16x16x32_bf16 v[128:131], a[132:135], a[192:195], v[128:131]
  v_add_f32 v7, v7, v77
  v_cvt_pk_bf16_f32 v124, v76, v77
  v_mfma_f32_16x16x32_bf16 v[132:135], a[128:131], v[100:103], v[132:135]
  ds_read_b64_tr_b16 a[160:161], v20 offset:0
  ds_read_b64_tr_b16 a[162:163], v20 offset:8192
  v_mfma_f32_16x16x32_bf16 v[132:135], a[132:135], a[196:199], v[132:135]
  buffer_load_dwordx4 v39, s[12:15], s37 offen offset:1024 lds
  v_mfma_f32_16x16x32_bf16 v[136:139], a[128:131], v[104:107], v[136:139]
  v_exp_f32 v78, v78
  v_mfma_f32_16x16x32_bf16 v[136:139], a[132:135], a[200:203], v[136:139]
  v_add_f32 v7, v7, v78
  v_mfma_f32_16x16x32_bf16 v[140:143], a[128:131], v[108:111], v[140:143]
  ds_read_b64_tr_b16 a[164:165], v28 offset:0
  ds_read_b64_tr_b16 a[166:167], v28 offset:8192
  v_mfma_f32_16x16x32_bf16 v[140:143], a[132:135], a[204:207], v[140:143]
  v_mfma_f32_16x16x32_bf16 v[144:147], a[136:139], v[96:99], v[144:147]
  v_exp_f32 v79, v79
  v_mfma_f32_16x16x32_bf16 v[144:147], a[140:143], a[192:195], v[144:147]
  v_add_f32 v7, v7, v79
  v_cvt_pk_bf16_f32 v125, v78, v79
  v_mfma_f32_16x16x32_bf16 v[148:151], a[136:139], v[100:103], v[148:151]
  ds_read_b64_tr_b16 a[168:169], v21 offset:0
  ds_read_b64_tr_b16 a[170:171], v21 offset:8192
  v_mfma_f32_16x16x32_bf16 v[148:151], a[140:143], a[196:199], v[148:151]
  buffer_load_dwordx4 v40, s[12:15], s37 offen offset:2048 lds
  v_mfma_f32_16x16x32_bf16 v[152:155], a[136:139], v[104:107], v[152:155]
  v_exp_f32 v80, v80
  v_mfma_f32_16x16x32_bf16 v[152:155], a[140:143], a[200:203], v[152:155]
  v_add_f32 v4, v4, v80
  v_mfma_f32_16x16x32_bf16 v[156:159], a[136:139], v[108:111], v[156:159]
  ds_read_b64_tr_b16 a[172:173], v29 offset:0
  ds_read_b64_tr_b16 a[174:175], v29 offset:8192
  v_mfma_f32_16x16x32_bf16 v[156:159], a[140:143], a[204:207], v[156:159]
  s_waitcnt lgkmcnt(12)
  v_mfma_f32_16x16x32_bf16 v[160:163], a[144:147], v[96:99], v[160:163]
  v_exp_f32 v81, v81
  v_mfma_f32_16x16x32_bf16 v[160:163], a[148:151], a[192:195], v[160:163]
  v_add_f32 v4, v4, v81
  v_cvt_pk_bf16_f32 v114, v80, v81
  v_mfma_f32_16x16x32_bf16 v[164:167], a[144:147], v[100:103], v[164:167]
  ds_read_b64_tr_b16 a[176:177], v22 offset:0
  ds_read_b64_tr_b16 a[178:179], v22 offset:8192
  v_mfma_f32_16x16x32_bf16 v[164:167], a[148:151], a[196:199], v[164:167]
  buffer_load_dwordx4 v41, s[12:15], s37 offen offset:3072 lds
  v_mfma_f32_16x16x32_bf16 v[168:171], a[144:147], v[104:107], v[168:171]
  v_exp_f32 v82, v82
  s_add_u32 m0, s32, 32768
  v_mfma_f32_16x16x32_bf16 v[168:171], a[148:151], a[200:203], v[168:171]
  v_add_f32 v4, v4, v82
  s_add_u32 s37, s36, 4096
  v_mfma_f32_16x16x32_bf16 v[172:175], a[144:147], v[108:111], v[172:175]
  ds_read_b64_tr_b16 a[180:181], v30 offset:0
  ds_read_b64_tr_b16 a[182:183], v30 offset:8192
  v_mfma_f32_16x16x32_bf16 v[172:175], a[148:151], a[204:207], v[172:175]
  s_waitcnt vmcnt(8) lgkmcnt(12)
  s_barrier
  v_mfma_f32_16x16x32_bf16 v[176:179], a[152:155], v[96:99], v[176:179]
  v_exp_f32 v83, v83
  v_mfma_f32_16x16x32_bf16 v[176:179], a[156:159], a[192:195], v[176:179]
  v_add_f32 v4, v4, v83
  v_cvt_pk_bf16_f32 v115, v82, v83
  v_mfma_f32_16x16x32_bf16 v[180:183], a[152:155], v[100:103], v[180:183]
  ds_read_b64_tr_b16 a[184:185], v23 offset:0
  ds_read_b64_tr_b16 a[186:187], v23 offset:8192
  v_mfma_f32_16x16x32_bf16 v[180:183], a[156:159], a[196:199], v[180:183]
  buffer_load_dwordx4 v34, s[8:11], s36 offen lds
  v_mfma_f32_16x16x32_bf16 v[184:187], a[152:155], v[104:107], v[184:187]
  v_exp_f32 v84, v84
  v_mfma_f32_16x16x32_bf16 v[184:187], a[156:159], a[200:203], v[184:187]
  v_add_f32 v5, v5, v84
  v_mfma_f32_16x16x32_bf16 v[188:191], a[152:155], v[108:111], v[188:191]
  ds_read_b64_tr_b16 a[188:189], v31 offset:0
  ds_read_b64_tr_b16 a[190:191], v31 offset:8192
  v_mfma_f32_16x16x32_bf16 v[188:191], a[156:159], a[204:207], v[188:191]
  ds_write_b64 v32, v[112:113] offset:0
  s_waitcnt lgkmcnt(9)
  v_mfma_f32_16x16x32_bf16 v[192:195], a[160:163], v[96:99], v[192:195]
  v_exp_f32 v85, v85
  v_mfma_f32_16x16x32_bf16 v[192:195], a[164:167], a[192:195], v[192:195]
  v_add_f32 v5, v5, v85
  v_cvt_pk_bf16_f32 v118, v84, v85
  v_mfma_f32_16x16x32_bf16 v[196:199], a[160:163], v[100:103], v[196:199]
  ds_read_b128 a[128:131], v8 offset:0
  ds_read_b128 a[132:135], v9 offset:0
  v_mfma_f32_16x16x32_bf16 v[196:199], a[164:167], a[196:199], v[196:199]
  buffer_load_dwordx4 v35, s[8:11], s36 offen offset:1024 lds
  v_mfma_f32_16x16x32_bf16 v[200:203], a[160:163], v[104:107], v[200:203]
  v_exp_f32 v86, v86
  v_mfma_f32_16x16x32_bf16 v[200:203], a[164:167], a[200:203], v[200:203]
  v_add_f32 v5, v5, v86
  v_mfma_f32_16x16x32_bf16 v[204:207], a[160:163], v[108:111], v[204:207]
  ds_read_b128 a[136:139], v10 offset:0
  ds_read_b128 a[140:143], v11 offset:0
  v_mfma_f32_16x16x32_bf16 v[204:207], a[164:167], a[204:207], v[204:207]
  ds_write_b64 v32, v[114:115] offset:512
  v_mfma_f32_16x16x32_bf16 v[208:211], a[168:171], v[96:99], v[208:211]
  v_exp_f32 v87, v87
  v_mfma_f32_16x16x32_bf16 v[208:211], a[172:175], a[192:195], v[208:211]
  v_add_f32 v5, v5, v87
  v_cvt_pk_bf16_f32 v119, v86, v87
  v_mfma_f32_16x16x32_bf16 v[212:215], a[168:171], v[100:103], v[212:215]
  ds_read_b128 a[144:147], v12 offset:0
  ds_read_b128 a[148:151], v13 offset:0
  v_mfma_f32_16x16x32_bf16 v[212:215], a[172:175], a[196:199], v[212:215]
  buffer_load_dwordx4 v36, s[8:11], s36 offen offset:2048 lds
  v_mfma_f32_16x16x32_bf16 v[216:219], a[168:171], v[104:107], v[216:219]
  v_exp_f32 v88, v88
  v_mfma_f32_16x16x32_bf16 v[216:219], a[172:175], a[200:203], v[216:219]
  v_add_f32 v6, v6, v88
  s_sub_u32 s33, s33, 1
  v_mfma_f32_16x16x32_bf16 v[220:223], a[168:171], v[108:111], v[220:223]
  ds_read_b128 a[152:155], v14 offset:0
  ds_read_b128 a[156:159], v15 offset:0
  v_mfma_f32_16x16x32_bf16 v[220:223], a[172:175], a[204:207], v[220:223]
  s_waitcnt lgkmcnt(10)
  v_mfma_f32_16x16x32_bf16 v[224:227], a[176:179], v[96:99], v[224:227]
  v_exp_f32 v89, v89
  v_mfma_f32_16x16x32_bf16 v[224:227], a[180:183], a[192:195], v[224:227]
  v_add_f32 v6, v6, v89
  v_cvt_pk_bf16_f32 v122, v88, v89
  v_mfma_f32_16x16x32_bf16 v[228:231], a[176:179], v[100:103], v[228:231]
  ds_write_b64 v32, v[116:117] offset:1024
  v_mfma_f32_16x16x32_bf16 v[228:231], a[180:183], a[196:199], v[228:231]
  buffer_load_dwordx4 v37, s[8:11], s36 offen offset:3072 lds
  v_mfma_f32_16x16x32_bf16 v[232:235], a[176:179], v[104:107], v[232:235]
  v_exp_f32 v90, v90
  v_mfma_f32_16x16x32_bf16 v[232:235], a[180:183], a[200:203], v[232:235]
  v_add_f32 v6, v6, v90
  s_add_u32 m0, s32, 36864
  v_mfma_f32_16x16x32_bf16 v[236:239], a[176:179], v[108:111], v[236:239]
  ds_write_b64 v32, v[118:119] offset:1536
  v_mfma_f32_16x16x32_bf16 v[236:239], a[180:183], a[204:207], v[236:239]
  v_mfma_f32_16x16x32_bf16 v[240:243], a[184:187], v[96:99], v[240:243]
  v_exp_f32 v91, v91
  v_mfma_f32_16x16x32_bf16 v[240:243], a[188:191], a[192:195], v[240:243]
  v_add_f32 v6, v6, v91
  v_cvt_pk_bf16_f32 v123, v90, v91
  v_mfma_f32_16x16x32_bf16 v[244:247], a[184:187], v[100:103], v[244:247]
  ds_write_b64 v32, v[120:121] offset:2048
  v_mfma_f32_16x16x32_bf16 v[244:247], a[188:191], a[196:199], v[244:247]
  buffer_load_dwordx4 v34, s[8:11], s37 offen lds
  v_mfma_f32_16x16x32_bf16 v[248:251], a[184:187], v[104:107], v[248:251]
  v_exp_f32 v92, v92
  v_mfma_f32_16x16x32_bf16 v[248:251], a[188:191], a[200:203], v[248:251]
  v_add_f32 v7, v7, v92
  s_cmp_lg_u32 s33, 0
  v_mfma_f32_16x16x32_bf16 v[252:255], a[184:187], v[108:111], v[252:255]
  ds_write_b64 v32, v[122:123] offset:2560
  v_mfma_f32_16x16x32_bf16 v[252:255], a[188:191], a[204:207], v[252:255]
  s_cbranch_scc1 K1_LOOP
  s_waitcnt lgkmcnt(4)
  v_mfma_f32_16x16x32_bf16 v[64:67], a[128:131], a[0:3], v[48:51]
  v_exp_f32 v93, v93
  v_mfma_f32_16x16x32_bf16 v[64:67], a[132:135], a[16:19], v[64:67]
  v_add_f32 v7, v7, v93
  v_cvt_pk_bf16_f32 v126, v92, v93
  v_mfma_f32_16x16x32_bf16 v[64:67], a[136:139], a[32:35], v[64:67]
  ds_read_b128 a[160:163], v8 offset:8192
  ds_read_b128 a[164:167], v9 offset:8192
  v_mfma_f32_16x16x32_bf16 v[64:67], a[140:143], a[48:51], v[64:67]
  buffer_load_dwordx4 v35, s[8:11], s37 offen offset:1024 lds
  v_mfma_f32_16x16x32_bf16 v[64:67], a[144:147], a[64:67], v[64:67]
  v_exp_f32 v94, v94
  v_mfma_f32_16x16x32_bf16 v[64:67], a[148:151], a[80:83], v[64:67]
  v_add_f32 v7, v7, v94
  v_mfma_f32_16x16x32_bf16 v[64:67], a[152:155], a[96:99], v[64:67]
  ds_read_b128 a[168:171], v10 offset:8192
  ds_read_b128 a[172:175], v11 offset:8192
  v_mfma_f32_16x16x32_bf16 v[64:67], a[156:159], a[112:115], v[64:67]
  ds_write_b64 v32, v[124:125] offset:3072
  v_mfma_f32_16x16x32_bf16 v[68:71], a[128:131], a[4:7], v[52:55]
  v_exp_f32 v95, v95
  v_mfma_f32_16x16x32_bf16 v[68:71], a[132:135], a[20:23], v[68:71]
  v_add_f32 v7, v7, v95
  v_cvt_pk_bf16_f32 v127, v94, v95
  v_mfma_f32_16x16x32_bf16 v[68:71], a[136:139], a[36:39], v[68:71]
  ds_read_b128 a[176:179], v12 offset:8192
  ds_read_b128 a[180:183], v13 offset:8192
  v_mfma_f32_16x16x32_bf16 v[68:71], a[140:143], a[52:55], v[68:71]
  buffer_load_dwordx4 v36, s[8:11], s37 offen offset:2048 lds
  v_mfma_f32_16x16x32_bf16 v[68:71], a[144:147], a[68:71], v[68:71]
  v_exp_f32 v64, v64
  v_mfma_f32_16x16x32_bf16 v[68:71], a[148:151], a[84:87], v[68:71]
  v_add_f32 v4, v4, v64
  v_mfma_f32_16x16x32_bf16 v[68:71], a[152:155], a[100:103], v[68:71]
  ds_read_b128 a[184:187], v14 offset:8192
  ds_read_b128 a[188:191], v15 offset:8192
  v_mfma_f32_16x16x32_bf16 v[68:71], a[156:159], a[116:119], v[68:71]
  ds_write_b64 v32, v[126:127] offset:3584
  v_mfma_f32_16x16x32_bf16 v[72:75], a[128:131], a[8:11], v[56:59]
  v_exp_f32 v65, v65
  v_mfma_f32_16x16x32_bf16 v[72:75], a[132:135], a[24:27], v[72:75]
  v_add_f32 v4, v4, v65
  v_cvt_pk_bf16_f32 v96, v64, v65
  v_mfma_f32_16x16x32_bf16 v[72:75], a[136:139], a[40:43], v[72:75]
  v_mfma_f32_16x16x32_bf16 v[72:75], a[140:143], a[56:59], v[72:75]
  buffer_load_dwordx4 v37, s[8:11], s37 offen offset:3072 lds
  v_mfma_f32_16x16x32_bf16 v[72:75], a[144:147], a[72:75], v[72:75]
  v_exp_f32 v66, v66
  v_mfma_f32_16x16x32_bf16 v[72:75], a[148:151], a[88:91], v[72:75]
  v_add_f32 v4, v4, v66
  s_add_u32 m0, s32, 65536
  s_mul_i32 s41, s4, 458752
  v_mfma_f32_16x16x32_bf16 v[72:75], a[152:155], a[104:107], v[72:75]
  v_mfma_f32_16x16x32_bf16 v[72:75], a[156:159], a[120:123], v[72:75]
  s_waitcnt vmcnt(8) lgkmcnt(0)
  s_barrier
  s_add_u32 s20, s54, s41
  s_addc_u32 s21, s55, 0
  s_and_b32 s21, s21, 0xffff
  s_mov_b32 s22, 458752
  s_mov_b32 s23, 0x20000
  v_mfma_f32_16x16x32_bf16 v[76:79], a[128:131], a[12:15], v[60:63]
  v_exp_f32 v67, v67
  v_mfma_f32_16x16x32_bf16 v[76:79], a[132:135], a[28:31], v[76:79]
  v_add_f32 v4, v4, v67
  v_cvt_pk_bf16_f32 v97, v66, v67
  v_lshrrev_b32 v1, 3, v2
  v_mfma_f32_16x16x32_bf16 v[76:79], a[136:139], a[44:47], v[76:79]
  ds_read2st64_b64 a[192:195], v33 offset0:0 offset1:1
  v_mfma_f32_16x16x32_bf16 v[76:79], a[140:143], a[60:63], v[76:79]
  buffer_load_dwordx4 v38, s[12:15], s34 offen lds
  v_and_b32 v3, 6, v1
  v_mfma_f32_16x16x32_bf16 v[76:79], a[144:147], a[76:79], v[76:79]
  v_exp_f32 v68, v68
  v_mfma_f32_16x16x32_bf16 v[76:79], a[148:151], a[92:95], v[76:79]
  v_add_f32 v5, v5, v68
  v_and_b32 v47, 7, v2
  v_mfma_f32_16x16x32_bf16 v[76:79], a[152:155], a[108:111], v[76:79]
  ds_read2st64_b64 a[196:199], v33 offset0:2 offset1:3
  v_mfma_f32_16x16x32_bf16 v[76:79], a[156:159], a[124:127], v[76:79]
  v_xor_b32 v3, v3, v47
  v_mfma_f32_16x16x32_bf16 v[80:83], a[160:163], a[0:3], v[48:51]
  v_exp_f32 v69, v69
  v_mfma_f32_16x16x32_bf16 v[80:83], a[164:167], a[16:19], v[80:83]
  v_add_f32 v5, v5, v69
  v_cvt_pk_bf16_f32 v100, v68, v69
  v_mul_u32_u24 v1, 896, v1
  v_mfma_f32_16x16x32_bf16 v[80:83], a[168:171], a[32:35], v[80:83]
  ds_read_b64_tr_b16 a[128:129], v16 offset:32768
  ds_read_b64_tr_b16 a[130:131], v16 offset:40960
  v_mfma_f32_16x16x32_bf16 v[80:83], a[172:175], a[48:51], v[80:83]
  buffer_load_dwordx4 v39, s[12:15], s34 offen offset:1024 lds
  v_lshl_add_u32 v1, v3, 4, v1
  v_mfma_f32_16x16x32_bf16 v[80:83], a[176:179], a[64:67], v[80:83]
  v_exp_f32 v70, v70
  v_mfma_f32_16x16x32_bf16 v[80:83], a[180:183], a[80:83], v[80:83]
  v_add_f32 v5, v5, v70
  s_lshl_b32 s41, s3, 7
  v_mfma_f32_16x16x32_bf16 v[80:83], a[184:187], a[96:99], v[80:83]
  ds_read_b64_tr_b16 a[132:133], v24 offset:32768
  ds_read_b64_tr_b16 a[134:135], v24 offset:40960
  v_mfma_f32_16x16x32_bf16 v[80:83], a[188:191], a[112:115], v[80:83]
  ds_read2st64_b64 a[200:203], v33 offset0:4 offset1:5
  v_add_u32 v34, s41, v1
  v_mfma_f32_16x16x32_bf16 v[84:87], a[160:163], a[4:7], v[52:55]
  v_exp_f32 v71, v71
  v_mfma_f32_16x16x32_bf16 v[84:87], a[164:167], a[20:23], v[84:87]
  v_add_f32 v5, v5, v71
  v_cvt_pk_bf16_f32 v101, v70, v71
  v_add_u32 v35, 6144, v34
  v_mfma_f32_16x16x32_bf16 v[84:87], a[168:171], a[36:39], v[84:87]
  ds_read_b64_tr_b16 a[136:137], v17 offset:32768
  ds_read_b64_tr_b16 a[138:139], v17 offset:40960
  v_mfma_f32_16x16x32_bf16 v[84:87], a[172:175], a[52:55], v[84:87]
  buffer_load_dwordx4 v40, s[12:15], s34 offen offset:2048 lds
  v_add_u32 v36, 12288, v34
  v_mfma_f32_16x16x32_bf16 v[84:87], a[176:179], a[68:71], v[84:87]
  v_exp_f32 v72, v72
  v_mfma_f32_16x16x32_bf16 v[84:87], a[180:183], a[84:87], v[84:87]
  v_add_f32 v6, v6, v72
  v_add_u32 v37, 18432, v34
  v_mfma_f32_16x16x32_bf16 v[84:87], a[184:187], a[100:103], v[84:87]
  ds_read_b64_tr_b16 a[140:141], v25 offset:32768
  ds_read_b64_tr_b16 a[142:143], v25 offset:40960
  v_mfma_f32_16x16x32_bf16 v[84:87], a[188:191], a[116:119], v[84:87]
  ds_read2st64_b64 a[204:207], v33 offset0:6 offset1:7
  s_lshl_b32 s41, s6, 6
  s_add_u32 s41, s41, s4
  v_mfma_f32_16x16x32_bf16 v[88:91], a[160:163], a[8:11], v[56:59]
  v_exp_f32 v73, v73
  v_mfma_f32_16x16x32_bf16 v[88:91], a[164:167], a[24:27], v[88:91]
  v_add_f32 v6, v6, v73
  v_cvt_pk_bf16_f32 v104, v72, v73
  s_mul_i32 s41, s41, 7168
  s_add_u32 s41, s41, 16777216
  v_mfma_f32_16x16x32_bf16 v[88:91], a[168:171], a[40:43], v[88:91]
  ds_read_b64_tr_b16 a[144:145], v18 offset:32768
  ds_read_b64_tr_b16 a[146:147], v18 offset:40960
  v_mfma_f32_16x16x32_bf16 v[88:91], a[172:175], a[56:59], v[88:91]
  buffer_load_dwordx4 v41, s[12:15], s34 offen offset:3072 lds
  s_add_u32 s28, s56, s41
  s_addc_u32 s29, s57, 0
  s_and_b32 s29, s29, 0xffff
  s_mov_b32 s30, 408576
  s_mov_b32 s31, 0x20000
  v_mfma_f32_16x16x32_bf16 v[88:91], a[176:179], a[72:75], v[88:91]
  v_exp_f32 v74, v74
  v_mfma_f32_16x16x32_bf16 v[88:91], a[180:183], a[88:91], v[88:91]
  v_add_f32 v6, v6, v74
  s_add_u32 m0, s32, 69632
  v_bfe_u32 v1, v2, 2, 2
  v_mfma_f32_16x16x32_bf16 v[88:91], a[184:187], a[104:107], v[88:91]
  ds_read_b64_tr_b16 a[148:149], v26 offset:32768
  ds_read_b64_tr_b16 a[150:151], v26 offset:40960
  v_mfma_f32_16x16x32_bf16 v[88:91], a[188:191], a[120:123], v[88:91]
  v_mul_u32_u24 v1, 57344, v1
  v_mfma_f32_16x16x32_bf16 v[92:95], a[160:163], a[12:15], v[60:63]
  v_exp_f32 v75, v75
  v_mfma_f32_16x16x32_bf16 v[92:95], a[164:167], a[28:31], v[92:95]
  v_add_f32 v6, v6, v75
  v_cvt_pk_bf16_f32 v105, v74, v75
  v_lshrrev_b32 v3, 4, v2
  v_mfma_f32_16x16x32_bf16 v[92:95], a[168:171], a[44:47], v[92:95]
  ds_read_b64_tr_b16 a[152:153], v19 offset:32768
  ds_read_b64_tr_b16 a[154:155], v19 offset:40960
  v_mfma_f32_16x16x32_bf16 v[92:95], a[172:175], a[60:63], v[92:95]
  buffer_load_dwordx4 v38, s[12:15], s35 offen lds
  v_lshl_add_u32 v1, v3, 6, v1
  v_mfma_f32_16x16x32_bf16 v[92:95], a[176:179], a[76:79], v[92:95]
  v_exp_f32 v76, v76
  v_mfma_f32_16x16x32_bf16 v[92:95], a[180:183], a[92:95], v[92:95]
  v_add_f32 v7, v7, v76
  v_and_b32 v3, 3, v2
  v_mfma_f32_16x16x32_bf16 v[92:95], a[184:187], a[108:111], v[92:95]
  ds_read_b64_tr_b16 a[156:157], v27 offset:32768
  ds_read_b64_tr_b16 a[158:159], v27 offset:40960
  v_mfma_f32_16x16x32_bf16 v[92:95], a[188:191], a[124:127], v[92:95]
  v_lshl_add_u32 v46, v3, 4, v1
  s_waitcnt lgkmcnt(8)
  v_mfma_f32_16x16x32_bf16 v[128:131], a[128:131], v[112:115], v[128:131]
  v_exp_f32 v77, v77
  v_mfma_f32_16x16x32_bf16 v[128:131], a[132:135], a[192:195], v[128:131]
  v_add_f32 v7, v7, v77
  v_cvt_pk_bf16_f32 v108, v76, v77
  s_lshl_b32 s44, s3, 12
  s_add_u32 s44, s44, 131072
  v_mfma_f32_16x16x32_bf16 v[132:135], a[128:131], v[116:119], v[132:135]
  ds_read_b64_tr_b16 a[160:161], v20 offset:32768
  ds_read_b64_tr_b16 a[162:163], v20 offset:40960
  v_mfma_f32_16x16x32_bf16 v[132:135], a[132:135], a[196:199], v[132:135]
  buffer_load_dwordx4 v39, s[12:15], s35 offen offset:1024 lds
  s_mov_b32 s45, 131072
  v_mfma_f32_16x16x32_bf16 v[136:139], a[128:131], v[120:123], v[136:139]
  v_exp_f32 v78, v78
  v_mfma_f32_16x16x32_bf16 v[136:139], a[132:135], a[200:203], v[136:139]
  v_add_f32 v7, v7, v78
  v_mfma_f32_16x16x32_bf16 v[140:143], a[128:131], v[124:127], v[140:143]
  ds_read_b64_tr_b16 a[164:165], v28 offset:32768
  ds_read_b64_tr_b16 a[166:167], v28 offset:40960
  v_mfma_f32_16x16x32_bf16 v[140:143], a[132:135], a[204:207], v[140:143]
  v_mfma_f32_16x16x32_bf16 v[144:147], a[136:139], v[112:115], v[144:147]
  v_exp_f32 v79, v79
  v_mfma_f32_16x16x32_bf16 v[144:147], a[140:143], a[192:195], v[144:147]
  v_add_f32 v7, v7, v79
  v_cvt_pk_bf16_f32 v109, v78, v79
  v_mfma_f32_16x16x32_bf16 v[148:151], a[136:139], v[116:119], v[148:151]
  ds_read_b64_tr_b16 a[168:169], v21 offset:32768
  ds_read_b64_tr_b16 a[170:171], v21 offset:40960
  v_mfma_f32_16x16x32_bf16 v[148:151], a[140:143], a[196:199], v[148:151]
  buffer_load_dwordx4 v40, s[12:15], s35 offen offset:2048 lds
  v_mfma_f32_16x16x32_bf16 v[152:155], a[136:139], v[120:123], v[152:155]
  v_exp_f32 v80, v80
  v_mfma_f32_16x16x32_bf16 v[152:155], a[140:143], a[200:203], v[152:155]
  v_add_f32 v4, v4, v80
  v_mfma_f32_16x16x32_bf16 v[156:159], a[136:139], v[124:127], v[156:159]
  ds_read_b64_tr_b16 a[172:173], v29 offset:32768
  ds_read_b64_tr_b16 a[174:175], v29 offset:40960
  v_mfma_f32_16x16x32_bf16 v[156:159], a[140:143], a[204:207], v[156:159]
  s_waitcnt lgkmcnt(12)
  v_mfma_f32_16x16x32_bf16 v[160:163], a[144:147], v[112:115], v[160:163]
  v_exp_f32 v81, v81
  v_mfma_f32_16x16x32_bf16 v[160:163], a[148:151], a[192:195], v[160:163]
  v_add_f32 v4, v4, v81
  v_cvt_pk_bf16_f32 v98, v80, v81
  v_mfma_f32_16x16x32_bf16 v[164:167], a[144:147], v[116:119], v[164:167]
  ds_read_b64_tr_b16 a[176:177], v22 offset:32768
  ds_read_b64_tr_b16 a[178:179], v22 offset:40960
  v_mfma_f32_16x16x32_bf16 v[164:167], a[148:151], a[196:199], v[164:167]
  buffer_load_dwordx4 v41, s[12:15], s35 offen offset:3072 lds
  v_mfma_f32_16x16x32_bf16 v[168:171], a[144:147], v[120:123], v[168:171]
  v_exp_f32 v82, v82
  v_mfma_f32_16x16x32_bf16 v[168:171], a[148:151], a[200:203], v[168:171]
  v_add_f32 v4, v4, v82
  v_mfma_f32_16x16x32_bf16 v[172:175], a[144:147], v[124:127], v[172:175]
  ds_read_b64_tr_b16 a[180:181], v30 offset:32768
  ds_read_b64_tr_b16 a[182:183], v30 offset:40960
  v_mfma_f32_16x16x32_bf16 v[172:175], a[148:151], a[204:207], v[172:175]
  s_waitcnt vmcnt(8) lgkmcnt(12)
  s_barrier
  v_mfma_f32_16x16x32_bf16 v[176:179], a[152:155], v[112:115], v[176:179]
  v_exp_f32 v83, v83
  v_mfma_f32_16x16x32_bf16 v[176:179], a[156:159], a[192:195], v[176:179]
  v_add_f32 v4, v4, v83
  v_cvt_pk_bf16_f32 v99, v82, v83
  s_mov_b32 s40, 0
  s_add_u32 m0, s32, 0
  v_mfma_f32_16x16x32_bf16 v[180:183], a[152:155], v[116:119], v[180:183]
  ds_read_b64_tr_b16 a[184:185], v23 offset:32768
  ds_read_b64_tr_b16 a[186:187], v23 offset:40960
  v_mfma_f32_16x16x32_bf16 v[180:183], a[156:159], a[196:199], v[180:183]
  buffer_load_dwordx4 v34, s[20:23], s40 offen lds
  v_mfma_f32_16x16x32_bf16 v[184:187], a[152:155], v[120:123], v[184:187]
  v_exp_f32 v84, v84
  v_mfma_f32_16x16x32_bf16 v[184:187], a[156:159], a[200:203], v[184:187]
  v_add_f32 v5, v5, v84
  s_lshl_b32 s41, s3, 8
  v_mfma_f32_16x16x32_bf16 v[188:191], a[152:155], v[124:127], v[188:191]
  ds_read_b64_tr_b16 a[188:189], v31 offset:32768
  ds_read_b64_tr_b16 a[190:191], v31 offset:40960
  v_mfma_f32_16x16x32_bf16 v[188:191], a[156:159], a[204:207], v[188:191]
  ds_write_b64 v32, v[96:97] offset:0
  s_waitcnt lgkmcnt(9)
  v_mfma_f32_16x16x32_bf16 v[192:195], a[160:163], v[112:115], v[192:195]
  v_exp_f32 v85, v85
  v_mfma_f32_16x16x32_bf16 v[192:195], a[164:167], a[192:195], v[192:195]
  v_add_f32 v5, v5, v85
  v_cvt_pk_bf16_f32 v102, v84, v85
  v_mfma_f32_16x16x32_bf16 v[196:199], a[160:163], v[116:119], v[196:199]
  ds_read_b128 a[128:131], v8 offset:32768
  ds_read_b128 a[132:135], v9 offset:32768
  v_mfma_f32_16x16x32_bf16 v[196:199], a[164:167], a[196:199], v[196:199]
  buffer_load_dwordx4 v35, s[20:23], s40 offen offset:1024 lds
  v_mfma_f32_16x16x32_bf16 v[200:203], a[160:163], v[120:123], v[200:203]
  v_exp_f32 v86, v86
  v_mfma_f32_16x16x32_bf16 v[200:203], a[164:167], a[200:203], v[200:203]
  v_add_f32 v5, v5, v86
  s_add_u32 s41, s41, 147456
  v_mfma_f32_16x16x32_bf16 v[204:207], a[160:163], v[124:127], v[204:207]
  ds_read_b128 a[136:139], v10 offset:32768
  ds_read_b128 a[140:143], v11 offset:32768
  v_mfma_f32_16x16x32_bf16 v[204:207], a[164:167], a[204:207], v[204:207]
  ds_write_b64 v32, v[98:99] offset:512
  v_mfma_f32_16x16x32_bf16 v[208:211], a[168:171], v[112:115], v[208:211]
  v_exp_f32 v87, v87
  v_mfma_f32_16x16x32_bf16 v[208:211], a[172:175], a[192:195], v[208:211]
  v_add_f32 v5, v5, v87
  v_cvt_pk_bf16_f32 v103, v86, v87
  v_mfma_f32_16x16x32_bf16 v[212:215], a[168:171], v[116:119], v[212:215]
  ds_read_b128 a[144:147], v12 offset:32768
  ds_read_b128 a[148:151], v13 offset:32768
  v_mfma_f32_16x16x32_bf16 v[212:215], a[172:175], a[196:199], v[212:215]
  buffer_load_dwordx4 v36, s[20:23], s40 offen offset:2048 lds
  v_mfma_f32_16x16x32_bf16 v[216:219], a[168:171], v[120:123], v[216:219]
  v_exp_f32 v88, v88
  v_mfma_f32_16x16x32_bf16 v[216:219], a[172:175], a[200:203], v[216:219]
  v_add_f32 v6, v6, v88
  v_and_b32 v3, 15, v2
  v_mfma_f32_16x16x32_bf16 v[220:223], a[168:171], v[124:127], v[220:223]
  ds_read_b128 a[152:155], v14 offset:32768
  ds_read_b128 a[156:159], v15 offset:32768
  v_mfma_f32_16x16x32_bf16 v[220:223], a[172:175], a[204:207], v[220:223]
  v_lshl_add_u32 v3, v3, 4, s41
  s_waitcnt lgkmcnt(10)
  v_mfma_f32_16x16x32_bf16 v[224:227], a[176:179], v[112:115], v[224:227]
  v_exp_f32 v89, v89
  v_mfma_f32_16x16x32_bf16 v[224:227], a[180:183], a[192:195], v[224:227]
  v_add_f32 v6, v6, v89
  v_cvt_pk_bf16_f32 v106, v88, v89
  v_mfma_f32_16x16x32_bf16 v[228:231], a[176:179], v[116:119], v[228:231]
  ds_write_b64 v32, v[100:101] offset:1024
  v_mfma_f32_16x16x32_bf16 v[228:231], a[180:183], a[196:199], v[228:231]
  buffer_load_dwordx4 v37, s[20:23], s40 offen offset:3072 lds
  v_mfma_f32_16x16x32_bf16 v[232:235], a[176:179], v[120:123], v[232:235]
  v_exp_f32 v90, v90
  v_mfma_f32_16x16x32_bf16 v[232:235], a[180:183], a[200:203], v[232:235]
  v_add_f32 v6, v6, v90
  v_lshrrev_b32 v1, 4, v2
  v_mfma_f32_16x16x32_bf16 v[236:239], a[176:179], v[124:127], v[236:239]
  ds_write_b64 v32, v[102:103] offset:1536
  v_mfma_f32_16x16x32_bf16 v[236:239], a[180:183], a[204:207], v[236:239]
  v_lshl_add_u32 v1, v1, 2, v3
  v_mfma_f32_16x16x32_bf16 v[240:243], a[184:187], v[112:115], v[240:243]
  v_exp_f32 v91, v91
  v_mfma_f32_16x16x32_bf16 v[240:243], a[188:191], a[192:195], v[240:243]
  v_add_f32 v6, v6, v91
  v_cvt_pk_bf16_f32 v107, v90, v91
  s_mov_b32 s40, 114688
  s_add_u32 m0, s32, 4096
  v_mfma_f32_16x16x32_bf16 v[244:247], a[184:187], v[116:119], v[244:247]
  ds_write_b64 v32, v[104:105] offset:2048
  v_mfma_f32_16x16x32_bf16 v[244:247], a[188:191], a[196:199], v[244:247]
  buffer_load_dwordx4 v34, s[20:23], s40 offen lds
  v_mfma_f32_16x16x32_bf16 v[248:251], a[184:187], v[120:123], v[248:251]
  v_exp_f32 v92, v92
  v_mfma_f32_16x16x32_bf16 v[248:251], a[188:191], a[200:203], v[248:251]
  v_add_f32 v7, v7, v92
  v_and_b32 v3, 0xfffffcff, v3
  v_mfma_f32_16x16x32_bf16 v[252:255], a[184:187], v[124:127], v[252:255]
  ds_write_b64 v32, v[106:107] offset:2560
  v_mfma_f32_16x16x32_bf16 v[252:255], a[188:191], a[204:207], v[252:255]
  s_waitcnt lgkmcnt(4)
  v_mfma_f32_16x16x32_bf16 v[64:67], a[128:131], a[0:3], v[48:51]
  v_exp_f32 v93, v93
  v_mfma_f32_16x16x32_bf16 v[64:67], a[132:135], a[16:19], v[64:67]
  v_add_f32 v7, v7, v93
  v_cvt_pk_bf16_f32 v110, v92, v93
  v_mfma_f32_16x16x32_bf16 v[64:67], a[136:139], a[32:35], v[64:67]
  ds_read_b128 a[160:163], v8 offset:40960
  ds_read_b128 a[164:167], v9 offset:40960
  v_mfma_f32_16x16x32_bf16 v[64:67], a[140:143], a[48:51], v[64:67]
  buffer_load_dwordx4 v35, s[20:23], s40 offen offset:1024 lds
  v_mfma_f32_16x16x32_bf16 v[64:67], a[144:147], a[64:67], v[64:67]
  v_exp_f32 v94, v94
  v_mfma_f32_16x16x32_bf16 v[64:67], a[148:151], a[80:83], v[64:67]
  v_add_f32 v7, v7, v94
  v_mfma_f32_16x16x32_bf16 v[64:67], a[152:155], a[96:99], v[64:67]
  ds_read_b128 a[168:171], v10 offset:40960
  ds_read_b128 a[172:175], v11 offset:40960
  v_mfma_f32_16x16x32_bf16 v[64:67], a[156:159], a[112:115], v[64:67]
  ds_write_b64 v32, v[108:109] offset:3072
  v_mfma_f32_16x16x32_bf16 v[68:71], a[128:131], a[4:7], v[52:55]
  v_exp_f32 v95, v95
  v_mfma_f32_16x16x32_bf16 v[68:71], a[132:135], a[20:23], v[68:71]
  v_add_f32 v7, v7, v95
  v_cvt_pk_bf16_f32 v111, v94, v95
  v_mfma_f32_16x16x32_bf16 v[68:71], a[136:139], a[36:39], v[68:71]
  ds_read_b128 a[176:179], v12 offset:40960
  ds_read_b128 a[180:183], v13 offset:40960
  v_mfma_f32_16x16x32_bf16 v[68:71], a[140:143], a[52:55], v[68:71]
  buffer_load_dwordx4 v36, s[20:23], s40 offen offset:2048 lds
  v_mfma_f32_16x16x32_bf16 v[68:71], a[144:147], a[68:71], v[68:71]
  v_exp_f32 v64, v64
  v_mfma_f32_16x16x32_bf16 v[68:71], a[148:151], a[84:87], v[68:71]
  v_add_f32 v4, v4, v64
  v_mfma_f32_16x16x32_bf16 v[68:71], a[152:155], a[100:103], v[68:71]
  ds_read_b128 a[184:187], v14 offset:40960
  ds_read_b128 a[188:191], v15 offset:40960
  v_mfma_f32_16x16x32_bf16 v[68:71], a[156:159], a[116:119], v[68:71]
  ds_write_b64 v32, v[110:111] offset:3584
  v_mfma_f32_16x16x32_bf16 v[72:75], a[128:131], a[8:11], v[56:59]
  v_exp_f32 v65, v65
  v_mfma_f32_16x16x32_bf16 v[72:75], a[132:135], a[24:27], v[72:75]
  v_add_f32 v4, v4, v65
  v_cvt_pk_bf16_f32 v112, v64, v65
  v_mfma_f32_16x16x32_bf16 v[72:75], a[136:139], a[40:43], v[72:75]
  v_exp_f32 v66, v66
  v_mfma_f32_16x16x32_bf16 v[72:75], a[140:143], a[56:59], v[72:75]
  buffer_load_dwordx4 v37, s[20:23], s40 offen offset:3072 lds
  v_mfma_f32_16x16x32_bf16 v[72:75], a[144:147], a[72:75], v[72:75]
  v_add_f32 v4, v4, v66
  v_mfma_f32_16x16x32_bf16 v[72:75], a[148:151], a[88:91], v[72:75]
  v_exp_f32 v67, v67
  v_mfma_f32_16x16x32_bf16 v[72:75], a[152:155], a[104:107], v[72:75]
  v_add_f32 v4, v4, v67
  v_cvt_pk_bf16_f32 v113, v66, v67
  v_mfma_f32_16x16x32_bf16 v[72:75], a[156:159], a[120:123], v[72:75]
  s_waitcnt vmcnt(8) lgkmcnt(0)
  s_barrier
  v_mfma_f32_16x16x32_bf16 v[76:79], a[128:131], a[12:15], v[60:63]
  ds_read2st64_b64 a[192:195], v33 offset0:0 offset1:1
  v_mfma_f32_16x16x32_bf16 v[76:79], a[132:135], a[28:31], v[76:79]
  s_add_u32 m0, s32, 98304
  ds_write_b64 v32, v[112:113] offset:18432
  v_mfma_f32_16x16x32_bf16 v[76:79], a[136:139], a[44:47], v[76:79]
  ds_read2st64_b64 a[196:199], v33 offset0:2 offset1:3
  v_exp_f32 v68, v68
  v_mfma_f32_16x16x32_bf16 v[76:79], a[140:143], a[60:63], v[76:79]
  buffer_load_dwordx4 v38, s[12:15], s36 offen lds
  v_mfma_f32_16x16x32_bf16 v[76:79], a[144:147], a[76:79], v[76:79]
  ds_read2st64_b64 a[200:203], v33 offset0:4 offset1:5
  v_mfma_f32_16x16x32_bf16 v[76:79], a[148:151], a[92:95], v[76:79]
  v_add_f32 v5, v5, v68
  v_exp_f32 v69, v69
  v_mfma_f32_16x16x32_bf16 v[76:79], a[152:155], a[108:111], v[76:79]
  ds_read2st64_b64 a[204:207], v33 offset0:6 offset1:7
  v_mfma_f32_16x16x32_bf16 v[76:79], a[156:159], a[124:127], v[76:79]
  buffer_load_dwordx4 v39, s[12:15], s36 offen offset:1024 lds
  v_mfma_f32_16x16x32_bf16 v[80:83], a[160:163], a[0:3], v[48:51]
  v_add_f32 v5, v5, v69
  v_cvt_pk_bf16_f32 v116, v68, v69
  v_mfma_f32_16x16x32_bf16 v[80:83], a[164:167], a[16:19], v[80:83]
  v_exp_f32 v70, v70
  v_mfma_f32_16x16x32_bf16 v[80:83], a[168:171], a[32:35], v[80:83]
  ds_read_b64_tr_b16 a[128:129], v16 offset:0
  ds_read_b64_tr_b16 a[130:131], v16 offset:8192
  v_mfma_f32_16x16x32_bf16 v[80:83], a[172:175], a[48:51], v[80:83]
  buffer_load_dwordx4 v40, s[12:15], s36 offen offset:2048 lds
  v_mfma_f32_16x16x32_bf16 v[80:83], a[176:179], a[64:67], v[80:83]
  v_add_f32 v5, v5, v70
  v_subrev_u32 v8, 65536, v42
  v_mfma_f32_16x16x32_bf16 v[80:83], a[180:183], a[80:83], v[80:83]
  v_exp_f32 v71, v71
  v_mfma_f32_16x16x32_bf16 v[80:83], a[184:187], a[96:99], v[80:83]
  ds_read_b64_tr_b16 a[132:133], v24 offset:0
  ds_read_b64_tr_b16 a[134:135], v24 offset:8192
  v_add_f32 v5, v5, v71
  v_cvt_pk_bf16_f32 v117, v70, v71
  v_mfma_f32_16x16x32_bf16 v[80:83], a[188:191], a[112:115], v[80:83]
  buffer_load_dwordx4 v41, s[12:15], s36 offen offset:3072 lds
  s_add_u32 m0, s32, 102400
  v_mfma_f32_16x16x32_bf16 v[84:87], a[160:163], a[4:7], v[52:55]
  ds_write_b64 v32, v[116:117] offset:19456
  v_mfma_f32_16x16x32_bf16 v[84:87], a[164:167], a[20:23], v[84:87]
  v_exp_f32 v72, v72
  v_mfma_f32_16x16x32_bf16 v[84:87], a[168:171], a[36:39], v[84:87]
  ds_read_b64_tr_b16 a[136:137], v17 offset:0
  ds_read_b64_tr_b16 a[138:139], v17 offset:8192
  v_add_f32 v6, v6, v72
  v_mfma_f32_16x16x32_bf16 v[84:87], a[172:175], a[52:55], v[84:87]
  buffer_load_dwordx4 v38, s[12:15], s37 offen lds
  v_mfma_f32_16x16x32_bf16 v[84:87], a[176:179], a[68:71], v[84:87]
  v_exp_f32 v73, v73
  v_mfma_f32_16x16x32_bf16 v[84:87], a[180:183], a[84:87], v[84:87]
  v_add_f32 v6, v6, v73
  v_cvt_pk_bf16_f32 v120, v72, v73
  v_mfma_f32_16x16x32_bf16 v[84:87], a[184:187], a[100:103], v[84:87]
  ds_read_b64_tr_b16 a[140:141], v25 offset:0
  ds_read_b64_tr_b16 a[142:143], v25 offset:8192
  v_mfma_f32_16x16x32_bf16 v[84:87], a[188:191], a[116:119], v[84:87]
  buffer_load_dwordx4 v39, s[12:15], s37 offen offset:1024 lds
  v_mfma_f32_16x16x32_bf16 v[88:91], a[160:163], a[8:11], v[56:59]
  v_exp_f32 v74, v74
  v_mfma_f32_16x16x32_bf16 v[88:91], a[164:167], a[24:27], v[88:91]
  v_add_f32 v6, v6, v74
  v_exp_f32 v75, v75
  v_mfma_f32_16x16x32_bf16 v[88:91], a[168:171], a[40:43], v[88:91]
  ds_read_b64_tr_b16 a[144:145], v18 offset:0
  ds_read_b64_tr_b16 a[146:147], v18 offset:8192
  v_mfma_f32_16x16x32_bf16 v[88:91], a[172:175], a[56:59], v[88:91]
  buffer_load_dwordx4 v40, s[12:15], s37 offen offset:2048 lds
  v_mfma_f32_16x16x32_bf16 v[88:91], a[176:179], a[72:75], v[88:91]
  v_add_f32 v6, v6, v75
  v_cvt_pk_bf16_f32 v121, v74, v75
  v_mfma_f32_16x16x32_bf16 v[88:91], a[180:183], a[88:91], v[88:91]
  v_exp_f32 v80, v80
  v_mfma_f32_16x16x32_bf16 v[88:91], a[184:187], a[104:107], v[88:91]
  ds_read_b64_tr_b16 a[148:149], v26 offset:0
  ds_read_b64_tr_b16 a[150:151], v26 offset:8192
  v_add_f32 v4, v4, v80
  v_mfma_f32_16x16x32_bf16 v[88:91], a[188:191], a[120:123], v[88:91]
  buffer_load_dwordx4 v41, s[12:15], s37 offen offset:3072 lds
  v_mfma_f32_16x16x32_bf16 v[92:95], a[160:163], a[12:15], v[60:63]
  v_exp_f32 v81, v81
  v_mfma_f32_16x16x32_bf16 v[92:95], a[164:167], a[28:31], v[92:95]
  v_add_f32 v4, v4, v81
  v_cvt_pk_bf16_f32 v114, v80, v81
  v_exp_f32 v82, v82
  v_mfma_f32_16x16x32_bf16 v[92:95], a[168:171], a[44:47], v[92:95]
  ds_read_b64_tr_b16 a[152:153], v19 offset:0
  ds_read_b64_tr_b16 a[154:155], v19 offset:8192
  v_mfma_f32_16x16x32_bf16 v[92:95], a[172:175], a[60:63], v[92:95]
  s_mov_b32 s40, 229376
  s_add_u32 m0, s32, 32768
  v_mfma_f32_16x16x32_bf16 v[92:95], a[176:179], a[76:79], v[92:95]
  buffer_load_dwordx4 v34, s[20:23], s40 offen lds
  v_mfma_f32_16x16x32_bf16 v[92:95], a[180:183], a[92:95], v[92:95]
  v_add_f32 v4, v4, v82
  v_exp_f32 v83, v83
  v_mfma_f32_16x16x32_bf16 v[92:95], a[184:187], a[108:111], v[92:95]
  ds_read_b64_tr_b16 a[156:157], v27 offset:0
  ds_read_b64_tr_b16 a[158:159], v27 offset:8192
  v_mfma_f32_16x16x32_bf16 v[92:95], a[188:191], a[124:127], v[92:95]
  v_add_f32 v4, v4, v83
  s_waitcnt lgkmcnt(8)
  v_mfma_f32_16x16x32_bf16 v[128:131], a[128:131], v[96:99], v[128:131]
  v_cvt_pk_bf16_f32 v115, v82, v83
  v_subrev_u32 v9, 65536, v43
  v_mfma_f32_16x16x32_bf16 v[128:131], a[132:135], a[192:195], v[128:131]
  buffer_load_dwordx4 v35, s[20:23], s40 offen offset:1024 lds
  ds_write_b64 v32, v[114:115] offset:18944
  v_mfma_f32_16x16x32_bf16 v[132:135], a[128:131], v[100:103], v[132:135]
  ds_read_b64_tr_b16 a[160:161], v20 offset:0
  ds_read_b64_tr_b16 a[162:163], v20 offset:8192
  v_mfma_f32_16x16x32_bf16 v[132:135], a[132:135], a[196:199], v[132:135]
  v_exp_f32 v84, v84
  v_mfma_f32_16x16x32_bf16 v[136:139], a[128:131], v[104:107], v[136:139]
  v_add_f32 v5, v5, v84
  v_subrev_u32 v10, 65536, v44
  v_mfma_f32_16x16x32_bf16 v[136:139], a[132:135], a[200:203], v[136:139]
  v_exp_f32 v85, v85
  v_mfma_f32_16x16x32_bf16 v[140:143], a[128:131], v[108:111], v[140:143]
  ds_read_b64_tr_b16 a[164:165], v28 offset:0
  ds_read_b64_tr_b16 a[166:167], v28 offset:8192
  v_mfma_f32_16x16x32_bf16 v[140:143], a[132:135], a[204:207], v[140:143]
  buffer_load_dwordx4 v36, s[20:23], s40 offen offset:2048 lds
  v_mfma_f32_16x16x32_bf16 v[144:147], a[136:139], v[96:99], v[144:147]
  v_add_f32 v5, v5, v85
  v_cvt_pk_bf16_f32 v118, v84, v85
  v_mfma_f32_16x16x32_bf16 v[144:147], a[140:143], a[192:195], v[144:147]
  v_exp_f32 v86, v86
  v_mfma_f32_16x16x32_bf16 v[148:151], a[136:139], v[100:103], v[148:151]
  ds_read_b64_tr_b16 a[168:169], v21 offset:0
  ds_read_b64_tr_b16 a[170:171], v21 offset:8192
  v_mfma_f32_16x16x32_bf16 v[148:151], a[140:143], a[196:199], v[148:151]
  v_add_f32 v5, v5, v86
  v_exp_f32 v87, v87
  v_mfma_f32_16x16x32_bf16 v[152:155], a[136:139], v[104:107], v[152:155]
  buffer_load_dwordx4 v37, s[20:23], s40 offen offset:3072 lds
  s_mov_b32 s40, 344064
  v_mfma_f32_16x16x32_bf16 v[152:155], a[140:143], a[200:203], v[152:155]
  s_add_u32 m0, s32, 36864
  v_add_f32 v5, v5, v87
  v_mfma_f32_16x16x32_bf16 v[156:159], a[136:139], v[108:111], v[156:159]
  ds_read_b64_tr_b16 a[172:173], v29 offset:0
  ds_read_b64_tr_b16 a[174:175], v29 offset:8192
  v_mfma_f32_16x16x32_bf16 v[156:159], a[140:143], a[204:207], v[156:159]
  v_cvt_pk_bf16_f32 v119, v86, v87
  s_waitcnt lgkmcnt(9)
  v_mfma_f32_16x16x32_bf16 v[160:163], a[144:147], v[96:99], v[160:163]
  ds_write_b64 v32, v[118:119] offset:19968
  v_exp_f32 v76, v76
  v_mfma_f32_16x16x32_bf16 v[160:163], a[148:151], a[192:195], v[160:163]
  buffer_load_dwordx4 v34, s[20:23], s40 offen lds
  v_add_f32 v7, v7, v76
  v_mfma_f32_16x16x32_bf16 v[164:167], a[144:147], v[100:103], v[164:167]
  ds_read_b64_tr_b16 a[176:177], v22 offset:0
  ds_read_b64_tr_b16 a[178:179], v22 offset:8192
  v_mfma_f32_16x16x32_bf16 v[164:167], a[148:151], a[196:199], v[164:167]
  v_exp_f32 v77, v77
  v_mfma_f32_16x16x32_bf16 v[168:171], a[144:147], v[104:107], v[168:171]
  s_waitcnt vmcnt(5) lgkmcnt(2)
  s_barrier
  v_mfma_f32_16x16x32_bf16 v[168:171], a[148:151], a[200:203], v[168:171]
  v_add_f32 v7, v7, v77
  v_cvt_pk_bf16_f32 v124, v76, v77
  v_exp_f32 v78, v78
  v_mfma_f32_16x16x32_bf16 v[172:175], a[144:147], v[108:111], v[172:175]
  ds_read_b64_tr_b16 a[180:181], v30 offset:0
  ds_read_b64_tr_b16 a[182:183], v30 offset:8192
  v_mfma_f32_16x16x32_bf16 v[172:175], a[148:151], a[204:207], v[172:175]
  buffer_load_dwordx4 v35, s[20:23], s40 offen offset:1024 lds
  v_mfma_f32_16x16x32_bf16 v[176:179], a[152:155], v[96:99], v[176:179]
  v_add_f32 v7, v7, v78
  ds_read2st64_b64 a[208:211], v33 offset0:36 offset1:37
  v_mfma_f32_16x16x32_bf16 v[176:179], a[156:159], a[192:195], v[176:179]
  v_exp_f32 v79, v79
  v_mfma_f32_16x16x32_bf16 v[180:183], a[152:155], v[100:103], v[180:183]
  ds_read_b64_tr_b16 a[184:185], v23 offset:0
  ds_read_b64_tr_b16 a[186:187], v23 offset:8192
  v_mfma_f32_16x16x32_bf16 v[180:183], a[156:159], a[196:199], v[180:183]
  v_add_f32 v7, v7, v79
  v_cvt_pk_bf16_f32 v125, v78, v79
  v_mfma_f32_16x16x32_bf16 v[184:187], a[152:155], v[104:107], v[184:187]
  buffer_load_dwordx4 v36, s[20:23], s40 offen offset:2048 lds
  v_mfma_f32_16x16x32_bf16 v[184:187], a[156:159], a[200:203], v[184:187]
  ds_write_b64 v32, v[120:121] offset:2048
  v_mfma_f32_16x16x32_bf16 v[188:191], a[152:155], v[108:111], v[188:191]
  ds_read_b64_tr_b16 a[188:189], v31 offset:0
  ds_read_b64_tr_b16 a[190:191], v31 offset:8192
  ds_write_b64 v32, v[124:125] offset:3072
  v_mfma_f32_16x16x32_bf16 v[188:191], a[156:159], a[204:207], v[188:191]
  ds_read2st64_b64 a[212:215], v33 offset0:38 offset1:39
  v_mfma_f32_16x16x32_bf16 v[192:195], a[160:163], v[96:99], v[192:195]
  v_exp_f32 v88, v88
  v_mfma_f32_16x16x32_bf16 v[192:195], a[164:167], a[192:195], v[192:195]
  buffer_load_dwordx4 v37, s[20:23], s40 offen offset:3072 lds
  v_add_f32 v6, v6, v88
  v_mfma_f32_16x16x32_bf16 v[196:199], a[160:163], v[100:103], v[196:199]
  ds_read_b64_tr_b16 a[128:129], v16 offset:32768
  ds_read_b64_tr_b16 a[130:131], v16 offset:40960
  v_exp_f32 v89, v89
  v_mfma_f32_16x16x32_bf16 v[196:199], a[164:167], a[196:199], v[196:199]
  v_add_f32 v6, v6, v89
  v_cvt_pk_bf16_f32 v122, v88, v89
  v_mfma_f32_16x16x32_bf16 v[200:203], a[160:163], v[104:107], v[200:203]
  ds_read_b64_tr_b16 a[132:133], v24 offset:32768
  v_subrev_u32 v11, 65536, v45
  v_mfma_f32_16x16x32_bf16 v[200:203], a[164:167], a[200:203], v[200:203]
  v_exp_f32 v90, v90
  v_mfma_f32_16x16x32_bf16 v[204:207], a[160:163], v[108:111], v[204:207]
  ds_read_b64_tr_b16 a[134:135], v24 offset:40960
  v_add_f32 v6, v6, v90
  v_mfma_f32_16x16x32_bf16 v[204:207], a[164:167], a[204:207], v[204:207]
  ds_read_b64_tr_b16 a[136:137], v17 offset:32768
  v_mfma_f32_16x16x32_bf16 v[208:211], a[168:171], v[96:99], v[208:211]
  v_exp_f32 v91, v91
  v_mfma_f32_16x16x32_bf16 v[208:211], a[172:175], a[192:195], v[208:211]
  ds_read_b64_tr_b16 a[138:139], v17 offset:40960
  v_add_f32 v6, v6, v91
  v_mfma_f32_16x16x32_bf16 v[212:215], a[168:171], v[100:103], v[212:215]
  v_cvt_pk_bf16_f32 v123, v90, v91
  v_mfma_f32_16x16x32_bf16 v[212:215], a[172:175], a[196:199], v[212:215]
  ds_read_b64_tr_b16 a[140:141], v25 offset:32768
  ds_write_b64 v32, v[122:123] offset:2560
  v_mfma_f32_16x16x32_bf16 v[216:219], a[168:171], v[104:107], v[216:219]
  ds_read_b64_tr_b16 a[142:143], v25 offset:40960
  v_mfma_f32_16x16x32_bf16 v[216:219], a[172:175], a[200:203], v[216:219]
  v_exp_f32 v92, v92
  v_mfma_f32_16x16x32_bf16 v[220:223], a[168:171], v[108:111], v[220:223]
  ds_read_b64_tr_b16 a[144:145], v18 offset:32768
  v_add_f32 v7, v7, v92
  v_mfma_f32_16x16x32_bf16 v[220:223], a[172:175], a[204:207], v[220:223]
  v_exp_f32 v93, v93
  s_waitcnt lgkmcnt(12)
  v_mfma_f32_16x16x32_bf16 v[224:227], a[176:179], v[96:99], v[224:227]
  ds_read_b64_tr_b16 a[146:147], v18 offset:40960
  v_add_f32 v7, v7, v93
  v_mfma_f32_16x16x32_bf16 v[224:227], a[180:183], a[192:195], v[224:227]
  ds_read_b64_tr_b16 a[148:149], v26 offset:32768
  v_cvt_pk_bf16_f32 v126, v92, v93
  v_mfma_f32_16x16x32_bf16 v[228:231], a[176:179], v[100:103], v[228:231]
  v_exp_f32 v94, v94
  v_mfma_f32_16x16x32_bf16 v[228:231], a[180:183], a[196:199], v[228:231]
  ds_read_b64_tr_b16 a[150:151], v26 offset:40960
  v_add_f32 v7, v7, v94
  v_mfma_f32_16x16x32_bf16 v[232:235], a[176:179], v[104:107], v[232:235]
  v_exp_f32 v95, v95
  v_mfma_f32_16x16x32_bf16 v[232:235], a[180:183], a[200:203], v[232:235]
  ds_read_b64_tr_b16 a[152:153], v19 offset:32768
  v_add_f32 v7, v7, v95
  v_mfma_f32_16x16x32_bf16 v[236:239], a[176:179], v[108:111], v[236:239]
  ds_read_b64_tr_b16 a[154:155], v19 offset:40960
  v_cvt_pk_bf16_f32 v127, v94, v95
  v_mfma_f32_16x16x32_bf16 v[236:239], a[180:183], a[204:207], v[236:239]
  ds_write_b64 v32, v[126:127] offset:3584
  s_nop 0
  v_mfma_f32_16x16x32_bf16 v[240:243], a[184:187], v[96:99], v[240:243]
  ds_read_b64_tr_b16 a[156:157], v27 offset:32768
  v_permlane16_swap_b32 v4, v5
  v_permlane16_swap_b32 v6, v7
  v_mfma_f32_16x16x32_bf16 v[240:243], a[188:191], a[192:195], v[240:243]
  v_add_f32 v4, v4, v5
  v_add_f32 v6, v6, v7
  s_nop 1
  v_mfma_f32_16x16x32_bf16 v[244:247], a[184:187], v[100:103], v[244:247]
  ds_read_b64_tr_b16 a[158:159], v27 offset:40960
  v_permlane32_swap_b32 v4, v6
  v_add_f32 v4, v4, v6
  v_mfma_f32_16x16x32_bf16 v[244:247], a[188:191], a[196:199], v[244:247]
  ds_write_b32 v1, v4
  v_mfma_f32_16x16x32_bf16 v[248:251], a[184:187], v[104:107], v[248:251]
  v_mfma_f32_16x16x32_bf16 v[248:251], a[188:191], a[200:203], v[248:251]
  s_waitcnt lgkmcnt(0)
  s_barrier
  v_mfma_f32_16x16x32_bf16 v[252:255], a[184:187], v[108:111], v[252:255]
  ds_read2st64_b64 a[216:219], v33 offset0:4 offset1:5
  ds_read2st64_b64 a[220:223], v33 offset0:6 offset1:7
  v_mfma_f32_16x16x32_bf16 v[252:255], a[188:191], a[204:207], v[252:255]
  ds_read_b128 v[64:67], v3 offset:0
  v_mfma_f32_16x16x32_bf16 v[128:131], a[128:131], v[112:115], v[128:131]
  ds_read_b64_tr_b16 a[224:225], v8 offset:0
  ds_read_b64_tr_b16 a[226:227], v8 offset:2048
  s_mov_b32 s40, 28672
  v_mfma_f32_16x16x32_bf16 v[128:131], a[132:135], a[208:211], v[128:131]
  ds_read_b128 v[68:71], v3 offset:256
  ds_read_b128 v[72:75], v3 offset:512
  v_mfma_f32_16x16x32_bf16 v[132:135], a[128:131], v[116:119], v[132:135]
  ds_read_b128 v[76:79], v3 offset:768
  s_add_u32 m0, s32, 65536
  v_mfma_f32_16x16x32_bf16 v[132:135], a[132:135], a[212:215], v[132:135]
  s_cmp_lt_u32 s3, 2
  s_cselect_b64 vcc, -1, 0
  v_lshl_add_u32 v38, v2, 4, s44
  v_mfma_f32_16x16x32_bf16 v[144:147], a[136:139], v[112:115], v[144:147]
  ds_read_b64_tr_b16 a[228:229], v8 offset:4096
  ds_read_b64_tr_b16 a[230:231], v8 offset:6144
  v_lshl_add_u32 v39, v2, 4, s45
  v_mfma_f32_16x16x32_bf16 v[144:147], a[140:143], a[208:211], v[144:147]
  buffer_load_dwordx4 v34, s[20:23], s40 offen lds
  v_mfma_f32_16x16x32_bf16 v[148:151], a[136:139], v[116:119], v[148:151]
  ds_read_b64_tr_b16 a[160:161], v20 offset:32768
  ds_read_b64_tr_b16 a[162:163], v20 offset:40960
  v_mfma_f32_16x16x32_bf16 v[148:151], a[140:143], a[212:215], v[148:151]
  ds_read_b64_tr_b16 a[164:165], v28 offset:32768
  v_mfma_f32_16x16x32_bf16 v[160:163], a[144:147], v[112:115], v[160:163]
  ds_read_b64_tr_b16 a[232:233], v9 offset:0
  ds_read_b64_tr_b16 a[234:235], v9 offset:2048
  s_waitcnt lgkmcnt(7)
  s_barrier
  v_mfma_f32_16x16x32_bf16 v[160:163], a[148:151], a[208:211], v[160:163]
  v_add_f32 v64, v64, v68
  v_add_f32 v72, v72, v76
  v_add_f32 v65, v65, v69
  v_mfma_f32_16x16x32_bf16 v[164:167], a[144:147], v[116:119], v[164:167]
  v_add_f32 v73, v73, v77
  v_add_f32 v66, v66, v70
  v_add_f32 v74, v74, v78
  v_mfma_f32_16x16x32_bf16 v[164:167], a[148:151], a[212:215], v[164:167]
  v_add_f32 v67, v67, v71
  v_add_f32 v75, v75, v79
  v_cndmask_b32 v48, v72, v64, vcc
  v_mfma_f32_16x16x32_bf16 v[176:179], a[152:155], v[112:115], v[176:179]
  ds_read_b64_tr_b16 a[236:237], v9 offset:4096
  ds_read_b64_tr_b16 a[238:239], v9 offset:6144
  v_cndmask_b32 v49, v73, v65, vcc
  v_mfma_f32_16x16x32_bf16 v[176:179], a[156:159], a[208:211], v[176:179]
  v_cndmask_b32 v50, v74, v66, vcc
  v_cndmask_b32 v51, v75, v67, vcc
  v_mfma_f32_16x16x32_bf16 v[180:183], a[152:155], v[116:119], v[180:183]
  v_rcp_f32 v48, v48
  v_max3_f32 v64, v64, v65, v66
  v_mfma_f32_16x16x32_bf16 v[180:183], a[156:159], a[212:215], v[180:183]
  v_rcp_f32 v49, v49
  v_mfma_f32_16x16x32_bf16 v[136:139], a[128:131], v[120:123], v[136:139]
  ds_read_b64_tr_b16 a[240:241], v10 offset:0
  ds_read_b64_tr_b16 a[242:243], v10 offset:2048
  v_max3_f32 v72, v72, v73, v74
  v_mfma_f32_16x16x32_bf16 v[136:139], a[132:135], a[216:219], v[136:139]
  v_rcp_f32 v50, v50
  v_max3_f32 v64, v64, v67, v75
  v_mfma_f32_16x16x32_bf16 v[140:143], a[128:131], v[124:127], v[140:143]
  v_rcp_f32 v51, v51
  v_max_f32 v64, v64, v72
  v_mfma_f32_16x16x32_bf16 v[140:143], a[132:135], a[220:223], v[140:143]
  v_cmp_lt_f32 vcc, s62, v64
  buffer_load_dwordx4 v35, s[20:23], s40 offen offset:1024 lds
  v_mfma_f32_16x16x32_bf16 v[152:155], a[136:139], v[120:123], v[152:155]
  ds_read_b64_tr_b16 a[244:245], v10 offset:4096
  ds_read_b64_tr_b16 a[246:247], v10 offset:6144
  v_mul_f32 v128, v128, v48
  v_mfma_f32_16x16x32_bf16 v[152:155], a[140:143], a[216:219], v[152:155]
  ds_read_b64_tr_b16 a[166:167], v28 offset:40960
  ds_read_b64_tr_b16 a[168:169], v21 offset:32768
  v_mul_f32 v129, v129, v48
  v_mfma_f32_16x16x32_bf16 v[156:159], a[136:139], v[124:127], v[156:159]
  s_cbranch_vccnz K1_FB
  ds_read_b64_tr_b16 a[170:171], v21 offset:40960
  v_mul_f32 v130, v130, v48
  v_mfma_f32_16x16x32_bf16 v[156:159], a[140:143], a[220:223], v[156:159]
  buffer_load_dwordx4 v36, s[20:23], s40 offen offset:2048 lds
  v_mul_f32 v131, v131, v48
  v_mfma_f32_16x16x32_bf16 v[168:171], a[144:147], v[120:123], v[168:171]
  ds_read_b64_tr_b16 a[248:249], v11 offset:0
  ds_read_b64_tr_b16 a[250:251], v11 offset:2048
  v_mul_f32 v144, v144, v48
  v_mfma_f32_16x16x32_bf16 v[168:171], a[148:151], a[216:219], v[168:171]
  ds_read_b64_tr_b16 a[172:173], v29 offset:32768
  ds_read_b64_tr_b16 a[174:175], v29 offset:40960
  v_mul_f32 v145, v145, v48
  v_mfma_f32_16x16x32_bf16 v[172:175], a[144:147], v[124:127], v[172:175]
  ds_read_b64_tr_b16 a[176:177], v22 offset:32768
  ds_read_b64_tr_b16 a[178:179], v22 offset:40960
  v_mul_f32 v146, v146, v48
  v_mfma_f32_16x16x32_bf16 v[172:175], a[148:151], a[220:223], v[172:175]
  buffer_load_dwordx4 v37, s[20:23], s40 offen offset:3072 lds
  s_mov_b32 s40, 143360
  v_mfma_f32_16x16x32_bf16 v[184:187], a[152:155], v[120:123], v[184:187]
  ds_read_b64_tr_b16 a[252:253], v11 offset:4096
  ds_read_b64_tr_b16 a[254:255], v11 offset:6144
  s_add_u32 m0, s32, 69632
  v_mfma_f32_16x16x32_bf16 v[184:187], a[156:159], a[216:219], v[184:187]
  ds_read_b64_tr_b16 a[180:181], v30 offset:32768
  ds_read_b64_tr_b16 a[182:183], v30 offset:40960
  v_mul_f32 v147, v147, v48
  v_mfma_f32_16x16x32_bf16 v[188:191], a[152:155], v[124:127], v[188:191]
  ds_read_b64_tr_b16 a[184:185], v23 offset:32768
  ds_read_b64_tr_b16 a[186:187], v23 offset:40960
  v_cvt_pk_bf16_f32 v128, v128, v129
  v_mfma_f32_16x16x32_bf16 v[188:191], a[156:159], a[220:223], v[188:191]
  buffer_load_dwordx4 v34, s[20:23], s40 offen lds
  s_waitcnt lgkmcnt(14)
  v_mfma_f32_16x16x32_bf16 v[192:195], a[160:163], v[112:115], v[192:195]
  ds_read_b64_tr_b16 a[188:189], v31 offset:32768
  ds_read_b64_tr_b16 a[190:191], v31 offset:40960
  v_cvt_pk_bf16_f32 v129, v130, v131
  v_mfma_f32_16x16x32_bf16 v[192:195], a[164:167], a[208:211], v[192:195]
  v_cvt_pk_bf16_f32 v130, v144, v145
  v_cvt_pk_bf16_f32 v131, v146, v147
  v_mfma_f32_16x16x32_bf16 v[196:199], a[160:163], v[116:119], v[196:199]
  ds_write_b128 v38, v[128:131] offset:0
  v_mul_f32 v132, v132, v49
  v_mfma_f32_16x16x32_bf16 v[196:199], a[164:167], a[212:215], v[196:199]
  buffer_load_dwordx4 v35, s[20:23], s40 offen offset:1024 lds
  v_mul_f32 v133, v133, v49
  v_mfma_f32_16x16x32_bf16 v[200:203], a[160:163], v[120:123], v[200:203]
  v_mul_f32 v134, v134, v49
  v_mul_f32 v135, v135, v49
  v_mul_f32 v148, v148, v49
  v_mfma_f32_16x16x32_bf16 v[200:203], a[164:167], a[216:219], v[200:203]
  v_mul_f32 v149, v149, v49
  v_mul_f32 v150, v150, v49
  v_mul_f32 v151, v151, v49
  v_mfma_f32_16x16x32_bf16 v[204:207], a[160:163], v[124:127], v[204:207]
  v_cvt_pk_bf16_f32 v132, v132, v133
  v_cvt_pk_bf16_f32 v133, v134, v135
  v_cvt_pk_bf16_f32 v134, v148, v149
  v_mfma_f32_16x16x32_bf16 v[204:207], a[164:167], a[220:223], v[204:207]
  buffer_load_dwordx4 v36, s[20:23], s40 offen offset:2048 lds
  s_waitcnt lgkmcnt(11)
  v_mfma_f32_16x16x32_bf16 v[208:211], a[168:171], v[112:115], v[208:211]
  v_cvt_pk_bf16_f32 v135, v150, v151
  ds_write_b128 v38, v[132:135] offset:1024
  v_mfma_f32_16x16x32_bf16 v[208:211], a[172:175], a[208:211], v[208:211]
  v_mul_f32 v136, v136, v50
  v_mul_f32 v137, v137, v50
  v_mul_f32 v138, v138, v50
  v_mfma_f32_16x16x32_bf16 v[212:215], a[168:171], v[116:119], v[212:215]
  v_mul_f32 v139, v139, v50
  v_mul_f32 v152, v152, v50
  v_mul_f32 v153, v153, v50
  v_mfma_f32_16x16x32_bf16 v[212:215], a[172:175], a[212:215], v[212:215]
  buffer_load_dwordx4 v37, s[20:23], s40 offen offset:3072 lds
  v_mul_f32 v154, v154, v50
  v_mfma_f32_16x16x32_bf16 v[216:219], a[168:171], v[120:123], v[216:219]
  v_mul_f32 v155, v155, v50
  v_cvt_pk_bf16_f32 v136, v136, v137
  v_cvt_pk_bf16_f32 v137, v138, v139
  v_mfma_f32_16x16x32_bf16 v[216:219], a[172:175], a[216:219], v[216:219]
  v_cvt_pk_bf16_f32 v138, v152, v153
  v_cvt_pk_bf16_f32 v139, v154, v155
  v_mfma_f32_16x16x32_bf16 v[220:223], a[168:171], v[124:127], v[220:223]
  ds_write_b128 v38, v[136:139] offset:2048
  v_mul_f32 v140, v140, v51
  v_mfma_f32_16x16x32_bf16 v[220:223], a[172:175], a[220:223], v[220:223]
  v_mul_f32 v141, v141, v51
  v_mul_f32 v142, v142, v51
  s_waitcnt lgkmcnt(7)
  v_mfma_f32_16x16x32_bf16 v[224:227], a[176:179], v[112:115], v[224:227]
  v_mul_f32 v143, v143, v51
  v_mul_f32 v156, v156, v51
  v_mul_f32 v157, v157, v51
  v_mfma_f32_16x16x32_bf16 v[224:227], a[180:183], a[208:211], v[224:227]
  v_mul_f32 v158, v158, v51
  v_mul_f32 v159, v159, v51
  v_cvt_pk_bf16_f32 v140, v140, v141
  v_mfma_f32_16x16x32_bf16 v[228:231], a[176:179], v[116:119], v[228:231]
  v_cvt_pk_bf16_f32 v141, v142, v143
  v_cvt_pk_bf16_f32 v142, v156, v157
  v_cvt_pk_bf16_f32 v143, v158, v159
  v_mfma_f32_16x16x32_bf16 v[228:231], a[180:183], a[212:215], v[228:231]
  ds_write_b128 v38, v[140:143] offset:3072
  v_mfma_f32_16x16x32_bf16 v[232:235], a[176:179], v[120:123], v[232:235]
  v_mfma_f32_16x16x32_bf16 v[232:235], a[180:183], a[216:219], v[232:235]
  s_waitcnt lgkmcnt(0)
  s_barrier
  s_mov_b32 s40, 258048
  v_mfma_f32_16x16x32_bf16 v[236:239], a[176:179], v[124:127], v[236:239]
  ds_read_b128 a[0:3], v39 offset:0
  ds_read_b128 a[4:7], v39 offset:1024
  v_mfma_f32_16x16x32_bf16 v[236:239], a[180:183], a[220:223], v[236:239]
  ds_read_b128 a[8:11], v39 offset:2048
  v_mfma_f32_16x16x32_bf16 v[240:243], a[184:187], v[112:115], v[240:243]
  ds_read_b128 a[12:15], v39 offset:3072
  ds_read_b128 a[16:19], v39 offset:4096
  v_mfma_f32_16x16x32_bf16 v[240:243], a[188:191], a[208:211], v[240:243]
  ds_read_b128 a[20:23], v39 offset:5120
  ds_read_b128 a[24:27], v39 offset:6144
  v_mfma_f32_16x16x32_bf16 v[244:247], a[184:187], v[116:119], v[244:247]
  ds_read_b128 a[28:31], v39 offset:7168
  s_add_u32 m0, s32, 0
  v_mfma_f32_16x16x32_bf16 v[244:247], a[188:191], a[212:215], v[244:247]
  buffer_load_dwordx4 v34, s[20:23], s40 offen lds
  v_mul_f32 v160, v160, v48
  v_mfma_f32_16x16x32_bf16 v[248:251], a[184:187], v[120:123], v[248:251]
  ds_read_b128 a[32:35], v39 offset:8192
  v_mul_f32 v161, v161, v48
  v_mfma_f32_16x16x32_bf16 v[248:251], a[188:191], a[216:219], v[248:251]
  v_mul_f32 v162, v162, v48
  v_mul_f32 v163, v163, v48
  v_mul_f32 v176, v176, v48
  v_mfma_f32_16x16x32_bf16 v[252:255], a[184:187], v[124:127], v[252:255]
  ds_read_b128 a[36:39], v39 offset:9216
  v_mul_f32 v177, v177, v48
  v_mfma_f32_16x16x32_bf16 v[252:255], a[188:191], a[220:223], v[252:255]
  buffer_load_dwordx4 v35, s[20:23], s40 offen offset:1024 lds
  s_waitcnt lgkmcnt(2)
  v_mfma_f32_16x16x32_bf16 v[64:67], a[224:227], a[0:3], 0
  v_mul_f32 v178, v178, v48
  v_mul_f32 v179, v179, v48
  v_cvt_pk_bf16_f32 v160, v160, v161
  v_mfma_f32_16x16x32_bf16 v[64:67], a[228:231], a[16:19], v[64:67]
  ds_read_b128 a[40:43], v39 offset:10240
  v_cvt_pk_bf16_f32 v161, v162, v163
  v_mfma_f32_16x16x32_bf16 v[68:71], a[224:227], a[4:7], 0
  v_cvt_pk_bf16_f32 v162, v176, v177
  v_cvt_pk_bf16_f32 v163, v178, v179
  v_mfma_f32_16x16x32_bf16 v[68:71], a[228:231], a[20:23], v[68:71]
  buffer_load_dwordx4 v36, s[20:23], s40 offen offset:2048 lds
  v_mfma_f32_16x16x32_bf16 v[72:75], a[224:227], a[8:11], 0
  ds_read_b128 a[44:47], v39 offset:11264
  v_mfma_f32_16x16x32_bf16 v[72:75], a[228:231], a[24:27], v[72:75]
  ds_write_b128 v38, v[160:163] offset:16384
  v_mul_f32 v164, v164, v49
  v_mfma_f32_16x16x32_bf16 v[76:79], a[224:227], a[12:15], 0
  ds_read_b128 a[48:51], v39 offset:12288
  v_mul_f32 v165, v165, v49
  v_mfma_f32_16x16x32_bf16 v[76:79], a[228:231], a[28:31], v[76:79]
  buffer_load_dwordx4 v37, s[20:23], s40 offen offset:3072 lds
  v_mfma_f32_16x16x32_bf16 v[80:83], a[232:235], a[0:3], 0
  s_mov_b32 s40, 372736
  s_add_u32 m0, s32, 4096
  v_mul_f32 v166, v166, v49
  v_mfma_f32_16x16x32_bf16 v[80:83], a[236:239], a[16:19], v[80:83]
  v_mul_f32 v167, v167, v49
  v_mul_f32 v180, v180, v49
  v_mul_f32 v181, v181, v49
  v_mfma_f32_16x16x32_bf16 v[84:87], a[232:235], a[4:7], 0
  ds_read_b128 a[52:55], v39 offset:13312
  v_mul_f32 v182, v182, v49
  v_mfma_f32_16x16x32_bf16 v[84:87], a[236:239], a[20:23], v[84:87]
  buffer_load_dwordx4 v34, s[20:23], s40 offen lds
  v_mul_f32 v183, v183, v49
  v_mfma_f32_16x16x32_bf16 v[88:91], a[232:235], a[8:11], 0
  v_cvt_pk_bf16_f32 v164, v164, v165
  v_cvt_pk_bf16_f32 v165, v166, v167
  v_cvt_pk_bf16_f32 v166, v180, v181
  v_mfma_f32_16x16x32_bf16 v[88:91], a[236:239], a[24:27], v[88:91]
  ds_read_b128 a[56:59], v39 offset:14336
  v_cvt_pk_bf16_f32 v167, v182, v183
  v_mfma_f32_16x16x32_bf16 v[92:95], a[232:235], a[12:15], 0
  ds_write_b128 v38, v[164:167] offset:17408
  v_mul_f32 v168, v168, v50
  v_mfma_f32_16x16x32_bf16 v[92:95], a[236:239], a[28:31], v[92:95]
  buffer_load_dwordx4 v35, s[20:23], s40 offen offset:1024 lds
  v_mfma_f32_16x16x32_bf16 v[96:99], a[240:243], a[0:3], 0
  s_waitcnt vmcnt(14)
  ds_read_b64_tr_b16 a[224:225], v8 offset:32768
  ds_read_b64_tr_b16 a[226:227], v8 offset:34816
  v_mul_f32 v169, v169, v50
  v_mfma_f32_16x16x32_bf16 v[96:99], a[244:247], a[16:19], v[96:99]
  ds_read_b128 a[60:63], v39 offset:15360
  v_mul_f32 v170, v170, v50
  v_mfma_f32_16x16x32_bf16 v[100:103], a[240:243], a[4:7], 0
  ds_read_b64_tr_b16 a[228:229], v8 offset:36864
  ds_read_b64_tr_b16 a[230:231], v8 offset:38912
  v_mul_f32 v171, v171, v50
  v_mfma_f32_16x16x32_bf16 v[100:103], a[244:247], a[20:23], v[100:103]
  buffer_load_dwordx4 v36, s[20:23], s40 offen offset:2048 lds
  v_mul_f32 v184, v184, v50
  v_mfma_f32_16x16x32_bf16 v[104:107], a[240:243], a[8:11], 0
  v_mul_f32 v185, v185, v50
  v_mul_f32 v186, v186, v50
  v_mul_f32 v187, v187, v50
  v_mfma_f32_16x16x32_bf16 v[104:107], a[244:247], a[24:27], v[104:107]
  v_cvt_pk_bf16_f32 v168, v168, v169
  v_cvt_pk_bf16_f32 v169, v170, v171
  v_cvt_pk_bf16_f32 v170, v184, v185
  v_mfma_f32_16x16x32_bf16 v[108:111], a[240:243], a[12:15], 0
  v_cvt_pk_bf16_f32 v171, v186, v187
  ds_write_b128 v38, v[168:171] offset:18432
  v_mfma_f32_16x16x32_bf16 v[108:111], a[244:247], a[28:31], v[108:111]
  buffer_load_dwordx4 v37, s[20:23], s40 offen offset:3072 lds
  v_mfma_f32_16x16x32_bf16 v[112:115], a[248:251], a[0:3], 0
  ds_read_b64_tr_b16 a[232:233], v9 offset:32768
  ds_read_b64_tr_b16 a[234:235], v9 offset:34816
  v_mul_f32 v172, v172, v51
  v_mfma_f32_16x16x32_bf16 v[112:115], a[252:255], a[16:19], v[112:115]
  v_mul_f32 v173, v173, v51
  v_mul_f32 v174, v174, v51
  v_mul_f32 v175, v175, v51
  v_mfma_f32_16x16x32_bf16 v[116:119], a[248:251], a[4:7], 0
  ds_read_b64_tr_b16 a[236:237], v9 offset:36864
  ds_read_b64_tr_b16 a[238:239], v9 offset:38912
  v_mul_f32 v188, v188, v51
  v_mfma_f32_16x16x32_bf16 v[116:119], a[252:255], a[20:23], v[116:119]
  s_mov_b32 s40, 57344
  s_add_u32 m0, s32, 98304
  v_mul_f32 v189, v189, v51
  v_mfma_f32_16x16x32_bf16 v[120:123], a[248:251], a[8:11], 0
  buffer_load_dwordx4 v34, s[20:23], s40 offen lds
  v_mul_f32 v190, v190, v51
  v_mfma_f32_16x16x32_bf16 v[120:123], a[252:255], a[24:27], v[120:123]
  v_mul_f32 v191, v191, v51
  v_cvt_pk_bf16_f32 v172, v172, v173
  v_cvt_pk_bf16_f32 v173, v174, v175
  v_mfma_f32_16x16x32_bf16 v[124:127], a[248:251], a[12:15], 0
  v_cvt_pk_bf16_f32 v174, v188, v189
  v_cvt_pk_bf16_f32 v175, v190, v191
  v_mfma_f32_16x16x32_bf16 v[124:127], a[252:255], a[28:31], v[124:127]
  ds_write_b128 v38, v[172:175] offset:19456
  s_waitcnt lgkmcnt(6)
  v_mfma_f32_16x16x32_bf16 v[64:67], a[224:227], a[32:35], v[64:67]
  ds_read_b64_tr_b16 a[240:241], v10 offset:32768
  ds_read_b64_tr_b16 a[242:243], v10 offset:34816
  v_mfma_f32_16x16x32_bf16 v[64:67], a[228:231], a[48:51], v[64:67]
  buffer_load_dwordx4 v35, s[20:23], s40 offen offset:1024 lds
  s_waitcnt lgkmcnt(2)
  s_barrier
  v_mfma_f32_16x16x32_bf16 v[68:71], a[224:227], a[36:39], v[68:71]
  ds_read_b64_tr_b16 a[244:245], v10 offset:36864
  ds_read_b64_tr_b16 a[246:247], v10 offset:38912
  v_mul_f32 v192, v192, v48
  v_mfma_f32_16x16x32_bf16 v[68:71], a[228:231], a[52:55], v[68:71]
  v_add_u32 v12, 65536, v42
  v_add_u32 v13, 65536, v43
  v_mul_f32 v193, v193, v48
  v_mfma_f32_16x16x32_bf16 v[72:75], a[224:227], a[40:43], v[72:75]
  v_add_u32 v14, 65536, v44
  v_add_u32 v15, 65536, v45
  v_mul_f32 v194, v194, v48
  v_mfma_f32_16x16x32_bf16 v[72:75], a[228:231], a[56:59], v[72:75]
  buffer_load_dwordx4 v36, s[20:23], s40 offen offset:2048 lds
  v_mul_f32 v195, v195, v48
  v_mfma_f32_16x16x32_bf16 v[76:79], a[224:227], a[44:47], v[76:79]
  ds_read_b128 a[64:67], v39 offset:16384
  ds_read_b128 a[68:71], v39 offset:17408
  v_mfma_f32_16x16x32_bf16 v[76:79], a[228:231], a[60:63], v[76:79]
  ds_read_b128 a[72:75], v39 offset:18432
  v_mfma_f32_16x16x32_bf16 v[80:83], a[232:235], a[32:35], v[80:83]
  ds_read_b64_tr_b16 a[248:249], v11 offset:32768
  ds_read_b64_tr_b16 a[250:251], v11 offset:34816
  v_mul_f32 v208, v208, v48
  v_mfma_f32_16x16x32_bf16 v[80:83], a[236:239], a[48:51], v[80:83]
  buffer_load_dwordx4 v37, s[20:23], s40 offen offset:3072 lds
  s_mov_b32 s40, 172032
  v_mfma_f32_16x16x32_bf16 v[84:87], a[232:235], a[36:39], v[84:87]
  ds_read_b64_tr_b16 a[252:253], v11 offset:36864
  ds_read_b64_tr_b16 a[254:255], v11 offset:38912
  s_add_u32 m0, s32, 102400
  v_mfma_f32_16x16x32_bf16 v[84:87], a[236:239], a[52:55], v[84:87]
  ds_read_b128 a[76:79], v39 offset:19456
  ds_read_b128 a[80:83], v39 offset:20480
  v_mfma_f32_16x16x32_bf16 v[88:91], a[232:235], a[40:43], v[88:91]
  ds_read_b128 a[84:87], v39 offset:21504
  ds_read_b128 a[88:91], v39 offset:22528
  v_mfma_f32_16x16x32_bf16 v[88:91], a[236:239], a[56:59], v[88:91]
  buffer_load_dwordx4 v34, s[20:23], s40 offen lds
  v_mul_f32 v209, v209, v48
  v_mfma_f32_16x16x32_bf16 v[92:95], a[232:235], a[44:47], v[92:95]
  ds_read_b128 a[92:95], v39 offset:23552
  v_mul_f32 v210, v210, v48
  v_mfma_f32_16x16x32_bf16 v[92:95], a[236:239], a[60:63], v[92:95]
  v_mul_f32 v211, v211, v48
  v_cvt_pk_bf16_f32 v192, v192, v193
  s_waitcnt lgkmcnt(12)
  v_mfma_f32_16x16x32_bf16 v[96:99], a[240:243], a[32:35], v[96:99]
  s_waitcnt vmcnt(13)
  ds_read_b64_tr_b16 a[224:225], v42 offset:0
  ds_read_b64_tr_b16 a[226:227], v42 offset:2048
  v_cvt_pk_bf16_f32 v193, v194, v195
  v_mfma_f32_16x16x32_bf16 v[96:99], a[244:247], a[48:51], v[96:99]
  buffer_load_dwordx4 v35, s[20:23], s40 offen offset:1024 lds
  v_cvt_pk_bf16_f32 v194, v208, v209
  v_mfma_f32_16x16x32_bf16 v[100:103], a[240:243], a[36:39], v[100:103]
  ds_read_b64_tr_b16 a[228:229], v42 offset:4096
  ds_read_b64_tr_b16 a[230:231], v42 offset:6144
  v_cvt_pk_bf16_f32 v195, v210, v211
  v_mfma_f32_16x16x32_bf16 v[100:103], a[244:247], a[52:55], v[100:103]
  ds_write_b128 v38, v[192:195] offset:0
  v_mul_f32 v196, v196, v49
  v_mfma_f32_16x16x32_bf16 v[104:107], a[240:243], a[40:43], v[104:107]
  v_mul_f32 v197, v197, v49
  v_mul_f32 v198, v198, v49
  v_mul_f32 v199, v199, v49
  v_mfma_f32_16x16x32_bf16 v[104:107], a[244:247], a[56:59], v[104:107]
  buffer_load_dwordx4 v36, s[20:23], s40 offen offset:2048 lds
  v_mul_f32 v212, v212, v49
  v_mfma_f32_16x16x32_bf16 v[108:111], a[240:243], a[44:47], v[108:111]
  v_mul_f32 v213, v213, v49
  v_mul_f32 v214, v214, v49
  v_mul_f32 v215, v215, v49
  v_mfma_f32_16x16x32_bf16 v[108:111], a[244:247], a[60:63], v[108:111]
  v_cvt_pk_bf16_f32 v196, v196, v197
  v_cvt_pk_bf16_f32 v197, v198, v199
  s_waitcnt lgkmcnt(10)
  v_mfma_f32_16x16x32_bf16 v[112:115], a[248:251], a[32:35], v[112:115]
  ds_read_b64_tr_b16 a[232:233], v43 offset:0
  ds_read_b64_tr_b16 a[234:235], v43 offset:2048
  v_cvt_pk_bf16_f32 v198, v212, v213
  v_mfma_f32_16x16x32_bf16 v[112:115], a[252:255], a[48:51], v[112:115]
  buffer_load_dwordx4 v37, s[20:23], s40 offen offset:3072 lds
  v_cvt_pk_bf16_f32 v199, v214, v215
  v_mfma_f32_16x16x32_bf16 v[116:119], a[248:251], a[36:39], v[116:119]
  ds_read_b64_tr_b16 a[236:237], v43 offset:4096
  ds_read_b64_tr_b16 a[238:239], v43 offset:6144
  v_mfma_f32_16x16x32_bf16 v[116:119], a[252:255], a[52:55], v[116:119]
  ds_write_b128 v38, v[196:199] offset:1024
  v_mul_f32 v200, v200, v50
  v_mfma_f32_16x16x32_bf16 v[120:123], a[248:251], a[40:43], v[120:123]
  ds_read_b128 a[96:99], v39 offset:24576
  ds_read_b128 a[100:103], v39 offset:25600
  v_mfma_f32_16x16x32_bf16 v[120:123], a[252:255], a[56:59], v[120:123]
  s_mov_b32 s40, 286720
  s_add_u32 m0, s32, 32768
  v_mul_f32 v201, v201, v50
  v_mfma_f32_16x16x32_bf16 v[124:127], a[248:251], a[44:47], v[124:127]
  buffer_load_dwordx4 v34, s[20:23], s40 offen lds
  v_mul_f32 v202, v202, v50
  v_mfma_f32_16x16x32_bf16 v[124:127], a[252:255], a[60:63], v[124:127]
  ds_read_b128 a[104:107], v39 offset:26624
  s_waitcnt lgkmcnt(9)
  v_mfma_f32_16x16x32_bf16 v[64:67], a[224:227], a[64:67], v[64:67]
  ds_read_b64_tr_b16 a[240:241], v44 offset:0
  ds_read_b64_tr_b16 a[242:243], v44 offset:2048
  v_mul_f32 v203, v203, v50
  v_mfma_f32_16x16x32_bf16 v[64:67], a[228:231], a[80:83], v[64:67]
  ds_read_b128 a[108:111], v39 offset:27648
  ds_read_b128 a[112:115], v39 offset:28672
  v_mfma_f32_16x16x32_bf16 v[68:71], a[224:227], a[68:71], v[68:71]
  ds_read_b64_tr_b16 a[244:245], v44 offset:4096
  ds_read_b64_tr_b16 a[246:247], v44 offset:6144
  v_mul_f32 v216, v216, v50
  v_mfma_f32_16x16x32_bf16 v[68:71], a[228:231], a[84:87], v[68:71]
  buffer_load_dwordx4 v35, s[20:23], s40 offen offset:1024 lds
  v_mul_f32 v217, v217, v50
  v_mfma_f32_16x16x32_bf16 v[72:75], a[224:227], a[72:75], v[72:75]
  ds_read_b128 a[116:119], v39 offset:29696
  ds_read_b128 a[120:123], v39 offset:30720
  v_mfma_f32_16x16x32_bf16 v[72:75], a[228:231], a[88:91], v[72:75]
  ds_read_b128 a[124:127], v39 offset:31744
  v_mul_f32 v218, v218, v50
  v_mfma_f32_16x16x32_bf16 v[76:79], a[224:227], a[76:79], v[76:79]
  v_mul_f32 v219, v219, v50
  v_cvt_pk_bf16_f32 v200, v200, v201
  v_cvt_pk_bf16_f32 v201, v202, v203
  v_mfma_f32_16x16x32_bf16 v[76:79], a[228:231], a[92:95], v[76:79]
  buffer_load_dwordx4 v36, s[20:23], s40 offen offset:2048 lds
  s_waitcnt lgkmcnt(13)
  v_mfma_f32_16x16x32_bf16 v[80:83], a[232:235], a[64:67], v[80:83]
  ds_read_b64_tr_b16 a[248:249], v45 offset:0
  ds_read_b64_tr_b16 a[250:251], v45 offset:2048
  v_cvt_pk_bf16_f32 v202, v216, v217
  v_mfma_f32_16x16x32_bf16 v[80:83], a[236:239], a[80:83], v[80:83]
  v_cvt_pk_bf16_f32 v203, v218, v219
  ds_write_b128 v38, v[200:203] offset:2048
  v_mfma_f32_16x16x32_bf16 v[84:87], a[232:235], a[68:71], v[84:87]
  ds_read_b64_tr_b16 a[252:253], v45 offset:4096
  ds_read_b64_tr_b16 a[254:255], v45 offset:6144
  v_mul_f32 v204, v204, v51
  v_mfma_f32_16x16x32_bf16 v[84:87], a[236:239], a[84:87], v[84:87]
  buffer_load_dwordx4 v37, s[20:23], s40 offen offset:3072 lds
  s_mov_b32 s40, 401408
  v_mfma_f32_16x16x32_bf16 v[88:91], a[232:235], a[72:75], v[88:91]
  s_add_u32 m0, s32, 36864
  v_mul_f32 v205, v205, v51
  v_mul_f32 v206, v206, v51
  v_mfma_f32_16x16x32_bf16 v[88:91], a[236:239], a[88:91], v[88:91]
  v_mul_f32 v207, v207, v51
  v_mul_f32 v220, v220, v51
  v_mul_f32 v221, v221, v51
  v_mfma_f32_16x16x32_bf16 v[92:95], a[232:235], a[76:79], v[92:95]
  v_mul_f32 v222, v222, v51
  v_mul_f32 v223, v223, v51
  v_cvt_pk_bf16_f32 v204, v204, v205
  v_mfma_f32_16x16x32_bf16 v[92:95], a[236:239], a[92:95], v[92:95]
  buffer_load_dwordx4 v34, s[20:23], s40 offen lds
  s_waitcnt lgkmcnt(8)
  v_mfma_f32_16x16x32_bf16 v[96:99], a[240:243], a[64:67], v[96:99]
  s_waitcnt vmcnt(13)
  ds_read_b64_tr_b16 a[224:225], v8 offset:0
  ds_read_b64_tr_b16 a[226:227], v8 offset:2048
  v_cvt_pk_bf16_f32 v205, v206, v207
  v_mfma_f32_16x16x32_bf16 v[96:99], a[244:247], a[80:83], v[96:99]
  v_cvt_pk_bf16_f32 v206, v220, v221
  v_cvt_pk_bf16_f32 v207, v222, v223
  v_mfma_f32_16x16x32_bf16 v[100:103], a[240:243], a[68:71], v[100:103]
  ds_read_b64_tr_b16 a[228:229], v8 offset:4096
  ds_read_b64_tr_b16 a[230:231], v8 offset:6144
  v_mfma_f32_16x16x32_bf16 v[100:103], a[244:247], a[84:87], v[100:103]
  buffer_load_dwordx4 v35, s[20:23], s40 offen offset:1024 lds
  v_mfma_f32_16x16x32_bf16 v[104:107], a[240:243], a[72:75], v[104:107]
  ds_write_b128 v38, v[204:207] offset:3072
  v_mfma_f32_16x16x32_bf16 v[104:107], a[244:247], a[88:91], v[104:107]
  s_mul_i32 s41, s3, 96
  s_add_u32 s41, s41, 512
  v_mfma_f32_16x16x32_bf16 v[108:111], a[240:243], a[76:79], v[108:111]
  s_waitcnt lgkmcnt(0)
  s_barrier
  v_mfma_f32_16x16x32_bf16 v[108:111], a[244:247], a[92:95], v[108:111]
  buffer_load_dwordx4 v36, s[20:23], s40 offen offset:2048 lds
  v_mfma_f32_16x16x32_bf16 v[112:115], a[248:251], a[64:67], v[112:115]
  ds_read_b64_tr_b16 a[232:233], v9 offset:0
  ds_read_b64_tr_b16 a[234:235], v9 offset:2048
  v_mul_f32 v224, v224, v48
  v_mfma_f32_16x16x32_bf16 v[112:115], a[252:255], a[80:83], v[112:115]
  ds_read_b128 a[128:131], v39 offset:0
  ds_read_b128 a[132:135], v39 offset:1024
  v_mfma_f32_16x16x32_bf16 v[116:119], a[248:251], a[68:71], v[116:119]
  ds_read_b64_tr_b16 a[236:237], v9 offset:4096
  ds_read_b64_tr_b16 a[238:239], v9 offset:6144
  v_mul_f32 v225, v225, v48
  v_mfma_f32_16x16x32_bf16 v[116:119], a[252:255], a[84:87], v[116:119]
  buffer_load_dwordx4 v37, s[20:23], s40 offen offset:3072 lds
  v_mul_f32 v226, v226, v48
  v_mfma_f32_16x16x32_bf16 v[120:123], a[248:251], a[72:75], v[120:123]
  ds_read_b128 a[136:139], v39 offset:2048
  ds_read_b128 a[140:143], v39 offset:3072
  v_mfma_f32_16x16x32_bf16 v[120:123], a[252:255], a[88:91], v[120:123]
  ds_read_b128 a[144:147], v39 offset:4096
  ds_read_b128 a[148:151], v39 offset:5120
  v_mfma_f32_16x16x32_bf16 v[124:127], a[248:251], a[76:79], v[124:127]
  ds_read_b128 a[152:155], v39 offset:6144
  ds_read_b128 a[156:159], v39 offset:7168
  v_mfma_f32_16x16x32_bf16 v[124:127], a[252:255], a[92:95], v[124:127]
  s_mov_b32 s40, 86016
  s_add_u32 m0, s32, 65536
  v_mfma_f32_16x16x32_bf16 v[64:67], a[224:227], a[96:99], v[64:67]
  ds_read_b64_tr_b16 a[240:241], v10 offset:0
  ds_read_b64_tr_b16 a[242:243], v10 offset:2048
  v_mul_f32 v227, v227, v48
  v_mfma_f32_16x16x32_bf16 v[64:67], a[228:231], a[112:115], v[64:67]
  buffer_load_dwordx4 v34, s[20:23], s40 offen lds
  v_mul_f32 v240, v240, v48
  v_mfma_f32_16x16x32_bf16 v[68:71], a[224:227], a[100:103], v[68:71]
  ds_read_b64_tr_b16 a[244:245], v10 offset:4096
  ds_read_b64_tr_b16 a[246:247], v10 offset:6144
  v_mul_f32 v241, v241, v48
  v_mfma_f32_16x16x32_bf16 v[68:71], a[228:231], a[116:119], v[68:71]
  v_mul_f32 v242, v242, v48
  v_mul_f32 v243, v243, v48
  v_cvt_pk_bf16_f32 v224, v224, v225
  v_mfma_f32_16x16x32_bf16 v[72:75], a[224:227], a[104:107], v[72:75]
  v_cvt_pk_bf16_f32 v225, v226, v227
  v_cvt_pk_bf16_f32 v226, v240, v241
  v_cvt_pk_bf16_f32 v227, v242, v243
  v_mfma_f32_16x16x32_bf16 v[72:75], a[228:231], a[120:123], v[72:75]
  buffer_load_dwordx4 v35, s[20:23], s40 offen offset:1024 lds
  v_mfma_f32_16x16x32_bf16 v[76:79], a[224:227], a[108:111], v[76:79]
  ds_write_b128 v38, v[224:227] offset:16384
  v_mul_f32 v228, v228, v49
  v_mfma_f32_16x16x32_bf16 v[76:79], a[228:231], a[124:127], v[76:79]
  v_mul_f32 v229, v229, v49
  v_mul_f32 v230, v230, v49
  s_waitcnt lgkmcnt(11)
  v_mfma_f32_16x16x32_bf16 v[80:83], a[232:235], a[96:99], v[80:83]
  ds_read_b64_tr_b16 a[248:249], v11 offset:0
  ds_read_b64_tr_b16 a[250:251], v11 offset:2048
  v_mul_f32 v231, v231, v49
  v_mfma_f32_16x16x32_bf16 v[80:83], a[236:239], a[112:115], v[80:83]
  buffer_load_dwordx4 v36, s[20:23], s40 offen offset:2048 lds
  v_mul_f32 v244, v244, v49
  v_mfma_f32_16x16x32_bf16 v[84:87], a[232:235], a[100:103], v[84:87]
  ds_read_b64_tr_b16 a[252:253], v11 offset:4096
  ds_read_b64_tr_b16 a[254:255], v11 offset:6144
  v_mul_f32 v245, v245, v49
  v_mfma_f32_16x16x32_bf16 v[84:87], a[236:239], a[116:119], v[84:87]
  v_mul_f32 v246, v246, v49
  v_mul_f32 v247, v247, v49
  v_cvt_pk_bf16_f32 v228, v228, v229
  v_mfma_f32_16x16x32_bf16 v[88:91], a[232:235], a[104:107], v[88:91]
  v_cvt_pk_bf16_f32 v229, v230, v231
  v_cvt_pk_bf16_f32 v230, v244, v245
  v_cvt_pk_bf16_f32 v231, v246, v247
  v_mfma_f32_16x16x32_bf16 v[88:91], a[236:239], a[120:123], v[88:91]
  buffer_load_dwordx4 v37, s[20:23], s40 offen offset:3072 lds
  s_mov_b32 s40, 200704
  v_mfma_f32_16x16x32_bf16 v[92:95], a[232:235], a[108:111], v[92:95]
  s_add_u32 m0, s32, 69632
  ds_write_b128 v38, v[228:231] offset:17408
  v_mfma_f32_16x16x32_bf16 v[92:95], a[236:239], a[124:127], v[92:95]
  ds_read_b128 a[160:163], v39 offset:8192
  s_waitcnt lgkmcnt(7)
  v_mfma_f32_16x16x32_bf16 v[96:99], a[240:243], a[96:99], v[96:99]
  s_waitcnt vmcnt(12)
  ds_read_b64_tr_b16 a[224:225], v42 offset:32768
  ds_read_b64_tr_b16 a[226:227], v42 offset:34816
  v_mul_f32 v232, v232, v50
  v_mfma_f32_16x16x32_bf16 v[96:99], a[244:247], a[112:115], v[96:99]
  buffer_load_dwordx4 v34, s[20:23], s40 offen lds
  v_mul_f32 v233, v233, v50
  v_mfma_f32_16x16x32_bf16 v[100:103], a[240:243], a[100:103], v[100:103]
  ds_read_b64_tr_b16 a[228:229], v42 offset:36864
  ds_read_b64_tr_b16 a[230:231], v42 offset:38912
  v_mul_f32 v234, v234, v50
  v_mfma_f32_16x16x32_bf16 v[100:103], a[244:247], a[116:119], v[100:103]
  ds_read_b128 a[164:167], v39 offset:9216
  ds_read_b128 a[168:171], v39 offset:10240
  v_mfma_f32_16x16x32_bf16 v[104:107], a[240:243], a[104:107], v[104:107]
  ds_read_b128 a[172:175], v39 offset:11264
  ds_read_b128 a[176:179], v39 offset:12288
  v_mfma_f32_16x16x32_bf16 v[104:107], a[244:247], a[120:123], v[104:107]
  buffer_load_dwordx4 v35, s[20:23], s40 offen offset:1024 lds
  v_mul_f32 v235, v235, v50
  v_mfma_f32_16x16x32_bf16 v[108:111], a[240:243], a[108:111], v[108:111]
  ds_read_b128 a[180:183], v39 offset:13312
  ds_read_b128 a[184:187], v39 offset:14336
  v_mfma_f32_16x16x32_bf16 v[108:111], a[244:247], a[124:127], v[108:111]
  ds_read_b128 a[188:191], v39 offset:15360
  s_waitcnt lgkmcnt(13)
  v_mfma_f32_16x16x32_bf16 v[112:115], a[248:251], a[96:99], v[112:115]
  ds_read_b64_tr_b16 a[232:233], v43 offset:32768
  ds_read_b64_tr_b16 a[234:235], v43 offset:34816
  v_mul_f32 v248, v248, v50
  v_mfma_f32_16x16x32_bf16 v[112:115], a[252:255], a[112:115], v[112:115]
  buffer_load_dwordx4 v36, s[20:23], s40 offen offset:2048 lds
  v_mul_f32 v249, v249, v50
  v_mfma_f32_16x16x32_bf16 v[116:119], a[248:251], a[100:103], v[116:119]
  ds_read_b64_tr_b16 a[236:237], v43 offset:36864
  ds_read_b64_tr_b16 a[238:239], v43 offset:38912
  v_mul_f32 v250, v250, v50
  v_mfma_f32_16x16x32_bf16 v[116:119], a[252:255], a[116:119], v[116:119]
  v_mul_f32 v251, v251, v50
  v_cvt_pk_bf16_f32 v232, v232, v233
  v_cvt_pk_bf16_f32 v233, v234, v235
  v_mfma_f32_16x16x32_bf16 v[120:123], a[248:251], a[104:107], v[120:123]
  v_cvt_pk_bf16_f32 v234, v248, v249
  v_cvt_pk_bf16_f32 v235, v250, v251
  v_mfma_f32_16x16x32_bf16 v[120:123], a[252:255], a[120:123], v[120:123]
  buffer_load_dwordx4 v37, s[20:23], s40 offen offset:3072 lds
  v_mfma_f32_16x16x32_bf16 v[124:127], a[248:251], a[108:111], v[124:127]
  ds_write_b128 v38, v[232:235] offset:18432
  v_mul_f32 v236, v236, v51
  v_mfma_f32_16x16x32_bf16 v[124:127], a[252:255], a[124:127], v[124:127]
  v_mul_f32 v237, v237, v51
  v_mul_f32 v238, v238, v51
  s_waitcnt lgkmcnt(12)
  v_mfma_f32_16x16x32_bf16 v[64:67], a[224:227], a[128:131], v[64:67]
  ds_read_b64_tr_b16 a[240:241], v44 offset:32768
  ds_read_b64_tr_b16 a[242:243], v44 offset:34816
  v_mul_f32 v239, v239, v51
  v_mfma_f32_16x16x32_bf16 v[64:67], a[228:231], a[144:147], v[64:67]
  s_mov_b32 s40, 315392
  s_add_u32 m0, s32, 0
  v_mul_f32 v252, v252, v51
  v_mfma_f32_16x16x32_bf16 v[68:71], a[224:227], a[132:135], v[68:71]
  ds_read_b64_tr_b16 a[244:245], v44 offset:36864
  ds_read_b64_tr_b16 a[246:247], v44 offset:38912
  v_mul_f32 v253, v253, v51
  v_mfma_f32_16x16x32_bf16 v[68:71], a[228:231], a[148:151], v[68:71]
  buffer_load_dwordx4 v34, s[20:23], s40 offen lds
  v_mul_f32 v254, v254, v51
  v_mfma_f32_16x16x32_bf16 v[72:75], a[224:227], a[136:139], v[72:75]
  v_mul_f32 v255, v255, v51
  v_cvt_pk_bf16_f32 v236, v236, v237
  v_cvt_pk_bf16_f32 v237, v238, v239
  v_mfma_f32_16x16x32_bf16 v[72:75], a[228:231], a[152:155], v[72:75]
  v_cvt_pk_bf16_f32 v238, v252, v253
  v_cvt_pk_bf16_f32 v239, v254, v255
  v_mfma_f32_16x16x32_bf16 v[76:79], a[224:227], a[140:143], v[76:79]
  ds_write_b128 v38, v[236:239] offset:19456
  v_mfma_f32_16x16x32_bf16 v[76:79], a[228:231], a[156:159], v[76:79]
  buffer_load_dwordx4 v35, s[20:23], s40 offen offset:1024 lds
  s_waitcnt lgkmcnt(6)
  v_mfma_f32_16x16x32_bf16 v[80:83], a[232:235], a[128:131], v[80:83]
  ds_read_b64_tr_b16 a[248:249], v45 offset:32768
  ds_read_b64_tr_b16 a[250:251], v45 offset:34816
  s_waitcnt lgkmcnt(2)
  s_barrier
  v_mfma_f32_16x16x32_bf16 v[80:83], a[236:239], a[144:147], v[80:83]
  ds_read_b128 v[128:131], v39 offset:16384
  ds_read_b128 v[132:135], v39 offset:17408
  v_mfma_f32_16x16x32_bf16 v[84:87], a[232:235], a[132:135], v[84:87]
  ds_read_b64_tr_b16 a[252:253], v45 offset:36864
  ds_read_b64_tr_b16 a[254:255], v45 offset:38912
  v_mfma_f32_16x16x32_bf16 v[84:87], a[236:239], a[148:151], v[84:87]
  buffer_load_dwordx4 v36, s[20:23], s40 offen offset:2048 lds
  v_mfma_f32_16x16x32_bf16 v[88:91], a[232:235], a[136:139], v[88:91]
  ds_read_b128 v[136:139], v39 offset:18432
  ds_read_b128 v[140:143], v39 offset:19456
  v_mfma_f32_16x16x32_bf16 v[88:91], a[236:239], a[152:155], v[88:91]
  ds_read_b128 v[144:147], v39 offset:20480
  ds_read_b128 v[148:151], v39 offset:21504
  v_mfma_f32_16x16x32_bf16 v[92:95], a[232:235], a[140:143], v[92:95]
  ds_read_b128 v[152:155], v39 offset:22528
  ds_read_b128 v[156:159], v39 offset:23552
  v_mfma_f32_16x16x32_bf16 v[92:95], a[236:239], a[156:159], v[92:95]
  buffer_load_dwordx4 v37, s[20:23], s40 offen offset:3072 lds
  v_mfma_f32_16x16x32_bf16 v[96:99], a[240:243], a[128:131], v[96:99]
  s_waitcnt vmcnt(12)
  ds_read_b64_tr_b16 a[224:225], v8 offset:32768
  ds_read_b64_tr_b16 a[226:227], v8 offset:34816
  s_mov_b32 s40, 430080
  v_mfma_f32_16x16x32_bf16 v[96:99], a[244:247], a[144:147], v[96:99]
  s_add_u32 m0, s32, 4096
  ds_read_b128 v[160:163], v39 offset:24576
  v_mfma_f32_16x16x32_bf16 v[100:103], a[240:243], a[132:135], v[100:103]
  ds_read_b64_tr_b16 a[228:229], v8 offset:36864
  ds_read_b64_tr_b16 a[230:231], v8 offset:38912
  v_mfma_f32_16x16x32_bf16 v[100:103], a[244:247], a[148:151], v[100:103]
  buffer_load_dwordx4 v34, s[20:23], s40 offen lds
  v_mfma_f32_16x16x32_bf16 v[104:107], a[240:243], a[136:139], v[104:107]
  ds_read_b128 v[164:167], v39 offset:25600
  ds_read_b128 v[168:171], v39 offset:26624
  v_mfma_f32_16x16x32_bf16 v[104:107], a[244:247], a[152:155], v[104:107]
  ds_read_b128 v[172:175], v39 offset:27648
  ds_read_b128 v[176:179], v39 offset:28672
  v_mfma_f32_16x16x32_bf16 v[108:111], a[240:243], a[140:143], v[108:111]
  ds_read_b128 v[180:183], v39 offset:29696
  ds_read_b128 v[184:187], v39 offset:30720
  v_mfma_f32_16x16x32_bf16 v[108:111], a[244:247], a[156:159], v[108:111]
  buffer_load_dwordx4 v35, s[20:23], s40 offen offset:1024 lds
  s_waitcnt lgkmcnt(15)
  v_mfma_f32_16x16x32_bf16 v[112:115], a[248:251], a[128:131], v[112:115]
  ds_read_b64_tr_b16 a[232:233], v9 offset:32768
  ds_read_b64_tr_b16 a[234:235], v9 offset:34816
  v_mfma_f32_16x16x32_bf16 v[112:115], a[252:255], a[144:147], v[112:115]
  ds_read_b128 v[188:191], v39 offset:31744
  v_mfma_f32_16x16x32_bf16 v[116:119], a[248:251], a[132:135], v[116:119]
  ds_read_b64_tr_b16 a[236:237], v9 offset:36864
  ds_read_b64_tr_b16 a[238:239], v9 offset:38912
  v_mfma_f32_16x16x32_bf16 v[116:119], a[252:255], a[148:151], v[116:119]
  buffer_load_dwordx4 v36, s[20:23], s40 offen offset:2048 lds
  v_mfma_f32_16x16x32_bf16 v[120:123], a[248:251], a[136:139], v[120:123]
  v_add_u32 v1, 0, v2
  v_mul_u32_u24 v3, 10923, v1
  v_mfma_f32_16x16x32_bf16 v[120:123], a[252:255], a[152:155], v[120:123]
  s_waitcnt lgkmcnt(2)
  s_barrier
  v_mfma_f32_16x16x32_bf16 v[124:127], a[248:251], a[140:143], v[124:127]
  v_lshrrev_b32 v3, 16, v3
  v_mul_u32_u24 v3, 800, v3
  v_mfma_f32_16x16x32_bf16 v[124:127], a[252:255], a[156:159], v[124:127]
  buffer_load_dwordx4 v37, s[20:23], s40 offen offset:3072 lds
  v_mfma_f32_16x16x32_bf16 v[64:67], a[224:227], a[160:163], v[64:67]
  ds_read_b64_tr_b16 a[240:241], v10 offset:32768
  ds_read_b64_tr_b16 a[242:243], v10 offset:34816
  v_mfma_f32_16x16x32_bf16 v[64:67], a[228:231], a[176:179], v[64:67]
  v_lshl_add_u32 v3, v2, 4, v3
  v_add_u32 v56, s41, v3
  v_mfma_f32_16x16x32_bf16 v[68:71], a[224:227], a[164:167], v[68:71]
  ds_read_b64_tr_b16 a[244:245], v10 offset:36864
  ds_read_b64_tr_b16 a[246:247], v10 offset:38912
  v_mfma_f32_16x16x32_bf16 v[68:71], a[228:231], a[180:183], v[68:71]
  v_add_u32 v1, 64, v2
  v_mul_u32_u24 v3, 10923, v1
  v_mfma_f32_16x16x32_bf16 v[72:75], a[224:227], a[168:171], v[72:75]
  v_lshrrev_b32 v3, 16, v3
  v_mul_u32_u24 v3, 800, v3
  v_mfma_f32_16x16x32_bf16 v[72:75], a[228:231], a[184:187], v[72:75]
  v_lshl_add_u32 v3, v2, 4, v3
  v_add_u32 v57, s41, v3
  v_mfma_f32_16x16x32_bf16 v[76:79], a[224:227], a[172:175], v[76:79]
  v_add_u32 v1, 128, v2
  v_mul_u32_u24 v3, 10923, v1
  v_mfma_f32_16x16x32_bf16 v[76:79], a[228:231], a[188:191], v[76:79]
  v_lshrrev_b32 v3, 16, v3
  s_waitcnt lgkmcnt(4)
  v_mfma_f32_16x16x32_bf16 v[80:83], a[232:235], a[160:163], v[80:83]
  ds_read_b64_tr_b16 a[248:249], v11 offset:32768
  ds_read_b64_tr_b16 a[250:251], v11 offset:34816
  v_mfma_f32_16x16x32_bf16 v[80:83], a[236:239], a[176:179], v[80:83]
  v_mul_u32_u24 v3, 800, v3
  v_lshl_add_u32 v3, v2, 4, v3
  v_mfma_f32_16x16x32_bf16 v[84:87], a[232:235], a[164:167], v[84:87]
  ds_read_b64_tr_b16 a[252:253], v11 offset:36864
  ds_read_b64_tr_b16 a[254:255], v11 offset:38912
  v_mfma_f32_16x16x32_bf16 v[84:87], a[236:239], a[180:183], v[84:87]
  v_add_u32 v58, s41, v3
  v_lshrrev_b32 v1, 2, v2
  v_mfma_f32_16x16x32_bf16 v[88:91], a[232:235], a[168:171], v[88:91]
  s_mov_b32 s40, 0
  s_add_u32 m0, s32, 98304
  v_mfma_f32_16x16x32_bf16 v[88:91], a[236:239], a[184:187], v[88:91]
  buffer_load_dwordx4 v56, s[20:23], s40 offen offset:0 lds
  v_mfma_f32_16x16x32_bf16 v[92:95], a[232:235], a[172:175], v[92:95]
  v_mul_u32_u24 v1, 96, v1
  v_and_b32 v3, 3, v2
  v_mfma_f32_16x16x32_bf16 v[92:95], a[236:239], a[188:191], v[92:95]
  v_lshl_add_u32 v1, v3, 3, v1
  s_waitcnt lgkmcnt(4)
  v_mfma_f32_16x16x32_bf16 v[96:99], a[240:243], a[160:163], v[96:99]
  s_waitcnt vmcnt(9)
  ds_read_b64_tr_b16 a[224:225], v42 offset:0
  ds_read_b64_tr_b16 a[226:227], v42 offset:2048
  v_mfma_f32_16x16x32_bf16 v[96:99], a[244:247], a[176:179], v[96:99]
  buffer_load_dwordx4 v57, s[20:23], s40 offen offset:1024 lds
  v_mfma_f32_16x16x32_bf16 v[100:103], a[240:243], a[164:167], v[100:103]
  ds_read_b64_tr_b16 a[228:229], v42 offset:4096
  ds_read_b64_tr_b16 a[230:231], v42 offset:6144
  v_mfma_f32_16x16x32_bf16 v[100:103], a[244:247], a[180:183], v[100:103]
  v_add_u32 v59, s32, v1
  v_add_u32 v60, 65536, v59
  v_mfma_f32_16x16x32_bf16 v[104:107], a[240:243], a[168:171], v[104:107]
  v_add_u32 v61, 131072, v59
  s_lshl_b32 s42, s3, 10
  v_mfma_f32_16x16x32_bf16 v[104:107], a[244:247], a[184:187], v[104:107]
  buffer_load_dwordx4 v58, s[20:23], s40 offen offset:2048 lds
  s_mov_b32 s40, 114688
  v_mfma_f32_16x16x32_bf16 v[108:111], a[240:243], a[172:175], v[108:111]
  s_add_u32 m0, s32, 101376
  s_add_u32 s43, s42, 229376
  v_mfma_f32_16x16x32_bf16 v[108:111], a[244:247], a[188:191], v[108:111]
  s_waitcnt lgkmcnt(4)
  v_mfma_f32_16x16x32_bf16 v[112:115], a[248:251], a[160:163], v[112:115]
  ds_read_b64_tr_b16 a[232:233], v43 offset:0
  ds_read_b64_tr_b16 a[234:235], v43 offset:2048
  v_mfma_f32_16x16x32_bf16 v[112:115], a[252:255], a[176:179], v[112:115]
  buffer_load_dwordx4 v56, s[20:23], s40 offen offset:0 lds
  v_mfma_f32_16x16x32_bf16 v[116:119], a[248:251], a[164:167], v[116:119]
  ds_read_b64_tr_b16 a[236:237], v43 offset:4096
  ds_read_b64_tr_b16 a[238:239], v43 offset:6144
  v_mfma_f32_16x16x32_bf16 v[116:119], a[252:255], a[180:183], v[116:119]
  v_mfma_f32_16x16x32_bf16 v[120:123], a[248:251], a[168:171], v[120:123]
  v_mfma_f32_16x16x32_bf16 v[120:123], a[252:255], a[184:187], v[120:123]
  buffer_load_dwordx4 v57, s[20:23], s40 offen offset:1024 lds
  v_mfma_f32_16x16x32_bf16 v[124:127], a[248:251], a[172:175], v[124:127]
  v_mfma_f32_16x16x32_bf16 v[124:127], a[252:255], a[188:191], v[124:127]
  s_waitcnt lgkmcnt(4)
  v_mfma_f32_16x16x32_bf16 v[64:67], a[224:227], v[128:131], v[64:67]
  ds_read_b64_tr_b16 a[240:241], v44 offset:0
  ds_read_b64_tr_b16 a[242:243], v44 offset:2048
  v_mfma_f32_16x16x32_bf16 v[64:67], a[228:231], v[144:147], v[64:67]
  buffer_load_dwordx4 v58, s[20:23], s40 offen offset:2048 lds
  v_mfma_f32_16x16x32_bf16 v[68:71], a[224:227], v[132:135], v[68:71]
  ds_read_b64_tr_b16 a[244:245], v44 offset:4096
  ds_read_b64_tr_b16 a[246:247], v44 offset:6144
  v_mfma_f32_16x16x32_bf16 v[68:71], a[228:231], v[148:151], v[68:71]
  v_mfma_f32_16x16x32_bf16 v[72:75], a[224:227], v[136:139], v[72:75]
  v_mfma_f32_16x16x32_bf16 v[72:75], a[228:231], v[152:155], v[72:75]
  s_mov_b32 s40, 229376
  s_add_u32 m0, s32, 131072
  v_mfma_f32_16x16x32_bf16 v[76:79], a[224:227], v[140:143], v[76:79]
  buffer_load_dwordx4 v56, s[20:23], s40 offen offset:0 lds
  v_mfma_f32_16x16x32_bf16 v[76:79], a[228:231], v[156:159], v[76:79]
  s_waitcnt lgkmcnt(4)
  v_mfma_f32_16x16x32_bf16 v[80:83], a[232:235], v[128:131], v[80:83]
  ds_read_b64_tr_b16 a[248:249], v45 offset:0
  ds_read_b64_tr_b16 a[250:251], v45 offset:2048
  v_mfma_f32_16x16x32_bf16 v[80:83], a[236:239], v[144:147], v[80:83]
  v_mfma_f32_16x16x32_bf16 v[84:87], a[232:235], v[132:135], v[84:87]
  ds_read_b64_tr_b16 a[252:253], v45 offset:4096
  ds_read_b64_tr_b16 a[254:255], v45 offset:6144
  v_mfma_f32_16x16x32_bf16 v[84:87], a[236:239], v[148:151], v[84:87]
  buffer_load_dwordx4 v57, s[20:23], s40 offen offset:1024 lds
  v_mfma_f32_16x16x32_bf16 v[88:91], a[232:235], v[136:139], v[88:91]
  v_mfma_f32_16x16x32_bf16 v[88:91], a[236:239], v[152:155], v[88:91]
  v_mfma_f32_16x16x32_bf16 v[92:95], a[232:235], v[140:143], v[92:95]
  v_mfma_f32_16x16x32_bf16 v[92:95], a[236:239], v[156:159], v[92:95]
  buffer_load_dwordx4 v58, s[20:23], s40 offen offset:2048 lds
  s_waitcnt lgkmcnt(4)
  v_mfma_f32_16x16x32_bf16 v[96:99], a[240:243], v[128:131], v[96:99]
  s_waitcnt vmcnt(9)
  ds_read_b64_tr_b16 a[224:225], v8 offset:0
  ds_read_b64_tr_b16 a[226:227], v8 offset:2048
  s_mov_b32 s40, 344064
  v_mfma_f32_16x16x32_bf16 v[96:99], a[244:247], v[144:147], v[96:99]
  s_add_u32 m0, s32, 134144
  v_mfma_f32_16x16x32_bf16 v[100:103], a[240:243], v[132:135], v[100:103]
  ds_read_b64_tr_b16 a[228:229], v8 offset:4096
  ds_read_b64_tr_b16 a[230:231], v8 offset:6144
  v_mfma_f32_16x16x32_bf16 v[100:103], a[244:247], v[148:151], v[100:103]
  buffer_load_dwordx4 v56, s[20:23], s40 offen offset:0 lds
  v_mfma_f32_16x16x32_bf16 v[104:107], a[240:243], v[136:139], v[104:107]
  v_mfma_f32_16x16x32_bf16 v[104:107], a[244:247], v[152:155], v[104:107]
  v_mfma_f32_16x16x32_bf16 v[108:111], a[240:243], v[140:143], v[108:111]
  v_mfma_f32_16x16x32_bf16 v[108:111], a[244:247], v[156:159], v[108:111]
  buffer_load_dwordx4 v57, s[20:23], s40 offen offset:1024 lds
  s_waitcnt lgkmcnt(4)
  v_mfma_f32_16x16x32_bf16 v[112:115], a[248:251], v[128:131], v[112:115]
  ds_read_b64_tr_b16 a[232:233], v9 offset:0
  ds_read_b64_tr_b16 a[234:235], v9 offset:2048
  v_mfma_f32_16x16x32_bf16 v[112:115], a[252:255], v[144:147], v[112:115]
  v_mfma_f32_16x16x32_bf16 v[116:119], a[248:251], v[132:135], v[116:119]
  ds_read_b64_tr_b16 a[236:237], v9 offset:4096
  ds_read_b64_tr_b16 a[238:239], v9 offset:6144
  v_mfma_f32_16x16x32_bf16 v[116:119], a[252:255], v[148:151], v[116:119]
  buffer_load_dwordx4 v58, s[20:23], s40 offen offset:2048 lds
  v_mfma_f32_16x16x32_bf16 v[120:123], a[248:251], v[136:139], v[120:123]
  v_mfma_f32_16x16x32_bf16 v[120:123], a[252:255], v[152:155], v[120:123]
  v_mfma_f32_16x16x32_bf16 v[124:127], a[248:251], v[140:143], v[124:127]
  v_mfma_f32_16x16x32_bf16 v[124:127], a[252:255], v[156:159], v[124:127]
  s_mov_b32 s40, 28672
  s_add_u32 m0, s32, 32768
  s_waitcnt lgkmcnt(4)
  v_mfma_f32_16x16x32_bf16 v[64:67], a[224:227], v[160:163], v[64:67]
  ds_read_b64_tr_b16 a[240:241], v10 offset:0
  ds_read_b64_tr_b16 a[242:243], v10 offset:2048
  v_mfma_f32_16x16x32_bf16 v[64:67], a[228:231], v[176:179], v[64:67]
  buffer_load_dwordx4 v56, s[20:23], s40 offen offset:0 lds
  v_mfma_f32_16x16x32_bf16 v[68:71], a[224:227], v[164:167], v[68:71]
  ds_read_b64_tr_b16 a[244:245], v10 offset:4096
  ds_read_b64_tr_b16 a[246:247], v10 offset:6144
  v_mfma_f32_16x16x32_bf16 v[68:71], a[228:231], v[180:183], v[68:71]
  v_mfma_f32_16x16x32_bf16 v[72:75], a[224:227], v[168:171], v[72:75]
  v_mfma_f32_16x16x32_bf16 v[72:75], a[228:231], v[184:187], v[72:75]
  buffer_load_dwordx4 v57, s[20:23], s40 offen offset:1024 lds
  v_mfma_f32_16x16x32_bf16 v[76:79], a[224:227], v[172:175], v[76:79]
  v_mfma_f32_16x16x32_bf16 v[76:79], a[228:231], v[188:191], v[76:79]
  s_waitcnt lgkmcnt(4)
  v_mfma_f32_16x16x32_bf16 v[80:83], a[232:235], v[160:163], v[80:83]
  ds_read_b64_tr_b16 a[248:249], v11 offset:0
  ds_read_b64_tr_b16 a[250:251], v11 offset:2048
  v_mfma_f32_16x16x32_bf16 v[80:83], a[236:239], v[176:179], v[80:83]
  buffer_load_dwordx4 v58, s[20:23], s40 offen offset:2048 lds
  s_mov_b32 s40, 143360
  v_mfma_f32_16x16x32_bf16 v[84:87], a[232:235], v[164:167], v[84:87]
  ds_read_b64_tr_b16 a[252:253], v11 offset:4096
  ds_read_b64_tr_b16 a[254:255], v11 offset:6144
  s_add_u32 m0, s32, 35840
  v_mfma_f32_16x16x32_bf16 v[84:87], a[236:239], v[180:183], v[84:87]
  v_mfma_f32_16x16x32_bf16 v[88:91], a[232:235], v[168:171], v[88:91]
  v_mfma_f32_16x16x32_bf16 v[88:91], a[236:239], v[184:187], v[88:91]
  buffer_load_dwordx4 v56, s[20:23], s40 offen offset:0 lds
  v_mfma_f32_16x16x32_bf16 v[92:95], a[232:235], v[172:175], v[92:95]
  v_mfma_f32_16x16x32_bf16 v[92:95], a[236:239], v[188:191], v[92:95]
  s_waitcnt lgkmcnt(4)
  v_mfma_f32_16x16x32_bf16 v[96:99], a[240:243], v[160:163], v[96:99]
  s_waitcnt vmcnt(10)
  ds_read_b64_tr_b16 a[224:225], v60 offset:32768
  ds_read_b64_tr_b16 a[226:227], v60 offset:34304
  v_mfma_f32_16x16x32_bf16 v[96:99], a[244:247], v[176:179], v[96:99]
  buffer_load_dwordx4 v57, s[20:23], s40 offen offset:1024 lds
  v_mfma_f32_16x16x32_bf16 v[100:103], a[240:243], v[164:167], v[100:103]
  ds_read_b64_tr_b16 a[228:229], v60 offset:35840
  ds_read_b64_tr_b16 a[230:231], v60 offset:37376
  v_mfma_f32_16x16x32_bf16 v[100:103], a[244:247], v[180:183], v[100:103]
  v_mfma_f32_16x16x32_bf16 v[104:107], a[240:243], v[168:171], v[104:107]
  v_mfma_f32_16x16x32_bf16 v[104:107], a[244:247], v[184:187], v[104:107]
  buffer_load_dwordx4 v58, s[20:23], s40 offen offset:2048 lds
  v_mfma_f32_16x16x32_bf16 v[108:111], a[240:243], v[172:175], v[108:111]
  v_mfma_f32_16x16x32_bf16 v[108:111], a[244:247], v[188:191], v[108:111]
  s_waitcnt lgkmcnt(4)
  v_mfma_f32_16x16x32_bf16 v[112:115], a[248:251], v[160:163], v[112:115]
  ds_read_b64_tr_b16 a[232:233], v60 offset:32800
  ds_read_b64_tr_b16 a[234:235], v60 offset:34336
  v_mfma_f32_16x16x32_bf16 v[112:115], a[252:255], v[176:179], v[112:115]
  s_mov_b32 s40, 258048
  s_add_u32 m0, s32, 65536
  v_mfma_f32_16x16x32_bf16 v[116:119], a[248:251], v[164:167], v[116:119]
  ds_read_b64_tr_b16 a[236:237], v60 offset:35872
  ds_read_b64_tr_b16 a[238:239], v60 offset:37408
  v_mfma_f32_16x16x32_bf16 v[116:119], a[252:255], v[180:183], v[116:119]
  buffer_load_dwordx4 v56, s[20:23], s40 offen offset:0 lds
  v_mfma_f32_16x16x32_bf16 v[120:123], a[248:251], v[168:171], v[120:123]
  v_mfma_f32_16x16x32_bf16 v[120:123], a[252:255], v[184:187], v[120:123]
  v_mfma_f32_16x16x32_bf16 v[124:127], a[248:251], v[172:175], v[124:127]
  v_mfma_f32_16x16x32_bf16 v[124:127], a[252:255], v[188:191], v[124:127]
  buffer_load_dwordx4 v57, s[20:23], s40 offen offset:1024 lds
  s_waitcnt lgkmcnt(4)
  v_mfma_f32_16x16x32_bf16 v[192:195], a[224:227], a[0:3], 0
  ds_read_b64_tr_b16 a[240:241], v60 offset:32832
  ds_read_b64_tr_b16 a[242:243], v60 offset:34368
  v_mfma_f32_16x16x32_bf16 v[192:195], a[228:231], a[16:19], v[192:195]
  v_mfma_f32_16x16x32_bf16 v[196:199], a[224:227], a[4:7], 0
  ds_read_b64_tr_b16 a[244:245], v60 offset:35904
  ds_read_b64_tr_b16 a[246:247], v60 offset:37440
  v_mfma_f32_16x16x32_bf16 v[196:199], a[228:231], a[20:23], v[196:199]
  buffer_load_dwordx4 v58, s[20:23], s40 offen offset:2048 lds
  s_mov_b32 s40, 372736
  v_mfma_f32_16x16x32_bf16 v[200:203], a[224:227], a[8:11], 0
  s_add_u32 m0, s32, 68608
  v_mfma_f32_16x16x32_bf16 v[200:203], a[228:231], a[24:27], v[200:203]
  v_mfma_f32_16x16x32_bf16 v[204:207], a[224:227], a[12:15], 0
  v_mfma_f32_16x16x32_bf16 v[204:207], a[228:231], a[28:31], v[204:207]
  buffer_load_dwordx4 v56, s[20:23], s40 offen offset:0 lds
  s_waitcnt lgkmcnt(4)
  v_mfma_f32_16x16x32_bf16 v[208:211], a[232:235], a[0:3], 0
  s_waitcnt vmcnt(10)
  ds_read_b64_tr_b16 a[248:249], v61 offset:0
  ds_read_b64_tr_b16 a[250:251], v61 offset:1536
  v_mfma_f32_16x16x32_bf16 v[208:211], a[236:239], a[16:19], v[208:211]
  v_mfma_f32_16x16x32_bf16 v[212:215], a[232:235], a[4:7], 0
  ds_read_b64_tr_b16 a[252:253], v61 offset:3072
  ds_read_b64_tr_b16 a[254:255], v61 offset:4608
  v_mfma_f32_16x16x32_bf16 v[212:215], a[236:239], a[20:23], v[212:215]
  buffer_load_dwordx4 v57, s[20:23], s40 offen offset:1024 lds
  v_mfma_f32_16x16x32_bf16 v[216:219], a[232:235], a[8:11], 0
  v_mfma_f32_16x16x32_bf16 v[216:219], a[236:239], a[24:27], v[216:219]
  v_mfma_f32_16x16x32_bf16 v[220:223], a[232:235], a[12:15], 0
  v_mfma_f32_16x16x32_bf16 v[220:223], a[236:239], a[28:31], v[220:223]
  buffer_load_dwordx4 v58, s[20:23], s40 offen offset:2048 lds
  s_waitcnt lgkmcnt(4)
  v_mfma_f32_16x16x32_bf16 v[224:227], a[240:243], a[0:3], 0
  ds_read_b64_tr_b16 a[224:225], v61 offset:32
  ds_read_b64_tr_b16 a[226:227], v61 offset:1568
  v_mfma_f32_16x16x32_bf16 v[224:227], a[244:247], a[16:19], v[224:227]
  v_mfma_f32_16x16x32_bf16 v[228:231], a[240:243], a[4:7], 0
  ds_read_b64_tr_b16 a[228:229], v61 offset:3104
  ds_read_b64_tr_b16 a[230:231], v61 offset:4640
  v_mfma_f32_16x16x32_bf16 v[228:231], a[244:247], a[20:23], v[228:231]
  s_mov_b32 s40, 57344
  s_add_u32 m0, s32, 0
  v_mfma_f32_16x16x32_bf16 v[232:235], a[240:243], a[8:11], 0
  buffer_load_dwordx4 v56, s[20:23], s40 offen offset:0 lds
  v_mfma_f32_16x16x32_bf16 v[232:235], a[244:247], a[24:27], v[232:235]
  v_mfma_f32_16x16x32_bf16 v[236:239], a[240:243], a[12:15], 0
  v_mfma_f32_16x16x32_bf16 v[236:239], a[244:247], a[28:31], v[236:239]
  s_waitcnt lgkmcnt(4)
  v_mfma_f32_16x16x32_bf16 v[192:195], a[248:251], a[32:35], v[192:195]
  ds_read_b64_tr_b16 a[232:233], v61 offset:64
  ds_read_b64_tr_b16 a[234:235], v61 offset:1600
  v_mfma_f32_16x16x32_bf16 v[192:195], a[252:255], a[48:51], v[192:195]
  buffer_load_dwordx4 v57, s[20:23], s40 offen offset:1024 lds
  v_mfma_f32_16x16x32_bf16 v[196:199], a[248:251], a[36:39], v[196:199]
  ds_read_b64_tr_b16 a[236:237], v61 offset:3136
  ds_read_b64_tr_b16 a[238:239], v61 offset:4672
  v_mfma_f32_16x16x32_bf16 v[196:199], a[252:255], a[52:55], v[196:199]
  v_mfma_f32_16x16x32_bf16 v[200:203], a[248:251], a[40:43], v[200:203]
  v_mfma_f32_16x16x32_bf16 v[200:203], a[252:255], a[56:59], v[200:203]
  buffer_load_dwordx4 v58, s[20:23], s40 offen offset:2048 lds
  s_mov_b32 s40, 172032
  v_mfma_f32_16x16x32_bf16 v[204:207], a[248:251], a[44:47], v[204:207]
  s_add_u32 m0, s32, 3072
  v_mfma_f32_16x16x32_bf16 v[204:207], a[252:255], a[60:63], v[204:207]
  s_waitcnt lgkmcnt(4)
  v_mfma_f32_16x16x32_bf16 v[208:211], a[224:227], a[32:35], v[208:211]
  s_waitcnt vmcnt(9)
  ds_read_b64_tr_b16 a[240:241], v59 offset:32768
  ds_read_b64_tr_b16 a[242:243], v59 offset:34304
  v_mfma_f32_16x16x32_bf16 v[208:211], a[228:231], a[48:51], v[208:211]
  buffer_load_dwordx4 v56, s[20:23], s40 offen offset:0 lds
  v_mfma_f32_16x16x32_bf16 v[212:215], a[224:227], a[36:39], v[212:215]
  ds_read_b64_tr_b16 a[244:245], v59 offset:35840
  ds_read_b64_tr_b16 a[246:247], v59 offset:37376
  v_mfma_f32_16x16x32_bf16 v[212:215], a[228:231], a[52:55], v[212:215]
  v_mfma_f32_16x16x32_bf16 v[216:219], a[224:227], a[40:43], v[216:219]
  v_mfma_f32_16x16x32_bf16 v[216:219], a[228:231], a[56:59], v[216:219]
  buffer_load_dwordx4 v57, s[20:23], s40 offen offset:1024 lds
  v_mfma_f32_16x16x32_bf16 v[220:223], a[224:227], a[44:47], v[220:223]
  v_mfma_f32_16x16x32_bf16 v[220:223], a[228:231], a[60:63], v[220:223]
  s_waitcnt lgkmcnt(4)
  v_mfma_f32_16x16x32_bf16 v[224:227], a[232:235], a[32:35], v[224:227]
  ds_read_b64_tr_b16 a[248:249], v59 offset:32800
  ds_read_b64_tr_b16 a[250:251], v59 offset:34336
  v_mfma_f32_16x16x32_bf16 v[224:227], a[236:239], a[48:51], v[224:227]
  buffer_load_dwordx4 v58, s[20:23], s40 offen offset:2048 lds
  v_mfma_f32_16x16x32_bf16 v[228:231], a[232:235], a[36:39], v[228:231]
  ds_read_b64_tr_b16 a[252:253], v59 offset:35872
  ds_read_b64_tr_b16 a[254:255], v59 offset:37408
  v_mfma_f32_16x16x32_bf16 v[228:231], a[236:239], a[52:55], v[228:231]
  v_mfma_f32_16x16x32_bf16 v[232:235], a[232:235], a[40:43], v[232:235]
  v_mfma_f32_16x16x32_bf16 v[232:235], a[236:239], a[56:59], v[232:235]
  s_mov_b32 s40, 286720
  s_add_u32 m0, s32, 98304
  v_mfma_f32_16x16x32_bf16 v[236:239], a[232:235], a[44:47], v[236:239]
  buffer_load_dwordx4 v56, s[20:23], s40 offen offset:0 lds
  v_mfma_f32_16x16x32_bf16 v[236:239], a[236:239], a[60:63], v[236:239]
  s_waitcnt lgkmcnt(4)
  v_mfma_f32_16x16x32_bf16 v[192:195], a[240:243], a[64:67], v[192:195]
  ds_read_b64_tr_b16 a[224:225], v59 offset:32832
  ds_read_b64_tr_b16 a[226:227], v59 offset:34368
  v_mfma_f32_16x16x32_bf16 v[192:195], a[244:247], a[80:83], v[192:195]
  v_mfma_f32_16x16x32_bf16 v[196:199], a[240:243], a[68:71], v[196:199]
  ds_read_b64_tr_b16 a[228:229], v59 offset:35904
  ds_read_b64_tr_b16 a[230:231], v59 offset:37440
  v_mfma_f32_16x16x32_bf16 v[196:199], a[244:247], a[84:87], v[196:199]
  buffer_load_dwordx4 v57, s[20:23], s40 offen offset:1024 lds
  v_mfma_f32_16x16x32_bf16 v[200:203], a[240:243], a[72:75], v[200:203]
  v_mfma_f32_16x16x32_bf16 v[200:203], a[244:247], a[88:91], v[200:203]
  v_mfma_f32_16x16x32_bf16 v[204:207], a[240:243], a[76:79], v[204:207]
  v_mfma_f32_16x16x32_bf16 v[204:207], a[244:247], a[92:95], v[204:207]
  buffer_load_dwordx4 v58, s[20:23], s40 offen offset:2048 lds
  s_waitcnt lgkmcnt(4)
  v_mfma_f32_16x16x32_bf16 v[208:211], a[248:251], a[64:67], v[208:211]
  s_waitcnt vmcnt(9)
  ds_read_b64_tr_b16 a[232:233], v60 offset:0
  ds_read_b64_tr_b16 a[234:235], v60 offset:1536
  s_mov_b32 s40, 401408
  v_mfma_f32_16x16x32_bf16 v[208:211], a[252:255], a[80:83], v[208:211]
  s_add_u32 m0, s32, 101376
  v_mfma_f32_16x16x32_bf16 v[212:215], a[248:251], a[68:71], v[212:215]
  ds_read_b64_tr_b16 a[236:237], v60 offset:3072
  ds_read_b64_tr_b16 a[238:239], v60 offset:4608
  v_mfma_f32_16x16x32_bf16 v[212:215], a[252:255], a[84:87], v[212:215]
  buffer_load_dwordx4 v56, s[20:23], s40 offen offset:0 lds
  v_mfma_f32_16x16x32_bf16 v[216:219], a[248:251], a[72:75], v[216:219]
  v_mfma_f32_16x16x32_bf16 v[216:219], a[252:255], a[88:91], v[216:219]
  v_mfma_f32_16x16x32_bf16 v[220:223], a[248:251], a[76:79], v[220:223]
  v_mfma_f32_16x16x32_bf16 v[220:223], a[252:255], a[92:95], v[220:223]
  buffer_load_dwordx4 v57, s[20:23], s40 offen offset:1024 lds
  s_waitcnt lgkmcnt(4)
  v_mfma_f32_16x16x32_bf16 v[224:227], a[224:227], a[64:67], v[224:227]
  ds_read_b64_tr_b16 a[240:241], v60 offset:32
  ds_read_b64_tr_b16 a[242:243], v60 offset:1568
  v_mfma_f32_16x16x32_bf16 v[224:227], a[228:231], a[80:83], v[224:227]
  v_mfma_f32_16x16x32_bf16 v[228:231], a[224:227], a[68:71], v[228:231]
  ds_read_b64_tr_b16 a[244:245], v60 offset:3104
  ds_read_b64_tr_b16 a[246:247], v60 offset:4640
  v_mfma_f32_16x16x32_bf16 v[228:231], a[228:231], a[84:87], v[228:231]
  buffer_load_dwordx4 v58, s[20:23], s40 offen offset:2048 lds
  v_mfma_f32_16x16x32_bf16 v[232:235], a[224:227], a[72:75], v[232:235]
  v_mfma_f32_16x16x32_bf16 v[232:235], a[228:231], a[88:91], v[232:235]
  v_mfma_f32_16x16x32_bf16 v[236:239], a[224:227], a[76:79], v[236:239]
  v_mfma_f32_16x16x32_bf16 v[236:239], a[228:231], a[92:95], v[236:239]
  s_mov_b32 s40, 86016
  s_add_u32 m0, s32, 131072
  s_waitcnt lgkmcnt(4)
  v_mfma_f32_16x16x32_bf16 v[192:195], a[232:235], a[96:99], v[192:195]
  ds_read_b64_tr_b16 a[248:249], v60 offset:64
  ds_read_b64_tr_b16 a[250:251], v60 offset:1600
  v_mfma_f32_16x16x32_bf16 v[192:195], a[236:239], a[112:115], v[192:195]
  buffer_load_dwordx4 v56, s[20:23], s40 offen offset:0 lds
  v_mfma_f32_16x16x32_bf16 v[196:199], a[232:235], a[100:103], v[196:199]
  ds_read_b64_tr_b16 a[252:253], v60 offset:3136
  ds_read_b64_tr_b16 a[254:255], v60 offset:4672
  v_mfma_f32_16x16x32_bf16 v[196:199], a[236:239], a[116:119], v[196:199]
  v_mfma_f32_16x16x32_bf16 v[200:203], a[232:235], a[104:107], v[200:203]
  v_mfma_f32_16x16x32_bf16 v[200:203], a[236:239], a[120:123], v[200:203]
  buffer_load_dwordx4 v57, s[20:23], s40 offen offset:1024 lds
  v_mfma_f32_16x16x32_bf16 v[204:207], a[232:235], a[108:111], v[204:207]
  v_mfma_f32_16x16x32_bf16 v[204:207], a[236:239], a[124:127], v[204:207]
  s_waitcnt lgkmcnt(4)
  v_mfma_f32_16x16x32_bf16 v[208:211], a[240:243], a[96:99], v[208:211]
  s_waitcnt vmcnt(8)
  ds_read_b64_tr_b16 a[224:225], v59 offset:0
  ds_read_b64_tr_b16 a[226:227], v59 offset:1536
  v_mfma_f32_16x16x32_bf16 v[208:211], a[244:247], a[112:115], v[208:211]
  buffer_load_dwordx4 v58, s[20:23], s40 offen offset:2048 lds
  s_mov_b32 s40, 200704
  v_mfma_f32_16x16x32_bf16 v[212:215], a[240:243], a[100:103], v[212:215]
  ds_read_b64_tr_b16 a[228:229], v59 offset:3072
  ds_read_b64_tr_b16 a[230:231], v59 offset:4608
  s_add_u32 m0, s32, 134144
  v_mfma_f32_16x16x32_bf16 v[212:215], a[244:247], a[116:119], v[212:215]
  v_mfma_f32_16x16x32_bf16 v[216:219], a[240:243], a[104:107], v[216:219]
  v_mfma_f32_16x16x32_bf16 v[216:219], a[244:247], a[120:123], v[216:219]
  buffer_load_dwordx4 v56, s[20:23], s40 offen offset:0 lds
  v_mfma_f32_16x16x32_bf16 v[220:223], a[240:243], a[108:111], v[220:223]
  v_mfma_f32_16x16x32_bf16 v[220:223], a[244:247], a[124:127], v[220:223]
  s_waitcnt lgkmcnt(4)
  v_mfma_f32_16x16x32_bf16 v[224:227], a[248:251], a[96:99], v[224:227]
  ds_read_b64_tr_b16 a[232:233], v59 offset:32
  ds_read_b64_tr_b16 a[234:235], v59 offset:1568
  v_mfma_f32_16x16x32_bf16 v[224:227], a[252:255], a[112:115], v[224:227]
  buffer_load_dwordx4 v57, s[20:23], s40 offen offset:1024 lds
  v_mfma_f32_16x16x32_bf16 v[228:231], a[248:251], a[100:103], v[228:231]
  ds_read_b64_tr_b16 a[236:237], v59 offset:3104
  ds_read_b64_tr_b16 a[238:239], v59 offset:4640
  v_mfma_f32_16x16x32_bf16 v[228:231], a[252:255], a[116:119], v[228:231]
  v_mfma_f32_16x16x32_bf16 v[232:235], a[248:251], a[104:107], v[232:235]
  v_mfma_f32_16x16x32_bf16 v[232:235], a[252:255], a[120:123], v[232:235]
  buffer_load_dwordx4 v58, s[20:23], s40 offen offset:2048 lds
  v_mfma_f32_16x16x32_bf16 v[236:239], a[248:251], a[108:111], v[236:239]
  v_mfma_f32_16x16x32_bf16 v[236:239], a[252:255], a[124:127], v[236:239]
  s_waitcnt lgkmcnt(4)
  v_mfma_f32_16x16x32_bf16 v[192:195], a[224:227], a[128:131], v[192:195]
  ds_read_b64_tr_b16 a[240:241], v59 offset:64
  ds_read_b64_tr_b16 a[242:243], v59 offset:1600
  v_mfma_f32_16x16x32_bf16 v[192:195], a[228:231], a[144:147], v[192:195]
  s_mov_b32 s40, 315392
  s_add_u32 m0, s32, 32768
  v_mfma_f32_16x16x32_bf16 v[196:199], a[224:227], a[132:135], v[196:199]
  ds_read_b64_tr_b16 a[244:245], v59 offset:3136
  ds_read_b64_tr_b16 a[246:247], v59 offset:4672
  v_mfma_f32_16x16x32_bf16 v[196:199], a[228:231], a[148:151], v[196:199]
  buffer_load_dwordx4 v56, s[20:23], s40 offen offset:0 lds
  v_mfma_f32_16x16x32_bf16 v[200:203], a[224:227], a[136:139], v[200:203]
  v_mfma_f32_16x16x32_bf16 v[200:203], a[228:231], a[152:155], v[200:203]
  v_mfma_f32_16x16x32_bf16 v[204:207], a[224:227], a[140:143], v[204:207]
  v_mfma_f32_16x16x32_bf16 v[204:207], a[228:231], a[156:159], v[204:207]
  buffer_load_dwordx4 v57, s[20:23], s40 offen offset:1024 lds
  s_waitcnt lgkmcnt(4)
  v_mfma_f32_16x16x32_bf16 v[208:211], a[232:235], a[128:131], v[208:211]
  s_waitcnt vmcnt(8)
  ds_read_b64_tr_b16 a[248:249], v60 offset:32768
  ds_read_b64_tr_b16 a[250:251], v60 offset:34304
  v_mfma_f32_16x16x32_bf16 v[208:211], a[236:239], a[144:147], v[208:211]
  v_mfma_f32_16x16x32_bf16 v[212:215], a[232:235], a[132:135], v[212:215]
  ds_read_b64_tr_b16 a[252:253], v60 offset:35840
  ds_read_b64_tr_b16 a[254:255], v60 offset:37376
  v_mfma_f32_16x16x32_bf16 v[212:215], a[236:239], a[148:151], v[212:215]
  buffer_load_dwordx4 v58, s[20:23], s40 offen offset:2048 lds
  s_mov_b32 s40, 430080
  v_mfma_f32_16x16x32_bf16 v[216:219], a[232:235], a[136:139], v[216:219]
  s_add_u32 m0, s32, 35840
  v_mfma_f32_16x16x32_bf16 v[216:219], a[236:239], a[152:155], v[216:219]
  v_mfma_f32_16x16x32_bf16 v[220:223], a[232:235], a[140:143], v[220:223]
  v_mfma_f32_16x16x32_bf16 v[220:223], a[236:239], a[156:159], v[220:223]
  buffer_load_dwordx4 v56, s[20:23], s40 offen offset:0 lds
  s_waitcnt lgkmcnt(4)
  v_mfma_f32_16x16x32_bf16 v[224:227], a[240:243], a[128:131], v[224:227]
  ds_read_b64_tr_b16 a[224:225], v60 offset:32800
  ds_read_b64_tr_b16 a[226:227], v60 offset:34336
  v_mfma_f32_16x16x32_bf16 v[224:227], a[244:247], a[144:147], v[224:227]
  v_mfma_f32_16x16x32_bf16 v[228:231], a[240:243], a[132:135], v[228:231]
  ds_read_b64_tr_b16 a[228:229], v60 offset:35872
  ds_read_b64_tr_b16 a[230:231], v60 offset:37408
  v_mfma_f32_16x16x32_bf16 v[228:231], a[244:247], a[148:151], v[228:231]
  buffer_load_dwordx4 v57, s[20:23], s40 offen offset:1024 lds
  v_mfma_f32_16x16x32_bf16 v[232:235], a[240:243], a[136:139], v[232:235]
  v_mfma_f32_16x16x32_bf16 v[232:235], a[244:247], a[152:155], v[232:235]
  v_mfma_f32_16x16x32_bf16 v[236:239], a[240:243], a[140:143], v[236:239]
  v_mfma_f32_16x16x32_bf16 v[236:239], a[244:247], a[156:159], v[236:239]
  buffer_load_dwordx4 v58, s[20:23], s40 offen offset:2048 lds
  s_waitcnt lgkmcnt(4)
  v_mfma_f32_16x16x32_bf16 v[192:195], a[248:251], a[160:163], v[192:195]
  ds_read_b64_tr_b16 a[232:233], v60 offset:32832
  ds_read_b64_tr_b16 a[234:235], v60 offset:34368
  v_mfma_f32_16x16x32_bf16 v[192:195], a[252:255], a[176:179], v[192:195]
  v_mfma_f32_16x16x32_bf16 v[196:199], a[248:251], a[164:167], v[196:199]
  ds_read_b64_tr_b16 a[236:237], v60 offset:35904
  ds_read_b64_tr_b16 a[238:239], v60 offset:37440
  v_mfma_f32_16x16x32_bf16 v[196:199], a[252:255], a[180:183], v[196:199]
  v_mfma_f32_16x16x32_bf16 v[200:203], a[248:251], a[168:171], v[200:203]
  v_cvt_pk_bf16_f32 v240, v64, v65
  v_cvt_pk_bf16_f32 v241, v66, v67
  v_mfma_f32_16x16x32_bf16 v[200:203], a[252:255], a[184:187], v[200:203]
  v_cvt_pk_bf16_f32 v242, v68, v69
  v_mfma_f32_16x16x32_bf16 v[204:207], a[248:251], a[172:175], v[204:207]
  v_cvt_pk_bf16_f32 v243, v70, v71
  v_mfma_f32_16x16x32_bf16 v[204:207], a[252:255], a[188:191], v[204:207]
  s_waitcnt lgkmcnt(4)
  v_mfma_f32_16x16x32_bf16 v[208:211], a[224:227], a[160:163], v[208:211]
  s_waitcnt vmcnt(6)
  ds_read_b64_tr_b16 a[240:241], v61 offset:0
  ds_read_b64_tr_b16 a[242:243], v61 offset:1536
  v_mfma_f32_16x16x32_bf16 v[208:211], a[228:231], a[176:179], v[208:211]
  buffer_store_dwordx4 v[240:243], v46, s[28:31], s42 offen offset:0 sc1
  v_mfma_f32_16x16x32_bf16 v[212:215], a[224:227], a[164:167], v[212:215]
  ds_read_b64_tr_b16 a[244:245], v61 offset:3072
  ds_read_b64_tr_b16 a[246:247], v61 offset:4608
  v_mfma_f32_16x16x32_bf16 v[212:215], a[228:231], a[180:183], v[212:215]
  v_cvt_pk_bf16_f32 v244, v72, v73
  v_cvt_pk_bf16_f32 v245, v74, v75
  v_mfma_f32_16x16x32_bf16 v[216:219], a[224:227], a[168:171], v[216:219]
  v_cvt_pk_bf16_f32 v246, v76, v77
  v_cvt_pk_bf16_f32 v247, v78, v79
  v_mfma_f32_16x16x32_bf16 v[216:219], a[228:231], a[184:187], v[216:219]
  buffer_store_dwordx4 v[244:247], v46, s[28:31], s43 offen offset:0 sc1
  v_mfma_f32_16x16x32_bf16 v[220:223], a[224:227], a[172:175], v[220:223]
  v_cvt_pk_bf16_f32 v248, v80, v81
  v_mfma_f32_16x16x32_bf16 v[220:223], a[228:231], a[188:191], v[220:223]
  v_cvt_pk_bf16_f32 v249, v82, v83
  s_waitcnt lgkmcnt(4)
  v_mfma_f32_16x16x32_bf16 v[224:227], a[232:235], a[160:163], v[224:227]
  ds_read_b64_tr_b16 a[248:249], v61 offset:32
  ds_read_b64_tr_b16 a[250:251], v61 offset:1568
  v_mfma_f32_16x16x32_bf16 v[224:227], a[236:239], a[176:179], v[224:227]
  v_cvt_pk_bf16_f32 v250, v84, v85
  v_cvt_pk_bf16_f32 v251, v86, v87
  v_mfma_f32_16x16x32_bf16 v[228:231], a[232:235], a[164:167], v[228:231]
  ds_read_b64_tr_b16 a[252:253], v61 offset:3104
  ds_read_b64_tr_b16 a[254:255], v61 offset:4640
  v_mfma_f32_16x16x32_bf16 v[228:231], a[236:239], a[180:183], v[228:231]
  buffer_store_dwordx4 v[248:251], v46, s[28:31], s42 offen offset:256 sc1
  v_mfma_f32_16x16x32_bf16 v[232:235], a[232:235], a[168:171], v[232:235]
  v_cvt_pk_bf16_f32 v252, v88, v89
  v_cvt_pk_bf16_f32 v253, v90, v91
  v_mfma_f32_16x16x32_bf16 v[232:235], a[236:239], a[184:187], v[232:235]
  v_cvt_pk_bf16_f32 v254, v92, v93
  v_mfma_f32_16x16x32_bf16 v[236:239], a[232:235], a[172:175], v[236:239]
  v_cvt_pk_bf16_f32 v255, v94, v95
  v_mfma_f32_16x16x32_bf16 v[236:239], a[236:239], a[188:191], v[236:239]
  s_waitcnt lgkmcnt(4)
  v_mfma_f32_16x16x32_bf16 v[192:195], a[240:243], v[128:131], v[192:195]
  ds_read_b64_tr_b16 a[224:225], v61 offset:64
  ds_read_b64_tr_b16 a[226:227], v61 offset:1600
  v_mfma_f32_16x16x32_bf16 v[192:195], a[244:247], v[144:147], v[192:195]
  buffer_store_dwordx4 v[252:255], v46, s[28:31], s43 offen offset:256 sc1
  v_mfma_f32_16x16x32_bf16 v[196:199], a[240:243], v[132:135], v[196:199]
  ds_read_b64_tr_b16 a[228:229], v61 offset:3136
  ds_read_b64_tr_b16 a[230:231], v61 offset:4672
  v_mfma_f32_16x16x32_bf16 v[196:199], a[244:247], v[148:151], v[196:199]
  v_cvt_pk_bf16_f32 v240, v96, v97
  v_cvt_pk_bf16_f32 v241, v98, v99
  v_mfma_f32_16x16x32_bf16 v[200:203], a[240:243], v[136:139], v[200:203]
  v_cvt_pk_bf16_f32 v242, v100, v101
  v_cvt_pk_bf16_f32 v243, v102, v103
  v_mfma_f32_16x16x32_bf16 v[200:203], a[244:247], v[152:155], v[200:203]
  buffer_store_dwordx4 v[240:243], v46, s[28:31], s42 offen offset:512 sc1
  v_mfma_f32_16x16x32_bf16 v[204:207], a[240:243], v[140:143], v[204:207]
  v_cvt_pk_bf16_f32 v244, v104, v105
  v_mfma_f32_16x16x32_bf16 v[204:207], a[244:247], v[156:159], v[204:207]
  v_cvt_pk_bf16_f32 v245, v106, v107
  s_waitcnt lgkmcnt(4)
  v_mfma_f32_16x16x32_bf16 v[208:211], a[248:251], v[128:131], v[208:211]
  s_waitcnt vmcnt(5)
  ds_read_b64_tr_b16 a[232:233], v59 offset:32768
  ds_read_b64_tr_b16 a[234:235], v59 offset:34304
  v_mfma_f32_16x16x32_bf16 v[208:211], a[252:255], v[144:147], v[208:211]
  v_cvt_pk_bf16_f32 v246, v108, v109
  v_cvt_pk_bf16_f32 v247, v110, v111
  v_mfma_f32_16x16x32_bf16 v[212:215], a[248:251], v[132:135], v[212:215]
  ds_read_b64_tr_b16 a[236:237], v59 offset:35840
  ds_read_b64_tr_b16 a[238:239], v59 offset:37376
  v_mfma_f32_16x16x32_bf16 v[212:215], a[252:255], v[148:151], v[212:215]
  buffer_store_dwordx4 v[244:247], v46, s[28:31], s43 offen offset:512 sc1
  v_mfma_f32_16x16x32_bf16 v[216:219], a[248:251], v[136:139], v[216:219]
  v_cvt_pk_bf16_f32 v248, v112, v113
  v_cvt_pk_bf16_f32 v249, v114, v115
  v_mfma_f32_16x16x32_bf16 v[216:219], a[252:255], v[152:155], v[216:219]
  v_cvt_pk_bf16_f32 v250, v116, v117
  v_mfma_f32_16x16x32_bf16 v[220:223], a[248:251], v[140:143], v[220:223]
  v_cvt_pk_bf16_f32 v251, v118, v119
  v_mfma_f32_16x16x32_bf16 v[220:223], a[252:255], v[156:159], v[220:223]
  s_waitcnt lgkmcnt(4)
  v_mfma_f32_16x16x32_bf16 v[224:227], a[224:227], v[128:131], v[224:227]
  ds_read_b64_tr_b16 a[240:241], v59 offset:32800
  ds_read_b64_tr_b16 a[242:243], v59 offset:34336
  v_mfma_f32_16x16x32_bf16 v[224:227], a[228:231], v[144:147], v[224:227]
  buffer_store_dwordx4 v[248:251], v46, s[28:31], s42 offen offset:768 sc1
  v_mfma_f32_16x16x32_bf16 v[228:231], a[224:227], v[132:135], v[228:231]
  ds_read_b64_tr_b16 a[244:245], v59 offset:35872
  ds_read_b64_tr_b16 a[246:247], v59 offset:37408
  v_mfma_f32_16x16x32_bf16 v[228:231], a[228:231], v[148:151], v[228:231]
  v_cvt_pk_bf16_f32 v252, v120, v121
  v_cvt_pk_bf16_f32 v253, v122, v123
  v_mfma_f32_16x16x32_bf16 v[232:235], a[224:227], v[136:139], v[232:235]
  v_cvt_pk_bf16_f32 v254, v124, v125
  v_cvt_pk_bf16_f32 v255, v126, v127
  v_mfma_f32_16x16x32_bf16 v[232:235], a[228:231], v[152:155], v[232:235]
  buffer_store_dwordx4 v[252:255], v46, s[28:31], s43 offen offset:768 sc1
  v_mfma_f32_16x16x32_bf16 v[236:239], a[224:227], v[140:143], v[236:239]
  s_mul_i32 s42, s3, 768
  s_add_u32 s42, s42, 4096
  v_mfma_f32_16x16x32_bf16 v[236:239], a[228:231], v[156:159], v[236:239]
  s_add_u32 s43, s42, 229376
  s_waitcnt lgkmcnt(4)
  v_mfma_f32_16x16x32_bf16 v[192:195], a[232:235], v[160:163], v[192:195]
  ds_read_b64_tr_b16 a[248:249], v59 offset:32832
  ds_read_b64_tr_b16 a[250:251], v59 offset:34368
  v_mfma_f32_16x16x32_bf16 v[192:195], a[236:239], v[176:179], v[192:195]
  v_mfma_f32_16x16x32_bf16 v[196:199], a[232:235], v[164:167], v[196:199]
  ds_read_b64_tr_b16 a[252:253], v59 offset:35904
  ds_read_b64_tr_b16 a[254:255], v59 offset:37440
  v_mfma_f32_16x16x32_bf16 v[196:199], a[236:239], v[180:183], v[196:199]
  v_mfma_f32_16x16x32_bf16 v[200:203], a[232:235], v[168:171], v[200:203]
  v_mfma_f32_16x16x32_bf16 v[200:203], a[236:239], v[184:187], v[200:203]
  v_mfma_f32_16x16x32_bf16 v[204:207], a[232:235], v[172:175], v[204:207]
  v_mfma_f32_16x16x32_bf16 v[204:207], a[236:239], v[188:191], v[204:207]
  s_waitcnt lgkmcnt(4)
  v_mfma_f32_16x16x32_bf16 v[208:211], a[240:243], v[160:163], v[208:211]
  v_cvt_pk_bf16_f32 v240, v192, v193
  v_cvt_pk_bf16_f32 v241, v194, v195
  v_cvt_pk_bf16_f32 v242, v196, v197
  v_mfma_f32_16x16x32_bf16 v[208:211], a[244:247], v[176:179], v[208:211]
  v_cvt_pk_bf16_f32 v243, v198, v199
  buffer_store_dwordx4 v[240:243], v46, s[28:31], s42 offen offset:0 sc1
  v_mfma_f32_16x16x32_bf16 v[212:215], a[240:243], v[164:167], v[212:215]
  v_mfma_f32_16x16x32_bf16 v[212:215], a[244:247], v[180:183], v[212:215]
  v_mfma_f32_16x16x32_bf16 v[216:219], a[240:243], v[168:171], v[216:219]
  v_cvt_pk_bf16_f32 v244, v200, v201
  v_cvt_pk_bf16_f32 v245, v202, v203
  v_cvt_pk_bf16_f32 v246, v204, v205
  v_mfma_f32_16x16x32_bf16 v[216:219], a[244:247], v[184:187], v[216:219]
  v_cvt_pk_bf16_f32 v247, v206, v207
  buffer_store_dwordx4 v[244:247], v46, s[28:31], s43 offen offset:0 sc1
  v_mfma_f32_16x16x32_bf16 v[220:223], a[240:243], v[172:175], v[220:223]
  v_mfma_f32_16x16x32_bf16 v[220:223], a[244:247], v[188:191], v[220:223]
  s_waitcnt lgkmcnt(0)
  v_mfma_f32_16x16x32_bf16 v[224:227], a[248:251], v[160:163], v[224:227]
  v_cvt_pk_bf16_f32 v248, v208, v209
  v_cvt_pk_bf16_f32 v249, v210, v211
  v_cvt_pk_bf16_f32 v250, v212, v213
  v_mfma_f32_16x16x32_bf16 v[224:227], a[252:255], v[176:179], v[224:227]
  v_cvt_pk_bf16_f32 v251, v214, v215
  buffer_store_dwordx4 v[248:251], v46, s[28:31], s42 offen offset:256 sc1
  v_mfma_f32_16x16x32_bf16 v[228:231], a[248:251], v[164:167], v[228:231]
  v_mfma_f32_16x16x32_bf16 v[228:231], a[252:255], v[180:183], v[228:231]
  v_mfma_f32_16x16x32_bf16 v[232:235], a[248:251], v[168:171], v[232:235]
  v_cvt_pk_bf16_f32 v252, v216, v217
  v_cvt_pk_bf16_f32 v253, v218, v219
  v_cvt_pk_bf16_f32 v254, v220, v221
  v_mfma_f32_16x16x32_bf16 v[232:235], a[252:255], v[184:187], v[232:235]
  v_cvt_pk_bf16_f32 v255, v222, v223
  buffer_store_dwordx4 v[252:255], v46, s[28:31], s43 offen offset:256 sc1
  v_mfma_f32_16x16x32_bf16 v[236:239], a[248:251], v[172:175], v[236:239]
  v_mfma_f32_16x16x32_bf16 v[236:239], a[252:255], v[188:191], v[236:239]
  s_nop 2
  v_cvt_pk_bf16_f32 v240, v224, v225
  v_cvt_pk_bf16_f32 v241, v226, v227
  v_cvt_pk_bf16_f32 v242, v228, v229
  v_cvt_pk_bf16_f32 v243, v230, v231
  buffer_store_dwordx4 v[240:243], v46, s[28:31], s42 offen offset:512 sc1
  v_cvt_pk_bf16_f32 v244, v232, v233
  v_cvt_pk_bf16_f32 v245, v234, v235
  v_cvt_pk_bf16_f32 v246, v236, v237
  v_cvt_pk_bf16_f32 v247, v238, v239
  buffer_store_dwordx4 v[244:247], v46, s[28:31], s43 offen offset:512 sc1
  s_add_u32 s80, s94, 32768
  s_addc_u32 s81, s95, 0
  s_and_b32 s81, s81, 0xffff
  s_mov_b32 s82, 12288
  s_mov_b32 s83, 0x20000
  s_mov_b32 s84, s92
  s_and_b32 s85, s93, 0xffff
  s_mov_b32 s86, 256
  s_mov_b32 s87, 0x20000
  v_lshrrev_b32 v1, 6, v0
  s_mov_b32 s36, s2
  s_mov_b32 s63, 0
  s_mov_b32 s58, 0
  v_readfirstlane_b32 s59, v1
  s_lshr_b32 s3, s2, 3
  s_and_b32 s37, s2, 1
  s_and_b32 s8, s3, 3
  s_lshl2_add_u32 s37, s37, s8
  s_bfe_u32 s62, s2, 0x20001
  s_mul_i32 s62, s62, 7
  s_lshr_b32 s3, s3, 2
  s_add_u32 s62, s62, s3
T_TOP:
  v_and_b32 v2, 63, v0
  v_min_u32 v118, 7, v2
  v_lshlrev_b32 v118, 2, v118
  v_mov_b32 v10, 128
  s_lshr_b32 s54, s36, 3
  s_lshl_b32 s54, s54, 7
  s_add_u32 s54, s54, 8192
  buffer_load_dword v120, v118, s[80:83], s54 offen sc1
  buffer_load_dwordx2 v[122:123], v10, s[84:87], 0 offen sc1
  s_load_dwordx2 s[6:7], s[0:1], 104
  s_load_dwordx2 s[4:5], s[0:1], 0
  s_load_dwordx4 s[40:43], s[0:1], 48
  s_load_dwordx2 s[44:45], s[0:1], 64
  s_load_dwordx2 s[46:47], s[0:1], 88
  v_cmp_gt_u32 vcc, 224, v0
  v_lshrrev_b32 v1, 4, v0
  v_and_b32 v2, 15, v0
  v_lshlrev_b32 v6, 9, v1
  v_lshl_add_u32 v6, v2, 4, v6
  v_mov_b32 v7, 0x7fff0000
  v_cndmask_b32 v6, v7, v6, vcc
  s_mul_i32 s3, s36, 57344
  s_add_u32 s3, s3, 16777216
  v_lshrrev_b32 v3, 2, v0
  v_and_b32 v4, 3, v0
  s_waitcnt lgkmcnt(0)
  s_add_u32 s12, s6, s3
  s_addc_u32 s13, s7, 0
  s_and_b32 s13, s13, 0xffff
  s_mov_b32 s14, 57344
  s_mov_b32 s15, 0x20000
  v_lshlrev_b32 v8, 5, v3
  v_cndmask_b32 v8, v7, v8, vcc
  v_mul_u32_u24 v9, 896, v4
  v_lshl_add_u32 v9, v1, 6, v9
  v_and_b32 v5, 3, v3
  v_lshl_add_u32 v9, v5, 3, v9
  v_cndmask_b32 v9, v7, v9, vcc
  s_lshr_b32 s3, s36, 2
  s_and_b32 s8, s36, 3
  s_mul_i32 s3, s3, 28672
  s_mul_i32 s9, s8, 3584
  s_add_u32 s9, s9, s3
  s_add_u32 s16, s4, s9
  s_addc_u32 s17, s5, 0
  s_and_b32 s17, s17, 0xffff
  s_mov_b32 s18, 17920
  s_mov_b32 s19, 0x20000
  s_movk_i32 s28, 14336
  s_mov_b32 s20, s6
  s_and_b32 s21, s7, 0xffff
  s_mov_b32 s22, 65536
  s_mov_b32 s23, 0x20000
  s_lshl_b32 s8, s8, 7
  s_add_u32 s3, s3, s8
  s_add_u32 s9, s3, 4194304
  s_add_u32 s3, s3, 2097152
  s_add_u32 s24, s6, s9
  s_addc_u32 s25, s7, 0
  s_and_b32 s25, s25, 0xffff
  s_mov_b32 s26, 28672
  s_mov_b32 s27, 0x20000
  s_add_u32 s32, s6, s3
  s_addc_u32 s33, s7, 0
  s_and_b32 s33, s33, 0xffff
  s_mov_b32 s34, 28672
  s_mov_b32 s35, 0x20000
  v_lshlrev_b32 v11, 9, v3
  v_lshl_add_u32 v11, v4, 4, v11
  v_cndmask_b32 v11, v7, v11, vcc
  v_lshlrev_b32 v12, 6, v4
  v_add_u32 v12, 129024, v12
  v_lshrrev_b32 v13, 6, v0
  v_lshl_add_u32 v13, v13, 4, v12
  s_lshr_b32 s3, s59, 1
  s_lshl_b32 s8, s3, 2
  v_bfe_u32 v3, v0, 3, 3
  v_mul_u32_u24 v4, 3584, v3
  v_and_b32 v3, 2, v3
  v_and_b32 v5, 7, v0
  v_xor_b32 v3, v3, v5
  v_xor_b32 v3, s8, v3
  v_lshl_add_u32 v96, v3, 4, v4
  v_add_u32 v97, 27648, v96
  v_add_u32 v98, 55296, v96
  v_add_u32 v99, 82944, v96
  s_lshl_b32 s56, s59, 13
  s_and_b32 s57, s59, 1
  s_mul_i32 s57, s57, 114688
  s_cmp_eq_u32 s3, 0
  s_cselect_b32 s8, s40, s42
  s_cselect_b32 s9, s41, s43
  s_lshl_b32 s3, s62, 7
  s_add_u32 s52, s8, s3
  s_addc_u32 s53, s9, 0
  s_and_b32 s53, s53, 0xffff
  s_mov_b32 s54, 1602176
  s_mov_b32 s55, 0x20000
  s_cmp_lt_u32 s2, 224
  s_cselect_b32 s61, 7, 0
  s_cselect_b32 s54, s54, 0
  v_lshlrev_b32 v116, 14, v0
  v_mov_b32 v117, 1
  v_lshrrev_b32 v14, 6, v0
  v_lshlrev_b32 v14, 2, v14
  v_add_u32 v14, 129280, v14
  v_mov_b32 v15, 129280
  v_and_b32 v2, 63, v0
  v_and_b32 v88, 3, v0
  v_lshrrev_b32 v89, 6, v0
  v_lshlrev_b32 v88, 13, v88
  v_lshl_add_u32 v88, v89, 2, v88
  v_lshlrev_b32 v89, 13, v89
  v_add_u32 v88, 131072, v88
  v_add_u32 v89, 131072, v89
  v_lshlrev_b32 v110, 4, v2
  v_add_u32 v111, 28672, v110
  v_lshrrev_b32 v3, 5, v2
  v_bfe_u32 v1, v2, 2, 2
  v_and_b32 v4, 1, v2
  v_lshlrev_b32 v4, 4, v4
  v_bfe_u32 v5, v2, 1, 1
  v_lshl_add_u32 v4, v5, 3, v4
  v_lshl_add_u32 v5, v3, 2, v1
  v_lshl_add_u32 v4, v5, 7, v4
  v_bfe_u32 v5, v2, 4, 1
  v_lshl_add_u32 v4, v5, 14, v4
  v_bfe_u32 v1, v2, 3, 2
  v_xor_b32 v5, 0, v1
  v_lshl_add_u32 v106, v5, 5, v4
  v_xor_b32 v5, 1, v1
  v_lshl_add_u32 v107, v5, 5, v4
  v_xor_b32 v5, 2, v1
  v_lshl_add_u32 v108, v5, 5, v4
  v_xor_b32 v5, 3, v1
  v_lshl_add_u32 v109, v5, 5, v4
  v_lshrrev_b32 v3, 3, v2
  v_mul_u32_u24 v4, 896, v3
  v_and_b32 v3, 2, v3
  v_lshlrev_b32 v3, 1, v3
  v_and_b32 v5, 7, v2
  v_xor_b32 v3, v3, v5
  v_lshl_add_u32 v112, v3, 4, v4
  v_add_u32 v113, 6144, v112
  v_add_u32 v114, 12288, v112
  v_add_u32 v115, 18432, v112
  s_bfe_u32 s8, s2, 0x20003
  s_lshr_b32 s9, s2, 5
  s_lshl1_add_u32 s8, s8, s9
  s_cmp_ge_u32 s8, 7
  s_cselect_b32 s10, 7, 0
  s_sub_u32 s8, s8, s10
  s_mul_i32 s10, s59, 401408
  s_mul_i32 s88, s8, 57344
  s_add_u32 s88, s88, s10
  s_lshl_b32 s95, s8, 12
  s_add_u32 s8, s8, 1
  s_cmp_eq_u32 s8, 7
  s_cselect_b32 s8, 0, s8
  s_mul_i32 s89, s8, 57344
  s_add_u32 s89, s89, s10
  s_lshl_b32 s96, s8, 12
  s_add_u32 s8, s8, 1
  s_cmp_eq_u32 s8, 7
  s_cselect_b32 s8, 0, s8
  s_mul_i32 s90, s8, 57344
  s_add_u32 s90, s90, s10
  s_lshl_b32 s97, s8, 12
  s_add_u32 s8, s8, 1
  s_cmp_eq_u32 s8, 7
  s_cselect_b32 s8, 0, s8
  s_mul_i32 s91, s8, 57344
  s_add_u32 s91, s91, s10
  s_lshl_b32 s98, s8, 12
  s_add_u32 s8, s8, 1
  s_cmp_eq_u32 s8, 7
  s_cselect_b32 s8, 0, s8
  s_mul_i32 s92, s8, 57344
  s_add_u32 s92, s92, s10
  s_lshl_b32 s99, s8, 12
  s_add_u32 s8, s8, 1
  s_cmp_eq_u32 s8, 7
  s_cselect_b32 s8, 0, s8
  s_mul_i32 s93, s8, 57344
  s_add_u32 s93, s93, s10
  s_lshl_b32 s100, s8, 12
  s_add_u32 s8, s8, 1
  s_cmp_eq_u32 s8, 7
  s_cselect_b32 s8, 0, s8
  s_mul_i32 s94, s8, 57344
  s_add_u32 s94, s94, s10
  s_lshl_b32 s101, s8, 12
  s_lshl_b32 s9, s9, 7
  s_add_u32 s48, s44, s9
  s_addc_u32 s49, s45, 0
  s_and_b32 s49, s49, 0xffff
  s_mov_b32 s50, 1604864
  s_mov_b32 s51, 0x20000
  s_lshl_b32 s10, s59, 13
  v_lshrrev_b32 v3, 5, v2
  v_bfe_u32 v1, v2, 2, 2
  v_and_b32 v4, 1, v2
  v_lshlrev_b32 v4, 4, v4
  v_bfe_u32 v5, v2, 1, 1
  v_lshl_add_u32 v4, v5, 3, v4
  v_lshl_add_u32 v5, v3, 3, v1
  v_lshl_add_u32 v4, v5, 7, v4
  v_bfe_u32 v5, v2, 4, 1
  v_lshl_add_u32 v4, v5, 5, v4
  v_add_u32 v4, s10, v4
  s_and_b32 s30, s59, 1
  v_lshrrev_b32 v1, 1, v1
  v_xor_b32 v1, s30, v1
  v_lshl_add_u32 v100, v1, 6, v4
  v_xor_b32 v101, 64, v100
  v_add_u32 v102, 65536, v100
  v_add_u32 v104, 131072, v100
  v_add_u32 v103, 65536, v101
  v_add_u32 v105, 131072, v101
  s_lshr_b32 s3, s36, 3
  s_lshl_b32 s3, s3, 7
  s_add_u32 s3, s3, 8192
  s_and_b32 s8, s2, 7
  s_lshl_b32 s8, 1, s8
  s_bitcmp1_b32 s39, 13
  s_cselect_b32 s8, 0x1ff, s8
  s_mov_b32 s29, 0
  s_mov_b32 s31, 0
  s_mov_b32 s60, 16384
  s_lshr_b32 s9, s2, 3
  s_lshl_b32 s9, s9, 7
  s_and_b32 s10, s2, 7
  s_lshl2_add_u32 s9, s10, s9
  s_add_u32 s9, s9, 8192
  s_waitcnt vmcnt(0)
  s_barrier
  buffer_store_dword v117, v116, s[80:83], s9 offen sc1
  s_and_b32 s9, s39, 0x5000
  s_cbranch_scc1 T_FB
T_PL:
  v_cmp_eq_u32 vcc, 1, v120
  v_or_b32 v123, 0xff000000, v123
  s_and_b32 s9, vcc_lo, 0xff
  s_or_b32 s9, s9, s8
  v_cmp_eq_u64 vcc, -1, v[122:123]
  s_and_b32 s10, vcc_lo, 0x100
  s_or_b32 s9, s9, s10
  s_andn2_b32 s30, s9, s29
  s_or_b32 s29, s29, s9
  s_bitcmp1_b32 s30, 0
  s_cbranch_scc0 T_PL0
  s_mov_b32 s10, 0
  buffer_load_dwordx4 v[136:139], v6, s[12:15], s10 offen offset:0 sc1
  buffer_load_dwordx4 v[140:143], v6, s[12:15], s10 offen offset:256 sc1
T_PL0:
  s_bitcmp1_b32 s30, 1
  s_cbranch_scc0 T_PL1
  s_mov_b32 s10, 7168
  buffer_load_dwordx4 v[152:155], v6, s[12:15], s10 offen offset:0 sc1
  buffer_load_dwordx4 v[156:159], v6, s[12:15], s10 offen offset:256 sc1
T_PL1:
  s_bitcmp1_b32 s30, 2
  s_cbranch_scc0 T_PL2
  s_mov_b32 s10, 14336
  buffer_load_dwordx4 v[168:171], v6, s[12:15], s10 offen offset:0 sc1
  buffer_load_dwordx4 v[172:175], v6, s[12:15], s10 offen offset:256 sc1
T_PL2:
  s_bitcmp1_b32 s30, 3
  s_cbranch_scc0 T_PL3
  s_mov_b32 s10, 21504
  buffer_load_dwordx4 v[184:187], v6, s[12:15], s10 offen offset:0 sc1
  buffer_load_dwordx4 v[188:191], v6, s[12:15], s10 offen offset:256 sc1
T_PL3:
  s_bitcmp1_b32 s30, 4
  s_cbranch_scc0 T_PL4
  s_mov_b32 s10, 28672
  buffer_load_dwordx4 v[200:203], v6, s[12:15], s10 offen offset:0 sc1
  buffer_load_dwordx4 v[204:207], v6, s[12:15], s10 offen offset:256 sc1
T_PL4:
  s_bitcmp1_b32 s30, 5
  s_cbranch_scc0 T_PL5
  s_mov_b32 s10, 35840
  buffer_load_dwordx4 v[216:219], v6, s[12:15], s10 offen offset:0 sc1
  buffer_load_dwordx4 v[220:223], v6, s[12:15], s10 offen offset:256 sc1
T_PL5:
  s_bitcmp1_b32 s30, 6
  s_cbranch_scc0 T_PL6
  s_mov_b32 s10, 43008
  buffer_load_dwordx4 v[232:235], v6, s[12:15], s10 offen offset:0 sc1
  buffer_load_dwordx4 v[236:239], v6, s[12:15], s10 offen offset:256 sc1
T_PL6:
  s_bitcmp1_b32 s30, 7
  s_cbranch_scc0 T_PL7
  s_mov_b32 s10, 50176
  buffer_load_dwordx4 v[248:251], v6, s[12:15], s10 offen offset:0 sc1
  buffer_load_dwordx4 v[252:255], v6, s[12:15], s10 offen offset:256 sc1
T_PL7:
  s_bitcmp1_b32 s30, 8
  s_cbranch_scc0 T_PL8
  buffer_load_dwordx2 v[48:49], v9, s[16:19], 0 offen offset:0
  buffer_load_dwordx2 v[50:51], v9, s[16:19], 0 offen offset:32
  buffer_load_dwordx2 v[52:53], v9, s[16:19], s28 offen offset:0
  buffer_load_dwordx2 v[54:55], v9, s[16:19], s28 offen offset:32
  s_movk_i32 s11, 4096
  buffer_load_dwordx4 v[56:59], v8, s[20:23], s11 offen offset:0 sc1
  buffer_load_dwordx4 v[60:63], v8, s[20:23], s11 offen offset:16 sc1
  s_movk_i32 s11, 6144
  buffer_load_dwordx4 v[64:67], v8, s[20:23], s11 offen offset:0 sc1
  buffer_load_dwordx4 v[68:71], v8, s[20:23], s11 offen offset:16 sc1
  s_movk_i32 s11, 8192
  buffer_load_dwordx4 v[72:75], v8, s[20:23], s11 offen offset:0 sc1
  buffer_load_dwordx4 v[76:79], v8, s[20:23], s11 offen offset:16 sc1
T_PL8:
  s_cmp_eq_u32 s29, 0x1ff
  s_cbranch_scc1 T_PU
  buffer_load_dword v120, v118, s[80:83], s3 offen sc1
  s_bitcmp1_b32 s29, 8
  s_cbranch_scc1 T_PNM
  buffer_load_dwordx2 v[122:123], v10, s[84:87], 0 offen sc1
T_PNM:
  s_cmp_eq_u32 s61, 0
  s_cbranch_scc1 T_PU
  s_mov_b32 m0, s56
  s_sub_u32 s61, s61, 1
  buffer_load_dwordx4 v96, s[52:55], s57 offen offset:0 lds
  buffer_load_dwordx4 v97, s[52:55], s57 offen offset:1024 lds
  buffer_load_dwordx4 v98, s[52:55], s57 offen offset:2048 lds
  buffer_load_dwordx4 v99, s[52:55], s57 offen offset:3072 lds
  s_add_u32 s57, s57, 229376
  s_xor_b32 s56, s56, 4096
  s_bitcmp1_b32 s56, 12
  s_cselect_b32 s11, 0, 32768
  s_add_u32 s56, s56, s11
  s_bitset1_b32 s31, 9
T_PU:
  s_bitcmp1_b32 s31, 0
  s_cbranch_scc0 T_PU0
  v_lshlrev_b32 v128, 16, v136
  v_and_b32 v129, 0xffff0000, v136
  v_lshlrev_b32 v130, 16, v137
  v_and_b32 v131, 0xffff0000, v137
  v_lshlrev_b32 v132, 16, v138
  v_and_b32 v133, 0xffff0000, v138
  v_lshlrev_b32 v134, 16, v139
  v_and_b32 v135, 0xffff0000, v139
  v_lshlrev_b32 v136, 16, v140
  v_and_b32 v137, 0xffff0000, v140
  v_lshlrev_b32 v138, 16, v141
  v_and_b32 v139, 0xffff0000, v141
  v_lshlrev_b32 v140, 16, v142
  v_and_b32 v141, 0xffff0000, v142
  v_lshlrev_b32 v142, 16, v143
  v_and_b32 v143, 0xffff0000, v143
T_PU0:
  s_bitcmp1_b32 s31, 1
  s_cbranch_scc0 T_PU1
  v_lshlrev_b32 v144, 16, v152
  v_and_b32 v145, 0xffff0000, v152
  v_lshlrev_b32 v146, 16, v153
  v_and_b32 v147, 0xffff0000, v153
  v_lshlrev_b32 v148, 16, v154
  v_and_b32 v149, 0xffff0000, v154
  v_lshlrev_b32 v150, 16, v155
  v_and_b32 v151, 0xffff0000, v155
  v_lshlrev_b32 v152, 16, v156
  v_and_b32 v153, 0xffff0000, v156
  v_lshlrev_b32 v154, 16, v157
  v_and_b32 v155, 0xffff0000, v157
  v_lshlrev_b32 v156, 16, v158
  v_and_b32 v157, 0xffff0000, v158
  v_lshlrev_b32 v158, 16, v159
  v_and_b32 v159, 0xffff0000, v159
T_PU1:
  s_bitcmp1_b32 s31, 2
  s_cbranch_scc0 T_PU2
  v_lshlrev_b32 v160, 16, v168
  v_and_b32 v161, 0xffff0000, v168
  v_lshlrev_b32 v162, 16, v169
  v_and_b32 v163, 0xffff0000, v169
  v_lshlrev_b32 v164, 16, v170
  v_and_b32 v165, 0xffff0000, v170
  v_lshlrev_b32 v166, 16, v171
  v_and_b32 v167, 0xffff0000, v171
  v_lshlrev_b32 v168, 16, v172
  v_and_b32 v169, 0xffff0000, v172
  v_lshlrev_b32 v170, 16, v173
  v_and_b32 v171, 0xffff0000, v173
  v_lshlrev_b32 v172, 16, v174
  v_and_b32 v173, 0xffff0000, v174
  v_lshlrev_b32 v174, 16, v175
  v_and_b32 v175, 0xffff0000, v175
T_PU2:
  s_bitcmp1_b32 s31, 3
  s_cbranch_scc0 T_PU3
  v_lshlrev_b32 v176, 16, v184
  v_and_b32 v177, 0xffff0000, v184
  v_lshlrev_b32 v178, 16, v185
  v_and_b32 v179, 0xffff0000, v185
  v_lshlrev_b32 v180, 16, v186
  v_and_b32 v181, 0xffff0000, v186
  v_lshlrev_b32 v182, 16, v187
  v_and_b32 v183, 0xffff0000, v187
  v_lshlrev_b32 v184, 16, v188
  v_and_b32 v185, 0xffff0000, v188
  v_lshlrev_b32 v186, 16, v189
  v_and_b32 v187, 0xffff0000, v189
  v_lshlrev_b32 v188, 16, v190
  v_and_b32 v189, 0xffff0000, v190
  v_lshlrev_b32 v190, 16, v191
  v_and_b32 v191, 0xffff0000, v191
T_PU3:
  s_bitcmp1_b32 s31, 4
  s_cbranch_scc0 T_PU4
  v_lshlrev_b32 v192, 16, v200
  v_and_b32 v193, 0xffff0000, v200
  v_lshlrev_b32 v194, 16, v201
  v_and_b32 v195, 0xffff0000, v201
  v_lshlrev_b32 v196, 16, v202
  v_and_b32 v197, 0xffff0000, v202
  v_lshlrev_b32 v198, 16, v203
  v_and_b32 v199, 0xffff0000, v203
  v_lshlrev_b32 v200, 16, v204
  v_and_b32 v201, 0xffff0000, v204
  v_lshlrev_b32 v202, 16, v205
  v_and_b32 v203, 0xffff0000, v205
  v_lshlrev_b32 v204, 16, v206
  v_and_b32 v205, 0xffff0000, v206
  v_lshlrev_b32 v206, 16, v207
  v_and_b32 v207, 0xffff0000, v207
T_PU4:
  s_bitcmp1_b32 s31, 5
  s_cbranch_scc0 T_PU5
  v_lshlrev_b32 v208, 16, v216
  v_and_b32 v209, 0xffff0000, v216
  v_lshlrev_b32 v210, 16, v217
  v_and_b32 v211, 0xffff0000, v217
  v_lshlrev_b32 v212, 16, v218
  v_and_b32 v213, 0xffff0000, v218
  v_lshlrev_b32 v214, 16, v219
  v_and_b32 v215, 0xffff0000, v219
  v_lshlrev_b32 v216, 16, v220
  v_and_b32 v217, 0xffff0000, v220
  v_lshlrev_b32 v218, 16, v221
  v_and_b32 v219, 0xffff0000, v221
  v_lshlrev_b32 v220, 16, v222
  v_and_b32 v221, 0xffff0000, v222
  v_lshlrev_b32 v222, 16, v223
  v_and_b32 v223, 0xffff0000, v223
T_PU5:
  s_bitcmp1_b32 s31, 6
  s_cbranch_scc0 T_PU6
  v_lshlrev_b32 v224, 16, v232
  v_and_b32 v225, 0xffff0000, v232
  v_lshlrev_b32 v226, 16, v233
  v_and_b32 v227, 0xffff0000, v233
  v_lshlrev_b32 v228, 16, v234
  v_and_b32 v229, 0xffff0000, v234
  v_lshlrev_b32 v230, 16, v235
  v_and_b32 v231, 0xffff0000, v235
  v_lshlrev_b32 v232, 16, v236
  v_and_b32 v233, 0xffff0000, v236
  v_lshlrev_b32 v234, 16, v237
  v_and_b32 v235, 0xffff0000, v237
  v_lshlrev_b32 v236, 16, v238
  v_and_b32 v237, 0xffff0000, v238
  v_lshlrev_b32 v238, 16, v239
  v_and_b32 v239, 0xffff0000, v239
T_PU6:
  s_bitcmp1_b32 s31, 7
  s_cbranch_scc0 T_PU7
  v_lshlrev_b32 v240, 16, v248
  v_and_b32 v241, 0xffff0000, v248
  v_lshlrev_b32 v242, 16, v249
  v_and_b32 v243, 0xffff0000, v249
  v_lshlrev_b32 v244, 16, v250
  v_and_b32 v245, 0xffff0000, v250
  v_lshlrev_b32 v246, 16, v251
  v_and_b32 v247, 0xffff0000, v251
  v_lshlrev_b32 v248, 16, v252
  v_and_b32 v249, 0xffff0000, v252
  v_lshlrev_b32 v250, 16, v253
  v_and_b32 v251, 0xffff0000, v253
  v_lshlrev_b32 v252, 16, v254
  v_and_b32 v253, 0xffff0000, v254
  v_lshlrev_b32 v254, 16, v255
  v_and_b32 v255, 0xffff0000, v255
T_PU7:
  s_bitcmp1_b32 s31, 9
  s_mov_b32 s31, s30
  s_mov_b32 s30, 0
  s_waitcnt vmcnt(4)
  s_cbranch_scc1 T_PL
  s_waitcnt vmcnt(0)
  s_cmp_eq_u32 s29, 0x1ff
  s_cbranch_scc0 T_PM
  s_cmp_lg_u32 s31, 0
  s_cbranch_scc1 T_PU
  s_branch T_PD
T_PM:
  s_sub_u32 s60, s60, 1
  s_cbranch_scc0 T_PL
  ds_write_b32 v14, v117
  s_waitcnt lgkmcnt(0)
  s_barrier
  s_branch T_FB
T_PD:
  v_pk_add_f32 v[128:129], v[128:129], v[144:145]
  v_pk_add_f32 v[130:131], v[130:131], v[146:147]
  v_pk_add_f32 v[132:133], v[132:133], v[148:149]
  v_pk_add_f32 v[134:135], v[134:135], v[150:151]
  v_pk_add_f32 v[136:137], v[136:137], v[152:153]
  v_pk_add_f32 v[138:139], v[138:139], v[154:155]
  v_pk_add_f32 v[140:141], v[140:141], v[156:157]
  v_pk_add_f32 v[142:143], v[142:143], v[158:159]
  v_pk_add_f32 v[128:129], v[128:129], v[160:161]
  v_pk_add_f32 v[130:131], v[130:131], v[162:163]
  v_pk_add_f32 v[132:133], v[132:133], v[164:165]
  v_pk_add_f32 v[134:135], v[134:135], v[166:167]
  v_pk_add_f32 v[136:137], v[136:137], v[168:169]
  v_pk_add_f32 v[138:139], v[138:139], v[170:171]
  v_pk_add_f32 v[140:141], v[140:141], v[172:173]
  v_pk_add_f32 v[142:143], v[142:143], v[174:175]
  v_pk_add_f32 v[128:129], v[128:129], v[176:177]
  v_pk_add_f32 v[130:131], v[130:131], v[178:179]
  v_pk_add_f32 v[132:133], v[132:133], v[180:181]
  v_pk_add_f32 v[134:135], v[134:135], v[182:183]
  v_pk_add_f32 v[136:137], v[136:137], v[184:185]
  v_pk_add_f32 v[138:139], v[138:139], v[186:187]
  v_pk_add_f32 v[140:141], v[140:141], v[188:189]
  v_pk_add_f32 v[142:143], v[142:143], v[190:191]
  v_pk_add_f32 v[128:129], v[128:129], v[192:193]
  v_pk_add_f32 v[130:131], v[130:131], v[194:195]
  v_pk_add_f32 v[132:133], v[132:133], v[196:197]
  v_pk_add_f32 v[134:135], v[134:135], v[198:199]
  v_pk_add_f32 v[136:137], v[136:137], v[200:201]
  v_pk_add_f32 v[138:139], v[138:139], v[202:203]
  v_pk_add_f32 v[140:141], v[140:141], v[204:205]
  v_pk_add_f32 v[142:143], v[142:143], v[206:207]
  v_pk_add_f32 v[128:129], v[128:129], v[208:209]
  v_pk_add_f32 v[130:131], v[130:131], v[210:211]
  v_pk_add_f32 v[132:133], v[132:133], v[212:213]
  v_pk_add_f32 v[134:135], v[134:135], v[214:215]
  v_pk_add_f32 v[136:137], v[136:137], v[216:217]
  v_pk_add_f32 v[138:139], v[138:139], v[218:219]
  v_pk_add_f32 v[140:141], v[140:141], v[220:221]
  v_pk_add_f32 v[142:143], v[142:143], v[222:223]
  v_pk_add_f32 v[128:129], v[128:129], v[224:225]
  v_pk_add_f32 v[130:131], v[130:131], v[226:227]
  v_pk_add_f32 v[132:133], v[132:133], v[228:229]
  v_pk_add_f32 v[134:135], v[134:135], v[230:231]
  v_pk_add_f32 v[136:137], v[136:137], v[232:233]
  v_pk_add_f32 v[138:139], v[138:139], v[234:235]
  v_pk_add_f32 v[140:141], v[140:141], v[236:237]
  v_pk_add_f32 v[142:143], v[142:143], v[238:239]
  v_pk_add_f32 v[128:129], v[128:129], v[240:241]
  v_pk_add_f32 v[130:131], v[130:131], v[242:243]
  v_pk_add_f32 v[132:133], v[132:133], v[244:245]
  v_pk_add_f32 v[134:135], v[134:135], v[246:247]
  v_pk_add_f32 v[136:137], v[136:137], v[248:249]
  v_pk_add_f32 v[138:139], v[138:139], v[250:251]
  v_pk_add_f32 v[140:141], v[140:141], v[252:253]
  v_pk_add_f32 v[142:143], v[142:143], v[254:255]
  v_lshlrev_b32 v32, 16, v48
  v_and_b32 v33, 0xffff0000, v48
  v_lshlrev_b32 v34, 16, v49
  v_and_b32 v35, 0xffff0000, v49
  v_lshlrev_b32 v36, 16, v50
  v_and_b32 v37, 0xffff0000, v50
  v_lshlrev_b32 v38, 16, v51
  v_and_b32 v39, 0xffff0000, v51
  v_lshlrev_b32 v40, 16, v52
  v_and_b32 v41, 0xffff0000, v52
  v_lshlrev_b32 v42, 16, v53
  v_and_b32 v43, 0xffff0000, v53
  v_lshlrev_b32 v44, 16, v54
  v_and_b32 v45, 0xffff0000, v54
  v_lshlrev_b32 v46, 16, v55
  v_and_b32 v47, 0xffff0000, v55
  v_pk_fma_f32 v[32:33], v[128:129], v[56:57], v[32:33]
  v_pk_fma_f32 v[34:35], v[130:131], v[58:59], v[34:35]
  v_pk_fma_f32 v[36:37], v[136:137], v[60:61], v[36:37]
  v_pk_fma_f32 v[38:39], v[138:139], v[62:63], v[38:39]
  v_pk_fma_f32 v[40:41], v[132:133], v[56:57], v[40:41]
  v_pk_fma_f32 v[42:43], v[134:135], v[58:59], v[42:43]
  v_pk_fma_f32 v[44:45], v[140:141], v[60:61], v[44:45]
  v_pk_fma_f32 v[46:47], v[142:143], v[62:63], v[46:47]
  v_pk_add_f32 v[20:21], v[32:33], v[34:35]
  v_pk_mul_f32 v[22:23], v[32:33], v[32:33]
  v_pk_add_f32 v[24:25], v[40:41], v[42:43]
  v_pk_mul_f32 v[26:27], v[40:41], v[40:41]
  v_pk_fma_f32 v[22:23], v[34:35], v[34:35], v[22:23]
  v_pk_fma_f32 v[26:27], v[42:43], v[42:43], v[26:27]
  v_pk_add_f32 v[20:21], v[20:21], v[36:37]
  v_pk_fma_f32 v[22:23], v[36:37], v[36:37], v[22:23]
  v_pk_add_f32 v[24:25], v[24:25], v[44:45]
  v_pk_fma_f32 v[26:27], v[44:45], v[44:45], v[26:27]
  v_pk_add_f32 v[20:21], v[20:21], v[38:39]
  v_pk_fma_f32 v[22:23], v[38:39], v[38:39], v[22:23]
  v_pk_add_f32 v[24:25], v[24:25], v[46:47]
  v_pk_fma_f32 v[26:27], v[46:47], v[46:47], v[26:27]
  v_add_f32 v16, v20, v21
  v_add_f32 v17, v24, v25
  v_add_f32 v18, v22, v23
  v_add_f32 v19, v26, v27
  v_cvt_pk_bf16_f32 v48, v32, v33
  v_cvt_pk_bf16_f32 v49, v34, v35
  v_add_f32_dpp v16, v16, v16 row_ror:4 row_mask:0xf bank_mask:0xf
  v_add_f32_dpp v17, v17, v17 row_ror:4 row_mask:0xf bank_mask:0xf
  v_add_f32_dpp v18, v18, v18 row_ror:4 row_mask:0xf bank_mask:0xf
  v_add_f32_dpp v19, v19, v19 row_ror:4 row_mask:0xf bank_mask:0xf
  v_add_f32_dpp v16, v16, v16 row_ror:8 row_mask:0xf bank_mask:0xf
  v_add_f32_dpp v17, v17, v17 row_ror:8 row_mask:0xf bank_mask:0xf
  v_add_f32_dpp v18, v18, v18 row_ror:8 row_mask:0xf bank_mask:0xf
  v_add_f32_dpp v19, v19, v19 row_ror:8 row_mask:0xf bank_mask:0xf
  v_mov_b32 v20, v16
  v_mov_b32 v21, v17
  v_mov_b32 v22, v18
  v_mov_b32 v23, v19
  v_cvt_pk_bf16_f32 v50, v36, v37
  v_cvt_pk_bf16_f32 v51, v38, v39
  v_cvt_pk_bf16_f32 v52, v40, v41
  v_permlane16_swap_b32 v16, v20
  v_permlane16_swap_b32 v17, v21
  v_permlane16_swap_b32 v18, v22
  v_permlane16_swap_b32 v19, v23
  v_pk_add_f32 v[16:17], v[16:17], v[20:21]
  v_pk_add_f32 v[18:19], v[18:19], v[22:23]
  v_mov_b32 v20, v16
  v_mov_b32 v21, v17
  v_mov_b32 v22, v18
  v_mov_b32 v23, v19
  v_cvt_pk_bf16_f32 v53, v42, v43
  v_cvt_pk_bf16_f32 v54, v44, v45
  v_cvt_pk_bf16_f32 v55, v46, v47
  v_permlane32_swap_b32 v16, v20
  v_permlane32_swap_b32 v17, v21
  v_permlane32_swap_b32 v18, v22
  v_permlane32_swap_b32 v19, v23
  v_pk_add_f32 v[16:17], v[16:17], v[20:21]
  v_pk_add_f32 v[18:19], v[18:19], v[22:23]
  ds_write_b128 v13, v[16:19]
  v_mov_b32 v20, 0
  ds_write_b32 v14, v20
  buffer_store_dwordx4 v[48:51], v11, s[24:27], 0 offen offset:0 sc1
  buffer_store_dwordx4 v[52:55], v11, s[24:27], 0 offen offset:64 sc1
  s_waitcnt lgkmcnt(0)
  s_barrier
  ds_read_b128 v[124:127], v15
  ds_read_b128 v[16:19], v12 offset:0
  ds_read_b128 v[20:23], v12 offset:16
  ds_read_b128 v[24:27], v12 offset:32
  ds_read_b128 v[28:31], v12 offset:48
  s_mov_b32 s30, 0x3b124925
  s_mov_b32 s31, s30
  s_waitcnt lgkmcnt(0)
  v_pk_add_f32 v[16:17], v[16:17], v[20:21]
  v_pk_add_f32 v[18:19], v[18:19], v[22:23]
  v_pk_add_f32 v[24:25], v[24:25], v[28:29]
  v_pk_add_f32 v[26:27], v[26:27], v[30:31]
  v_pk_add_f32 v[16:17], v[16:17], v[24:25]
  v_pk_add_f32 v[18:19], v[18:19], v[26:27]
  v_pk_mul_f32 v[16:17], v[16:17], s[30:31]
  v_pk_mul_f32 v[18:19], v[18:19], s[30:31]
  v_fma_f32 v18, -v16, v16, v18
  v_fma_f32 v19, -v17, v17, v19
  v_max_f32 v18, 0, v18
  v_max_f32 v19, 0, v19
  v_add_f32 v18, 0x3727c5ac, v18
  v_add_f32 v19, 0x3727c5ac, v19
  v_rsq_f32 v18, v18
  v_rsq_f32 v19, v19
  v_or3_b32 v124, v124, v125, v126
  v_or_b32 v124, v124, v127
  v_cmp_ne_u32 vcc, 0, v124
  s_cbranch_vccnz T_FB
  v_sub_f32 v32, v32, v16
  v_sub_f32 v33, v33, v16
  v_sub_f32 v34, v34, v16
  v_sub_f32 v35, v35, v16
  v_sub_f32 v36, v36, v16
  v_sub_f32 v37, v37, v16
  v_sub_f32 v38, v38, v16
  v_sub_f32 v39, v39, v16
  v_sub_f32 v40, v40, v17
  v_sub_f32 v41, v41, v17
  v_sub_f32 v42, v42, v17
  v_sub_f32 v43, v43, v17
  v_sub_f32 v44, v44, v17
  v_sub_f32 v45, v45, v17
  v_sub_f32 v46, v46, v17
  v_sub_f32 v47, v47, v17
  v_mul_f32 v32, v32, v18
  v_mul_f32 v33, v33, v18
  v_mul_f32 v34, v34, v18
  v_mul_f32 v35, v35, v18
  v_mul_f32 v36, v36, v18
  v_mul_f32 v37, v37, v18
  v_mul_f32 v38, v38, v18
  v_mul_f32 v39, v39, v18
  v_mul_f32 v40, v40, v19
  v_mul_f32 v41, v41, v19
  v_mul_f32 v42, v42, v19
  v_mul_f32 v43, v43, v19
  v_mul_f32 v44, v44, v19
  v_mul_f32 v45, v45, v19
  v_mul_f32 v46, v46, v19
  v_mul_f32 v47, v47, v19
  v_pk_fma_f32 v[32:33], v[32:33], v[64:65], v[72:73]
  v_pk_fma_f32 v[34:35], v[34:35], v[66:67], v[74:75]
  v_pk_fma_f32 v[36:37], v[36:37], v[68:69], v[76:77]
  v_pk_fma_f32 v[38:39], v[38:39], v[70:71], v[78:79]
  v_pk_fma_f32 v[40:41], v[40:41], v[64:65], v[72:73]
  v_pk_fma_f32 v[42:43], v[42:43], v[66:67], v[74:75]
  v_pk_fma_f32 v[44:45], v[44:45], v[68:69], v[76:77]
  v_pk_fma_f32 v[46:47], v[46:47], v[70:71], v[78:79]
  v_cvt_pk_bf16_f32 v80, v32, v33
  v_cvt_pk_bf16_f32 v81, v34, v35
  v_cvt_pk_bf16_f32 v82, v36, v37
  v_cvt_pk_bf16_f32 v83, v38, v39
  buffer_store_dwordx4 v[80:83], v11, s[32:35], 0 offen offset:0 sc1
  v_cvt_pk_bf16_f32 v84, v40, v41
  v_cvt_pk_bf16_f32 v85, v42, v43
  v_cvt_pk_bf16_f32 v86, v44, v45
  v_cvt_pk_bf16_f32 v87, v46, v47
  buffer_store_dwordx4 v[84:87], v11, s[32:35], 0 offen offset:64 sc1
  s_lshl2_add_u32 s30, s37, s59
  s_mul_i32 s31, s30, 57344
  s_add_u32 s31, s31, 2097152
  s_add_u32 s12, s6, s31
  s_addc_u32 s13, s7, 0
  s_and_b32 s13, s13, 0xffff
  s_mov_b32 s14, 57344
  s_mov_b32 s15, 0x20000
  s_mul_i32 s3, s30, 229376
  s_lshl_b32 s31, s62, 12
  s_add_u32 s3, s3, s31
  s_add_u32 s3, s3, 8388608
  s_add_u32 s16, s6, s3
  s_addc_u32 s17, s7, 0
  s_and_b32 s17, s17, 0xffff
  s_mov_b32 s18, 118784
  s_mov_b32 s19, 0x20000
  s_movk_i32 s20, 4096
  s_movk_i32 s21, 8192
  s_movk_i32 s22, 12288
  s_movk_i32 s23, 16384
  s_movk_i32 s24, 20480
  s_movk_i32 s25, 24576
  s_mov_b32 s28, 114688
  s_lshr_b32 s3, s36, 3
  s_lshl_b32 s3, s3, 7
  s_and_b32 s8, s36, 7
  s_lshl2_add_u32 s3, s8, s3
  s_waitcnt vmcnt(0)
  s_barrier
  buffer_store_dword v117, v116, s[80:83], s3 offen sc1
  s_cmp_ge_u32 s2, 224
  s_cbranch_scc1 T_PF
  s_cmp_lt_u32 s63, 2
  s_cbranch_scc1 T_L63
  s_add_u32 s36, s36, 1
  s_sub_u32 s63, s63, 1
  s_branch T_AGAIN
T_L63:
T_WL:
  s_cmp_eq_u32 s61, 0
  s_cbranch_scc1 T_WD
  s_mov_b32 m0, s56
  s_sub_u32 s61, s61, 1
  buffer_load_dwordx4 v96, s[52:55], s57 offen offset:0 lds
  buffer_load_dwordx4 v97, s[52:55], s57 offen offset:1024 lds
  buffer_load_dwordx4 v98, s[52:55], s57 offen offset:2048 lds
  buffer_load_dwordx4 v99, s[52:55], s57 offen offset:3072 lds
  s_add_u32 s57, s57, 229376
  s_xor_b32 s56, s56, 4096
  s_bitcmp1_b32 s56, 12
  s_cselect_b32 s11, 0, 32768
  s_add_u32 s56, s56, s11
  s_branch T_WL
T_WD:
  s_lshl_b32 s61, s59, 13
  s_mov_b32 s60, 16384
  s_bitcmp1_b32 s39, 13
  s_cbranch_scc1 T_RW
  s_lshl2_add_u32 s3, s37, s59
  s_lshl_b32 s3, s3, 7
  v_min_u32 v3, 28, v118
T_RL:
  buffer_load_dword v1, v3, s[80:83], s3 offen sc1
  s_sub_u32 s60, s60, 1
  s_cbranch_scc1 T_RW
  s_waitcnt vmcnt(0)
  v_cmp_ne_u32 vcc, 1, v1
  s_cbranch_vccnz T_RL
T_RW:
  s_waitcnt vmcnt(0)
T_RX:
  s_lshr_b32 s60, s60, 31
  v_mov_b32 v4, s60
  ds_write_b32 v88, v4
  buffer_load_dwordx4 a[0:3], v110, s[12:15], 0 offen offset:0 sc1
  buffer_load_dwordx4 a[4:7], v111, s[12:15], 0 offen offset:0 sc1
  buffer_load_dwordx4 a[8:11], v110, s[12:15], 0 offen offset:1024 sc1
  buffer_load_dwordx4 a[12:15], v111, s[12:15], 0 offen offset:1024 sc1
  buffer_load_dwordx4 a[16:19], v110, s[12:15], 0 offen offset:2048 sc1
  buffer_load_dwordx4 a[20:23], v111, s[12:15], 0 offen offset:2048 sc1
  buffer_load_dwordx4 a[24:27], v110, s[12:15], 0 offen offset:3072 sc1
  buffer_load_dwordx4 a[28:31], v111, s[12:15], 0 offen offset:3072 sc1
  buffer_load_dwordx4 a[32:35], v110, s[12:15], s20 offen offset:0 sc1
  buffer_load_dwordx4 a[36:39], v111, s[12:15], s20 offen offset:0 sc1
  buffer_load_dwordx4 a[40:43], v110, s[12:15], s20 offen offset:1024 sc1
  buffer_load_dwordx4 a[44:47], v111, s[12:15], s20 offen offset:1024 sc1
  buffer_load_dwordx4 a[48:51], v110, s[12:15], s20 offen offset:2048 sc1
  buffer_load_dwordx4 a[52:55], v111, s[12:15], s20 offen offset:2048 sc1
  buffer_load_dwordx4 a[56:59], v110, s[12:15], s20 offen offset:3072 sc1
  buffer_load_dwordx4 a[60:63], v111, s[12:15], s20 offen offset:3072 sc1
  s_waitcnt lgkmcnt(0)
  s_barrier
  ds_read_b128 v[12:15], v89
  ds_read_b64_tr_b16 v[32:33], v106 offset:0
  ds_read_b64_tr_b16 v[34:35], v106 offset:2048
  ds_read_b64_tr_b16 v[36:37], v107 offset:0
  ds_read_b64_tr_b16 v[38:39], v107 offset:2048
  ds_read_b64_tr_b16 v[40:41], v108 offset:0
  ds_read_b64_tr_b16 v[42:43], v108 offset:2048
  ds_read_b64_tr_b16 v[44:45], v109 offset:0
  ds_read_b64_tr_b16 v[46:47], v109 offset:2048
  ds_read_b64_tr_b16 v[48:49], v106 offset:1024
  ds_read_b64_tr_b16 v[50:51], v106 offset:3072
  s_waitcnt lgkmcnt(10)
  v_or3_b32 v4, v12, v13, v14
  v_or_b32 v4, v4, v15
  v_cmp_ne_u32 vcc, 0, v4
  s_cbranch_vccnz T_FB
  s_waitcnt vmcnt(14) lgkmcnt(8)
  v_mfma_f32_32x32x16_bf16 v[128:143], v[32:35], a[0:3], 0
  ds_read_b64_tr_b16 v[52:53], v107 offset:1024
  v_mfma_f32_32x32x16_bf16 v[144:159], v[32:35], a[4:7], 0
  ds_read_b64_tr_b16 v[54:55], v107 offset:3072
  buffer_load_dwordx4 a[64:67], v110, s[12:15], s21 offen offset:0 sc1
  s_waitcnt lgkmcnt(8)
  v_mfma_f32_32x32x16_bf16 v[160:175], v[36:39], a[0:3], 0
  ds_read_b64_tr_b16 v[56:57], v108 offset:1024
  v_mfma_f32_32x32x16_bf16 v[176:191], v[36:39], a[4:7], 0
  ds_read_b64_tr_b16 v[58:59], v108 offset:3072
  s_waitcnt lgkmcnt(8)
  v_mfma_f32_32x32x16_bf16 v[192:207], v[40:43], a[0:3], 0
  ds_read_b64_tr_b16 v[60:61], v109 offset:1024
  buffer_load_dwordx4 a[68:71], v111, s[12:15], s21 offen offset:0 sc1
  v_mfma_f32_32x32x16_bf16 v[208:223], v[40:43], a[4:7], 0
  ds_read_b64_tr_b16 v[62:63], v109 offset:3072
  s_waitcnt lgkmcnt(8)
  v_mfma_f32_32x32x16_bf16 v[224:239], v[44:47], a[0:3], 0
  ds_read_b64_tr_b16 v[64:65], v106 offset:8192
  v_mfma_f32_32x32x16_bf16 v[240:255], v[44:47], a[4:7], 0
  ds_read_b64_tr_b16 v[66:67], v106 offset:10240
  buffer_load_dwordx4 a[72:75], v110, s[12:15], s21 offen offset:1024 sc1
  s_waitcnt vmcnt(15) lgkmcnt(8)
  v_mfma_f32_32x32x16_bf16 v[128:143], v[48:51], a[8:11], v[128:143]
  ds_read_b64_tr_b16 v[68:69], v107 offset:8192
  v_mfma_f32_32x32x16_bf16 v[144:159], v[48:51], a[12:15], v[144:159]
  ds_read_b64_tr_b16 v[70:71], v107 offset:10240
  s_waitcnt lgkmcnt(8)
  v_mfma_f32_32x32x16_bf16 v[160:175], v[52:55], a[8:11], v[160:175]
  ds_read_b64_tr_b16 v[72:73], v108 offset:8192
  buffer_load_dwordx4 a[76:79], v111, s[12:15], s21 offen offset:1024 sc1
  v_mfma_f32_32x32x16_bf16 v[176:191], v[52:55], a[12:15], v[176:191]
  ds_read_b64_tr_b16 v[74:75], v108 offset:10240
  s_waitcnt lgkmcnt(8)
  v_mfma_f32_32x32x16_bf16 v[192:207], v[56:59], a[8:11], v[192:207]
  ds_read_b64_tr_b16 v[76:77], v109 offset:8192
  v_mfma_f32_32x32x16_bf16 v[208:223], v[56:59], a[12:15], v[208:223]
  ds_read_b64_tr_b16 v[78:79], v109 offset:10240
  buffer_load_dwordx4 a[80:83], v110, s[12:15], s21 offen offset:2048 sc1
  s_waitcnt lgkmcnt(8)
  v_mfma_f32_32x32x16_bf16 v[224:239], v[60:63], a[8:11], v[224:239]
  ds_read_b64_tr_b16 v[80:81], v106 offset:9216
  v_mfma_f32_32x32x16_bf16 v[240:255], v[60:63], a[12:15], v[240:255]
  ds_read_b64_tr_b16 v[82:83], v106 offset:11264
  s_waitcnt vmcnt(15) lgkmcnt(8)
  v_mfma_f32_32x32x16_bf16 v[128:143], v[64:67], a[16:19], v[128:143]
  ds_read_b64_tr_b16 v[84:85], v107 offset:9216
  buffer_load_dwordx4 a[84:87], v111, s[12:15], s21 offen offset:2048 sc1
  v_mfma_f32_32x32x16_bf16 v[144:159], v[64:67], a[20:23], v[144:159]
  ds_read_b64_tr_b16 v[86:87], v107 offset:11264
  s_waitcnt lgkmcnt(8)
  v_mfma_f32_32x32x16_bf16 v[160:175], v[68:71], a[16:19], v[160:175]
  ds_read_b64_tr_b16 v[88:89], v108 offset:9216
  v_mfma_f32_32x32x16_bf16 v[176:191], v[68:71], a[20:23], v[176:191]
  ds_read_b64_tr_b16 v[90:91], v108 offset:11264
  buffer_load_dwordx4 a[88:91], v110, s[12:15], s21 offen offset:3072 sc1
  s_waitcnt lgkmcnt(8)
  v_mfma_f32_32x32x16_bf16 v[192:207], v[72:75], a[16:19], v[192:207]
  ds_read_b64_tr_b16 v[92:93], v109 offset:9216
  v_mfma_f32_32x32x16_bf16 v[208:223], v[72:75], a[20:23], v[208:223]
  ds_read_b64_tr_b16 v[94:95], v109 offset:11264
  s_waitcnt lgkmcnt(8)
  v_mfma_f32_32x32x16_bf16 v[224:239], v[76:79], a[16:19], v[224:239]
  ds_read_b64_tr_b16 v[32:33], v106 offset:4096
  buffer_load_dwordx4 a[92:95], v111, s[12:15], s21 offen offset:3072 sc1
  v_mfma_f32_32x32x16_bf16 v[240:255], v[76:79], a[20:23], v[240:255]
  ds_read_b64_tr_b16 v[34:35], v106 offset:6144
  s_waitcnt vmcnt(16) lgkmcnt(8)
  v_mfma_f32_32x32x16_bf16 v[128:143], v[80:83], a[24:27], v[128:143]
  ds_read_b64_tr_b16 v[36:37], v107 offset:4096
  v_mfma_f32_32x32x16_bf16 v[144:159], v[80:83], a[28:31], v[144:159]
  ds_read_b64_tr_b16 v[38:39], v107 offset:6144
  s_waitcnt lgkmcnt(8)
  v_mfma_f32_32x32x16_bf16 v[160:175], v[84:87], a[24:27], v[160:175]
  ds_read_b64_tr_b16 v[40:41], v108 offset:4096
  v_mfma_f32_32x32x16_bf16 v[176:191], v[84:87], a[28:31], v[176:191]
  ds_read_b64_tr_b16 v[42:43], v108 offset:6144
  s_waitcnt lgkmcnt(8)
  v_mfma_f32_32x32x16_bf16 v[192:207], v[88:91], a[24:27], v[192:207]
  ds_read_b64_tr_b16 v[44:45], v109 offset:4096
  v_mfma_f32_32x32x16_bf16 v[208:223], v[88:91], a[28:31], v[208:223]
  ds_read_b64_tr_b16 v[46:47], v109 offset:6144
  s_waitcnt lgkmcnt(8)
  v_mfma_f32_32x32x16_bf16 v[224:239], v[92:95], a[24:27], v[224:239]
  ds_read_b64_tr_b16 v[48:49], v106 offset:5120
  s_add_u32 m0, s61, 131072
  s_nop 0
  buffer_load_dwordx4 v112, s[48:51], s88 offen offset:0 lds
  v_mfma_f32_32x32x16_bf16 v[240:255], v[92:95], a[28:31], v[240:255]
  ds_read_b64_tr_b16 v[50:51], v106 offset:7168
  s_waitcnt vmcnt(15) lgkmcnt(8)
  v_mfma_f32_32x32x16_bf16 v[128:143], v[32:35], a[32:35], v[128:143]
  ds_read_b64_tr_b16 v[52:53], v107 offset:5120
  v_mfma_f32_32x32x16_bf16 v[144:159], v[32:35], a[36:39], v[144:159]
  ds_read_b64_tr_b16 v[54:55], v107 offset:7168
  buffer_load_dwordx4 a[96:99], v110, s[12:15], s22 offen offset:0 sc1
  s_waitcnt lgkmcnt(8)
  v_mfma_f32_32x32x16_bf16 v[160:175], v[36:39], a[32:35], v[160:175]
  ds_read_b64_tr_b16 v[56:57], v108 offset:5120
  buffer_load_dwordx4 v113, s[48:51], s88 offen offset:1024 lds
  v_mfma_f32_32x32x16_bf16 v[176:191], v[36:39], a[36:39], v[176:191]
  ds_read_b64_tr_b16 v[58:59], v108 offset:7168
  s_waitcnt lgkmcnt(8)
  v_mfma_f32_32x32x16_bf16 v[192:207], v[40:43], a[32:35], v[192:207]
  ds_read_b64_tr_b16 v[60:61], v109 offset:5120
  buffer_load_dwordx4 a[100:103], v111, s[12:15], s22 offen offset:0 sc1
  v_mfma_f32_32x32x16_bf16 v[208:223], v[40:43], a[36:39], v[208:223]
  ds_read_b64_tr_b16 v[62:63], v109 offset:7168
  s_waitcnt lgkmcnt(8)
  v_mfma_f32_32x32x16_bf16 v[224:239], v[44:47], a[32:35], v[224:239]
  ds_read_b64_tr_b16 v[64:65], v106 offset:12288
  buffer_load_dwordx4 v114, s[48:51], s88 offen offset:2048 lds
  v_mfma_f32_32x32x16_bf16 v[240:255], v[44:47], a[36:39], v[240:255]
  ds_read_b64_tr_b16 v[66:67], v106 offset:14336
  buffer_load_dwordx4 a[104:107], v110, s[12:15], s22 offen offset:1024 sc1
  s_waitcnt vmcnt(18) lgkmcnt(8)
  v_mfma_f32_32x32x16_bf16 v[128:143], v[48:51], a[40:43], v[128:143]
  ds_read_b64_tr_b16 v[68:69], v107 offset:12288
  v_mfma_f32_32x32x16_bf16 v[144:159], v[48:51], a[44:47], v[144:159]
  ds_read_b64_tr_b16 v[70:71], v107 offset:14336
  s_waitcnt lgkmcnt(8)
  v_mfma_f32_32x32x16_bf16 v[160:175], v[52:55], a[40:43], v[160:175]
  ds_read_b64_tr_b16 v[72:73], v108 offset:12288
  buffer_load_dwordx4 a[108:111], v111, s[12:15], s22 offen offset:1024 sc1
  buffer_load_dwordx4 v115, s[48:51], s88 offen offset:3072 lds
  v_mfma_f32_32x32x16_bf16 v[176:191], v[52:55], a[44:47], v[176:191]
  ds_read_b64_tr_b16 v[74:75], v108 offset:14336
  s_waitcnt lgkmcnt(8)
  v_mfma_f32_32x32x16_bf16 v[192:207], v[56:59], a[40:43], v[192:207]
  ds_read_b64_tr_b16 v[76:77], v109 offset:12288
  v_mfma_f32_32x32x16_bf16 v[208:223], v[56:59], a[44:47], v[208:223]
  ds_read_b64_tr_b16 v[78:79], v109 offset:14336
  buffer_load_dwordx4 a[112:115], v110, s[12:15], s22 offen offset:2048 sc1
  s_waitcnt lgkmcnt(8)
  v_mfma_f32_32x32x16_bf16 v[224:239], v[60:63], a[40:43], v[224:239]
  ds_read_b64_tr_b16 v[80:81], v106 offset:13312
  s_add_u32 s29, s88, 28672
  s_add_u32 m0, s61, 135168
  s_nop 0
  buffer_load_dwordx4 v112, s[48:51], s29 offen offset:0 lds
  v_mfma_f32_32x32x16_bf16 v[240:255], v[60:63], a[44:47], v[240:255]
  ds_read_b64_tr_b16 v[82:83], v106 offset:15360
  s_waitcnt vmcnt(20) lgkmcnt(8)
  v_mfma_f32_32x32x16_bf16 v[128:143], v[64:67], a[48:51], v[128:143]
  ds_read_b64_tr_b16 v[84:85], v107 offset:13312
  buffer_load_dwordx4 a[116:119], v111, s[12:15], s22 offen offset:2048 sc1
  v_mfma_f32_32x32x16_bf16 v[144:159], v[64:67], a[52:55], v[144:159]
  ds_read_b64_tr_b16 v[86:87], v107 offset:15360
  s_waitcnt lgkmcnt(8)
  v_mfma_f32_32x32x16_bf16 v[160:175], v[68:71], a[48:51], v[160:175]
  ds_read_b64_tr_b16 v[88:89], v108 offset:13312
  buffer_load_dwordx4 v113, s[48:51], s29 offen offset:1024 lds
  v_mfma_f32_32x32x16_bf16 v[176:191], v[68:71], a[52:55], v[176:191]
  ds_read_b64_tr_b16 v[90:91], v108 offset:15360
  buffer_load_dwordx4 a[120:123], v110, s[12:15], s22 offen offset:3072 sc1
  s_waitcnt lgkmcnt(8)
  v_mfma_f32_32x32x16_bf16 v[192:207], v[72:75], a[48:51], v[192:207]
  ds_read_b64_tr_b16 v[92:93], v109 offset:13312
  v_mfma_f32_32x32x16_bf16 v[208:223], v[72:75], a[52:55], v[208:223]
  ds_read_b64_tr_b16 v[94:95], v109 offset:15360
  s_waitcnt lgkmcnt(8)
  v_mfma_f32_32x32x16_bf16 v[224:239], v[76:79], a[48:51], v[224:239]
  ds_read_b64_tr_b16 v[32:33], v106 offset:32768
  buffer_load_dwordx4 a[124:127], v111, s[12:15], s22 offen offset:3072 sc1
  buffer_load_dwordx4 v114, s[48:51], s29 offen offset:2048 lds
  v_mfma_f32_32x32x16_bf16 v[240:255], v[76:79], a[52:55], v[240:255]
  ds_read_b64_tr_b16 v[34:35], v106 offset:34816
  s_waitcnt vmcnt(23) lgkmcnt(8)
  v_mfma_f32_32x32x16_bf16 v[128:143], v[80:83], a[56:59], v[128:143]
  ds_read_b64_tr_b16 v[36:37], v107 offset:32768
  v_mfma_f32_32x32x16_bf16 v[144:159], v[80:83], a[60:63], v[144:159]
  ds_read_b64_tr_b16 v[38:39], v107 offset:34816
  s_waitcnt lgkmcnt(8)
  v_mfma_f32_32x32x16_bf16 v[160:175], v[84:87], a[56:59], v[160:175]
  ds_read_b64_tr_b16 v[40:41], v108 offset:32768
  buffer_load_dwordx4 v115, s[48:51], s29 offen offset:3072 lds
  v_mfma_f32_32x32x16_bf16 v[176:191], v[84:87], a[60:63], v[176:191]
  ds_read_b64_tr_b16 v[42:43], v108 offset:34816
  s_waitcnt lgkmcnt(8)
  v_mfma_f32_32x32x16_bf16 v[192:207], v[88:91], a[56:59], v[192:207]
  ds_read_b64_tr_b16 v[44:45], v109 offset:32768
  v_mfma_f32_32x32x16_bf16 v[208:223], v[88:91], a[60:63], v[208:223]
  ds_read_b64_tr_b16 v[46:47], v109 offset:34816
  s_waitcnt lgkmcnt(8)
  v_mfma_f32_32x32x16_bf16 v[224:239], v[92:95], a[56:59], v[224:239]
  ds_read_b64_tr_b16 v[48:49], v106 offset:33792
  v_mfma_f32_32x32x16_bf16 v[240:255], v[92:95], a[60:63], v[240:255]
  ds_read_b64_tr_b16 v[50:51], v106 offset:35840
  s_waitcnt vmcnt(22) lgkmcnt(8)
  v_mfma_f32_32x32x16_bf16 v[128:143], v[32:35], a[64:67], v[128:143]
  ds_read_b64_tr_b16 v[52:53], v107 offset:33792
  s_barrier
  v_mfma_f32_32x32x16_bf16 v[144:159], v[32:35], a[68:71], v[144:159]
  ds_read_b64_tr_b16 v[54:55], v107 offset:35840
  buffer_load_dwordx4 a[128:131], v110, s[12:15], s23 offen offset:0 sc1
  s_waitcnt lgkmcnt(8)
  v_mfma_f32_32x32x16_bf16 v[160:175], v[36:39], a[64:67], v[160:175]
  ds_read_b64_tr_b16 v[56:57], v108 offset:33792
  v_mfma_f32_32x32x16_bf16 v[176:191], v[36:39], a[68:71], v[176:191]
  ds_read_b64_tr_b16 v[58:59], v108 offset:35840
  s_waitcnt lgkmcnt(8)
  v_mfma_f32_32x32x16_bf16 v[192:207], v[40:43], a[64:67], v[192:207]
  ds_read_b64_tr_b16 v[60:61], v109 offset:33792
  buffer_load_dwordx4 a[132:135], v111, s[12:15], s23 offen offset:0 sc1
  s_add_u32 m0, s61, 0
  s_nop 0
  buffer_load_dwordx4 v112, s[48:51], s89 offen offset:0 lds
  v_mfma_f32_32x32x16_bf16 v[208:223], v[40:43], a[68:71], v[208:223]
  ds_read_b64_tr_b16 v[62:63], v109 offset:35840
  s_waitcnt lgkmcnt(8)
  v_mfma_f32_32x32x16_bf16 v[224:239], v[44:47], a[64:67], v[224:239]
  ds_read_b64_tr_b16 v[64:65], v106 offset:40960
  v_mfma_f32_32x32x16_bf16 v[240:255], v[44:47], a[68:71], v[240:255]
  ds_read_b64_tr_b16 v[66:67], v106 offset:43008
  buffer_load_dwordx4 a[136:139], v110, s[12:15], s23 offen offset:1024 sc1
  s_waitcnt vmcnt(24) lgkmcnt(8)
  v_mfma_f32_32x32x16_bf16 v[128:143], v[48:51], a[72:75], v[128:143]
  ds_read_b64_tr_b16 v[68:69], v107 offset:40960
  buffer_load_dwordx4 v113, s[48:51], s89 offen offset:1024 lds
  v_mfma_f32_32x32x16_bf16 v[144:159], v[48:51], a[76:79], v[144:159]
  ds_read_b64_tr_b16 v[70:71], v107 offset:43008
  s_waitcnt lgkmcnt(8)
  v_mfma_f32_32x32x16_bf16 v[160:175], v[52:55], a[72:75], v[160:175]
  ds_read_b64_tr_b16 v[72:73], v108 offset:40960
  buffer_load_dwordx4 a[140:143], v111, s[12:15], s23 offen offset:1024 sc1
  v_mfma_f32_32x32x16_bf16 v[176:191], v[52:55], a[76:79], v[176:191]
  ds_read_b64_tr_b16 v[74:75], v108 offset:43008
  s_waitcnt lgkmcnt(8)
  v_mfma_f32_32x32x16_bf16 v[192:207], v[56:59], a[72:75], v[192:207]
  ds_read_b64_tr_b16 v[76:77], v109 offset:40960
  buffer_load_dwordx4 v114, s[48:51], s89 offen offset:2048 lds
  v_mfma_f32_32x32x16_bf16 v[208:223], v[56:59], a[76:79], v[208:223]
  ds_read_b64_tr_b16 v[78:79], v109 offset:43008
  buffer_load_dwordx4 a[144:147], v110, s[12:15], s23 offen offset:2048 sc1
  s_waitcnt lgkmcnt(8)
  v_mfma_f32_32x32x16_bf16 v[224:239], v[60:63], a[72:75], v[224:239]
  ds_read_b64_tr_b16 v[80:81], v106 offset:41984
  s_waitcnt vmcnt(8)
  ds_read_b64_tr_b16 a[224:225], v104 offset:0
  v_mfma_f32_32x32x16_bf16 v[240:255], v[60:63], a[76:79], v[240:255]
  ds_read_b64_tr_b16 v[82:83], v106 offset:44032
  s_waitcnt lgkmcnt(9)
  v_mfma_f32_32x32x16_bf16 v[128:143], v[64:67], a[80:83], v[128:143]
  ds_read_b64_tr_b16 v[84:85], v107 offset:41984
  buffer_load_dwordx4 a[148:151], v111, s[12:15], s23 offen offset:2048 sc1
  buffer_load_dwordx4 v115, s[48:51], s89 offen offset:3072 lds
  ds_read_b64_tr_b16 a[226:227], v104 offset:512
  v_mfma_f32_32x32x16_bf16 v[144:159], v[64:67], a[84:87], v[144:159]
  ds_read_b64_tr_b16 v[86:87], v107 offset:44032
  s_waitcnt lgkmcnt(10)
  v_mfma_f32_32x32x16_bf16 v[160:175], v[68:71], a[80:83], v[160:175]
  ds_read_b64_tr_b16 v[88:89], v108 offset:41984
  ds_read_b64_tr_b16 a[228:229], v105 offset:0
  v_mfma_f32_32x32x16_bf16 v[176:191], v[68:71], a[84:87], v[176:191]
  ds_read_b64_tr_b16 v[90:91], v108 offset:44032
  buffer_load_dwordx4 a[152:155], v110, s[12:15], s23 offen offset:3072 sc1
  s_waitcnt lgkmcnt(11)
  v_mfma_f32_32x32x16_bf16 v[192:207], v[72:75], a[80:83], v[192:207]
  ds_read_b64_tr_b16 v[92:93], v109 offset:41984
  s_add_u32 s29, s89, 28672
  s_add_u32 m0, s61, 4096
  s_nop 0
  buffer_load_dwordx4 v112, s[48:51], s29 offen offset:0 lds
  ds_read_b64_tr_b16 a[230:231], v105 offset:512
  v_mfma_f32_32x32x16_bf16 v[208:223], v[72:75], a[84:87], v[208:223]
  ds_read_b64_tr_b16 v[94:95], v109 offset:44032
  s_waitcnt lgkmcnt(12)
  v_mfma_f32_32x32x16_bf16 v[224:239], v[76:79], a[80:83], v[224:239]
  ds_read_b64_tr_b16 v[32:33], v106 offset:36864
  buffer_load_dwordx4 a[156:159], v111, s[12:15], s23 offen offset:3072 sc1
  ds_read_b64_tr_b16 a[232:233], v104 offset:2048
  v_mfma_f32_32x32x16_bf16 v[240:255], v[76:79], a[84:87], v[240:255]
  ds_read_b64_tr_b16 v[34:35], v106 offset:38912
  s_waitcnt lgkmcnt(12)
  v_mfma_f32_32x32x16_bf16 v[128:143], v[80:83], a[88:91], v[128:143]
  ds_read_b64_tr_b16 v[36:37], v107 offset:36864
  buffer_load_dwordx4 v113, s[48:51], s29 offen offset:1024 lds
  ds_read_b64_tr_b16 a[234:235], v104 offset:2560
  v_mfma_f32_32x32x16_bf16 v[144:159], v[80:83], a[92:95], v[144:159]
  ds_read_b64_tr_b16 v[38:39], v107 offset:38912
  s_waitcnt lgkmcnt(12)
  v_mfma_f32_32x32x16_bf16 v[160:175], v[84:87], a[88:91], v[160:175]
  ds_read_b64_tr_b16 v[40:41], v108 offset:36864
  ds_read_b64_tr_b16 a[236:237], v105 offset:2048
  v_mfma_f32_32x32x16_bf16 v[176:191], v[84:87], a[92:95], v[176:191]
  ds_read_b64_tr_b16 v[42:43], v108 offset:38912
  s_waitcnt lgkmcnt(12)
  v_mfma_f32_32x32x16_bf16 v[192:207], v[88:91], a[88:91], v[192:207]
  ds_read_b64_tr_b16 v[44:45], v109 offset:36864
  buffer_load_dwordx4 v114, s[48:51], s29 offen offset:2048 lds
  ds_read_b64_tr_b16 a[238:239], v105 offset:2560
  v_mfma_f32_32x32x16_bf16 v[208:223], v[88:91], a[92:95], v[208:223]
  ds_read_b64_tr_b16 v[46:47], v109 offset:38912
  s_waitcnt lgkmcnt(12)
  v_mfma_f32_32x32x16_bf16 v[224:239], v[92:95], a[88:91], v[224:239]
  ds_read_b64_tr_b16 v[48:49], v106 offset:37888
  ds_read_b64_tr_b16 a[240:241], v104 offset:4096
  v_mfma_f32_32x32x16_bf16 v[240:255], v[92:95], a[92:95], v[240:255]
  ds_read_b64_tr_b16 v[50:51], v106 offset:39936
  s_waitcnt lgkmcnt(12)
  v_mfma_f32_32x32x16_bf16 v[128:143], v[32:35], a[96:99], v[128:143]
  ds_read_b64_tr_b16 v[52:53], v107 offset:37888
  buffer_load_dwordx4 v115, s[48:51], s29 offen offset:3072 lds
  ds_read_b64_tr_b16 a[242:243], v104 offset:4608
  v_mfma_f32_32x32x16_bf16 v[144:159], v[32:35], a[100:103], v[144:159]
  ds_read_b64_tr_b16 v[54:55], v107 offset:39936
  buffer_load_dwordx4 a[160:163], v110, s[12:15], s24 offen offset:0 sc1
  s_waitcnt lgkmcnt(12)
  v_mfma_f32_32x32x16_bf16 v[160:175], v[36:39], a[96:99], v[160:175]
  ds_read_b64_tr_b16 v[56:57], v108 offset:37888
  ds_read_b64_tr_b16 a[244:245], v105 offset:4096
  v_mfma_f32_32x32x16_bf16 v[176:191], v[36:39], a[100:103], v[176:191]
  ds_read_b64_tr_b16 v[58:59], v108 offset:39936
  s_waitcnt lgkmcnt(12)
  v_mfma_f32_32x32x16_bf16 v[192:207], v[40:43], a[96:99], v[192:207]
  ds_read_b64_tr_b16 v[60:61], v109 offset:37888
  buffer_load_dwordx4 a[164:167], v111, s[12:15], s24 offen offset:0 sc1
  ds_read_b64_tr_b16 a[246:247], v105 offset:4608
  v_mfma_f32_32x32x16_bf16 v[208:223], v[40:43], a[100:103], v[208:223]
  ds_read_b64_tr_b16 v[62:63], v109 offset:39936
  s_waitcnt lgkmcnt(12)
  v_mfma_f32_32x32x16_bf16 v[224:239], v[44:47], a[96:99], v[224:239]
  ds_read_b64_tr_b16 v[64:65], v106 offset:45056
  ds_read_b64_tr_b16 a[248:249], v104 offset:6144
  v_mfma_f32_32x32x16_bf16 v[240:255], v[44:47], a[100:103], v[240:255]
  ds_read_b64_tr_b16 v[66:67], v106 offset:47104
  buffer_load_dwordx4 a[168:171], v110, s[12:15], s24 offen offset:1024 sc1
  s_waitcnt lgkmcnt(12)
  v_mfma_f32_32x32x16_bf16 v[128:143], v[48:51], a[104:107], v[128:143]
  ds_read_b64_tr_b16 v[68:69], v107 offset:45056
  ds_read_b64_tr_b16 a[250:251], v104 offset:6656
  v_mfma_f32_32x32x16_bf16 v[144:159], v[48:51], a[108:111], v[144:159]
  ds_read_b64_tr_b16 v[70:71], v107 offset:47104
  s_waitcnt lgkmcnt(12)
  v_mfma_f32_32x32x16_bf16 v[160:175], v[52:55], a[104:107], v[160:175]
  ds_read_b64_tr_b16 v[72:73], v108 offset:45056
  buffer_load_dwordx4 a[172:175], v111, s[12:15], s24 offen offset:1024 sc1
  ds_read_b64_tr_b16 a[252:253], v105 offset:6144
  v_mfma_f32_32x32x16_bf16 v[176:191], v[52:55], a[108:111], v[176:191]
  ds_read_b64_tr_b16 v[74:75], v108 offset:47104
  s_waitcnt lgkmcnt(12)
  v_mfma_f32_32x32x16_bf16 v[192:207], v[56:59], a[104:107], v[192:207]
  ds_read_b64_tr_b16 v[76:77], v109 offset:45056
  ds_read_b64_tr_b16 a[254:255], v105 offset:6656
  v_mfma_f32_32x32x16_bf16 v[208:223], v[56:59], a[108:111], v[208:223]
  ds_read_b64_tr_b16 v[78:79], v109 offset:47104
  buffer_load_dwordx4 a[176:179], v110, s[12:15], s24 offen offset:2048 sc1
  s_waitcnt lgkmcnt(12)
  v_mfma_f32_32x32x16_bf16 v[224:239], v[60:63], a[104:107], v[224:239]
  ds_read_b64_tr_b16 v[80:81], v106 offset:46080
  v_mfma_f32_32x32x16_bf16 v[240:255], v[60:63], a[108:111], v[240:255]
  ds_read_b64_tr_b16 v[82:83], v106 offset:48128
  s_waitcnt lgkmcnt(11)
  v_mfma_f32_32x32x16_bf16 v[128:143], v[64:67], a[112:115], v[128:143]
  ds_read_b64_tr_b16 v[84:85], v107 offset:46080
  buffer_load_dwordx4 a[180:183], v111, s[12:15], s24 offen offset:2048 sc1
  s_add_u32 m0, s61, 131072
  s_nop 0
  buffer_load_dwordx4 v112, s[48:51], s90 offen offset:0 lds
  v_mfma_f32_32x32x16_bf16 v[144:159], v[64:67], a[116:119], v[144:159]
  ds_read_b64_tr_b16 v[86:87], v107 offset:48128
  s_waitcnt lgkmcnt(10)
  v_mfma_f32_32x32x16_bf16 v[160:175], v[68:71], a[112:115], v[160:175]
  ds_read_b64_tr_b16 v[88:89], v108 offset:46080
  v_mfma_f32_32x32x16_bf16 v[176:191], v[68:71], a[116:119], v[176:191]
  ds_read_b64_tr_b16 v[90:91], v108 offset:48128
  buffer_load_dwordx4 a[184:187], v110, s[12:15], s24 offen offset:3072 sc1
  s_waitcnt lgkmcnt(9)
  v_mfma_f32_32x32x16_bf16 v[192:207], v[72:75], a[112:115], v[192:207]
  ds_read_b64_tr_b16 v[92:93], v109 offset:46080
  buffer_load_dwordx4 v113, s[48:51], s90 offen offset:1024 lds
  v_mfma_f32_32x32x16_bf16 v[208:223], v[72:75], a[116:119], v[208:223]
  ds_read_b64_tr_b16 v[94:95], v109 offset:48128
  s_waitcnt lgkmcnt(8)
  v_mfma_f32_32x32x16_bf16 v[224:239], v[76:79], a[112:115], v[224:239]
  v_add_u32 v106, 65536, v106
  v_add_u32 v107, 65536, v107
  v_add_u32 v108, 65536, v108
  v_add_u32 v109, 65536, v109
  ds_read_b64_tr_b16 v[32:33], v106 offset:0
  buffer_load_dwordx4 a[188:191], v111, s[12:15], s24 offen offset:3072 sc1
  v_mfma_f32_32x32x16_bf16 v[240:255], v[76:79], a[116:119], v[240:255]
  ds_read_b64_tr_b16 v[34:35], v106 offset:2048
  s_waitcnt lgkmcnt(8)
  v_mfma_f32_32x32x16_bf16 v[128:143], v[80:83], a[120:123], v[128:143]
  ds_read_b64_tr_b16 v[36:37], v107 offset:0
  buffer_load_dwordx4 v114, s[48:51], s90 offen offset:2048 lds
  v_mfma_f32_32x32x16_bf16 v[144:159], v[80:83], a[124:127], v[144:159]
  ds_read_b64_tr_b16 v[38:39], v107 offset:2048
  s_waitcnt lgkmcnt(8)
  v_mfma_f32_32x32x16_bf16 v[160:175], v[84:87], a[120:123], v[160:175]
  ds_read_b64_tr_b16 v[40:41], v108 offset:0
  v_mfma_f32_32x32x16_bf16 v[176:191], v[84:87], a[124:127], v[176:191]
  ds_read_b64_tr_b16 v[42:43], v108 offset:2048
  s_waitcnt lgkmcnt(8)
  v_mfma_f32_32x32x16_bf16 v[192:207], v[88:91], a[120:123], v[192:207]
  ds_read_b64_tr_b16 v[44:45], v109 offset:0
  buffer_load_dwordx4 v115, s[48:51], s90 offen offset:3072 lds
  v_mfma_f32_32x32x16_bf16 v[208:223], v[88:91], a[124:127], v[208:223]
  ds_read_b64_tr_b16 v[46:47], v109 offset:2048
  s_waitcnt lgkmcnt(8)
  v_mfma_f32_32x32x16_bf16 v[224:239], v[92:95], a[120:123], v[224:239]
  ds_read_b64_tr_b16 v[48:49], v106 offset:1024
  v_mfma_f32_32x32x16_bf16 v[240:255], v[92:95], a[124:127], v[240:255]
  ds_read_b64_tr_b16 v[50:51], v106 offset:3072
  s_waitcnt vmcnt(26) lgkmcnt(8)
  v_mfma_f32_32x32x16_bf16 v[128:143], v[32:35], a[128:131], v[128:143]
  ds_read_b64_tr_b16 v[52:53], v107 offset:1024
  s_barrier
  s_add_u32 s29, s90, 28672
  s_add_u32 m0, s61, 135168
  s_nop 0
  buffer_load_dwordx4 v112, s[48:51], s29 offen offset:0 lds
  v_mfma_f32_32x32x16_bf16 v[144:159], v[32:35], a[132:135], v[144:159]
  ds_read_b64_tr_b16 v[54:55], v107 offset:3072
  buffer_load_dwordx4 a[192:195], v110, s[12:15], s25 offen offset:0 sc1
  s_waitcnt lgkmcnt(8)
  v_mfma_f32_32x32x16_bf16 v[160:175], v[36:39], a[128:131], v[160:175]
  ds_read_b64_tr_b16 v[56:57], v108 offset:1024
  v_mfma_f32_32x32x16_bf16 v[176:191], v[36:39], a[132:135], v[176:191]
  ds_read_b64_tr_b16 v[58:59], v108 offset:3072
  s_waitcnt lgkmcnt(8)
  v_mfma_f32_32x32x16_bf16 v[192:207], v[40:43], a[128:131], v[192:207]
  ds_read_b64_tr_b16 v[60:61], v109 offset:1024
  buffer_load_dwordx4 a[196:199], v111, s[12:15], s25 offen offset:0 sc1
  buffer_load_dwordx4 v113, s[48:51], s29 offen offset:1024 lds
  v_mfma_f32_32x32x16_bf16 v[208:223], v[40:43], a[132:135], v[208:223]
  ds_read_b64_tr_b16 v[62:63], v109 offset:3072
  s_waitcnt lgkmcnt(8)
  v_mfma_f32_32x32x16_bf16 v[224:239], v[44:47], a[128:131], v[224:239]
  ds_read_b64_tr_b16 v[64:65], v106 offset:8192
  v_mfma_f32_32x32x16_bf16 v[240:255], v[44:47], a[132:135], v[240:255]
  ds_read_b64_tr_b16 v[66:67], v106 offset:10240
  buffer_load_dwordx4 a[200:203], v110, s[12:15], s25 offen offset:1024 sc1
  s_waitcnt vmcnt(27) lgkmcnt(8)
  v_mfma_f32_32x32x16_bf16 v[128:143], v[48:51], a[136:139], v[128:143]
  ds_read_b64_tr_b16 v[68:69], v107 offset:8192
  buffer_load_dwordx4 v114, s[48:51], s29 offen offset:2048 lds
  v_mfma_f32_32x32x16_bf16 v[144:159], v[48:51], a[140:143], v[144:159]
  ds_read_b64_tr_b16 v[70:71], v107 offset:10240
  s_waitcnt lgkmcnt(8)
  v_mfma_f32_32x32x16_bf16 v[160:175], v[52:55], a[136:139], v[160:175]
  ds_read_b64_tr_b16 v[72:73], v108 offset:8192
  buffer_load_dwordx4 a[204:207], v111, s[12:15], s25 offen offset:1024 sc1
  v_mfma_f32_32x32x16_bf16 v[176:191], v[52:55], a[140:143], v[176:191]
  ds_read_b64_tr_b16 v[74:75], v108 offset:10240
  s_waitcnt lgkmcnt(8)
  v_mfma_f32_32x32x16_bf16 v[192:207], v[56:59], a[136:139], v[192:207]
  ds_read_b64_tr_b16 v[76:77], v109 offset:8192
  buffer_load_dwordx4 v115, s[48:51], s29 offen offset:3072 lds
  s_waitcnt vmcnt(20)
  ds_read_b64_tr_b16 a[0:1], v100 offset:0
  v_mfma_f32_32x32x16_bf16 v[208:223], v[56:59], a[140:143], v[208:223]
  ds_read_b64_tr_b16 v[78:79], v109 offset:10240
  buffer_load_dwordx4 a[208:211], v110, s[12:15], s25 offen offset:2048 sc1
  s_waitcnt lgkmcnt(9)
  v_mfma_f32_32x32x16_bf16 v[224:239], v[60:63], a[136:139], v[224:239]
  ds_read_b64_tr_b16 v[80:81], v106 offset:9216
  ds_read_b64_tr_b16 a[2:3], v100 offset:512
  v_mfma_f32_32x32x16_bf16 v[240:255], v[60:63], a[140:143], v[240:255]
  ds_read_b64_tr_b16 v[82:83], v106 offset:11264
  s_waitcnt lgkmcnt(10)
  v_mfma_f32_32x32x16_bf16 v[128:143], v[64:67], a[144:147], v[128:143]
  ds_read_b64_tr_b16 v[84:85], v107 offset:9216
  buffer_load_dwordx4 a[212:215], v111, s[12:15], s25 offen offset:2048 sc1
  ds_read_b64_tr_b16 a[4:5], v101 offset:0
  v_mfma_f32_32x32x16_bf16 v[144:159], v[64:67], a[148:151], v[144:159]
  ds_read_b64_tr_b16 v[86:87], v107 offset:11264
  s_waitcnt lgkmcnt(11)
  v_mfma_f32_32x32x16_bf16 v[160:175], v[68:71], a[144:147], v[160:175]
  ds_read_b64_tr_b16 v[88:89], v108 offset:9216
  ds_read_b64_tr_b16 a[6:7], v101 offset:512
  v_mfma_f32_32x32x16_bf16 v[176:191], v[68:71], a[148:151], v[176:191]
  ds_read_b64_tr_b16 v[90:91], v108 offset:11264
  buffer_load_dwordx4 a[216:219], v110, s[12:15], s25 offen offset:3072 sc1
  s_waitcnt lgkmcnt(12)
  v_mfma_f32_32x32x16_bf16 v[192:207], v[72:75], a[144:147], v[192:207]
  ds_read_b64_tr_b16 v[92:93], v109 offset:9216
  ds_read_b64_tr_b16 a[8:9], v100 offset:2048
  v_mfma_f32_32x32x16_bf16 v[208:223], v[72:75], a[148:151], v[208:223]
  ds_read_b64_tr_b16 v[94:95], v109 offset:11264
  s_waitcnt lgkmcnt(12)
  v_mfma_f32_32x32x16_bf16 v[224:239], v[76:79], a[144:147], v[224:239]
  ds_read_b64_tr_b16 v[32:33], v106 offset:4096
  buffer_load_dwordx4 a[220:223], v111, s[12:15], s25 offen offset:3072 sc1
  s_add_u32 m0, s61, 32768
  s_nop 0
  buffer_load_dwordx4 v112, s[48:51], s91 offen offset:0 lds
  ds_read_b64_tr_b16 a[10:11], v100 offset:2560
  v_mfma_f32_32x32x16_bf16 v[240:255], v[76:79], a[148:151], v[240:255]
  ds_read_b64_tr_b16 v[34:35], v106 offset:6144
  s_waitcnt lgkmcnt(12)
  v_mfma_f32_32x32x16_bf16 v[128:143], v[80:83], a[152:155], v[128:143]
  ds_read_b64_tr_b16 v[36:37], v107 offset:4096
  ds_read_b64_tr_b16 a[12:13], v101 offset:2048
  v_mfma_f32_32x32x16_bf16 v[144:159], v[80:83], a[156:159], v[144:159]
  ds_read_b64_tr_b16 v[38:39], v107 offset:6144
  s_waitcnt lgkmcnt(12)
  v_mfma_f32_32x32x16_bf16 v[160:175], v[84:87], a[152:155], v[160:175]
  ds_read_b64_tr_b16 v[40:41], v108 offset:4096
  buffer_load_dwordx4 v113, s[48:51], s91 offen offset:1024 lds
  ds_read_b64_tr_b16 a[14:15], v101 offset:2560
  v_mfma_f32_32x32x16_bf16 v[176:191], v[84:87], a[156:159], v[176:191]
  ds_read_b64_tr_b16 v[42:43], v108 offset:6144
  s_waitcnt lgkmcnt(12)
  v_mfma_f32_32x32x16_bf16 v[192:207], v[88:91], a[152:155], v[192:207]
  ds_read_b64_tr_b16 v[44:45], v109 offset:4096
  ds_read_b64_tr_b16 a[16:17], v100 offset:4096
  v_mfma_f32_32x32x16_bf16 v[208:223], v[88:91], a[156:159], v[208:223]
  ds_read_b64_tr_b16 v[46:47], v109 offset:6144
  s_waitcnt lgkmcnt(12)
  v_mfma_f32_32x32x16_bf16 v[224:239], v[92:95], a[152:155], v[224:239]
  ds_read_b64_tr_b16 v[48:49], v106 offset:5120
  buffer_load_dwordx4 v114, s[48:51], s91 offen offset:2048 lds
  ds_read_b64_tr_b16 a[18:19], v100 offset:4608
  v_mfma_f32_32x32x16_bf16 v[240:255], v[92:95], a[156:159], v[240:255]
  ds_read_b64_tr_b16 v[50:51], v106 offset:7168
  s_waitcnt vmcnt(25) lgkmcnt(12)
  v_mfma_f32_32x32x16_bf16 v[128:143], v[32:35], a[160:163], v[128:143]
  ds_read_b64_tr_b16 v[52:53], v107 offset:5120
  ds_read_b64_tr_b16 a[20:21], v101 offset:4096
  v_mfma_f32_32x32x16_bf16 v[144:159], v[32:35], a[164:167], v[144:159]
  ds_read_b64_tr_b16 v[54:55], v107 offset:7168
  s_waitcnt lgkmcnt(12)
  v_mfma_f32_32x32x16_bf16 v[160:175], v[36:39], a[160:163], v[160:175]
  ds_read_b64_tr_b16 v[56:57], v108 offset:5120
  buffer_load_dwordx4 v115, s[48:51], s91 offen offset:3072 lds
  ds_read_b64_tr_b16 a[22:23], v101 offset:4608
  v_mfma_f32_32x32x16_bf16 v[176:191], v[36:39], a[164:167], v[176:191]
  ds_read_b64_tr_b16 v[58:59], v108 offset:7168
  s_waitcnt lgkmcnt(12)
  v_mfma_f32_32x32x16_bf16 v[192:207], v[40:43], a[160:163], v[192:207]
  ds_read_b64_tr_b16 v[60:61], v109 offset:5120
  ds_read_b64_tr_b16 a[24:25], v100 offset:6144
  v_mfma_f32_32x32x16_bf16 v[208:223], v[40:43], a[164:167], v[208:223]
  ds_read_b64_tr_b16 v[62:63], v109 offset:7168
  s_waitcnt lgkmcnt(12)
  v_mfma_f32_32x32x16_bf16 v[224:239], v[44:47], a[160:163], v[224:239]
  ds_read_b64_tr_b16 v[64:65], v106 offset:12288
  s_add_u32 s29, s91, 28672
  s_add_u32 m0, s61, 36864
  s_nop 0
  buffer_load_dwordx4 v112, s[48:51], s29 offen offset:0 lds
  ds_read_b64_tr_b16 a[26:27], v100 offset:6656
  v_mfma_f32_32x32x16_bf16 v[240:255], v[44:47], a[164:167], v[240:255]
  ds_read_b64_tr_b16 v[66:67], v106 offset:14336
  s_waitcnt vmcnt(25) lgkmcnt(12)
  v_mfma_f32_32x32x16_bf16 v[128:143], v[48:51], a[168:171], v[128:143]
  ds_read_b64_tr_b16 v[68:69], v107 offset:12288
  ds_read_b64_tr_b16 a[28:29], v101 offset:6144
  v_mfma_f32_32x32x16_bf16 v[144:159], v[48:51], a[172:175], v[144:159]
  ds_read_b64_tr_b16 v[70:71], v107 offset:14336
  s_waitcnt lgkmcnt(12)
  v_mfma_f32_32x32x16_bf16 v[160:175], v[52:55], a[168:171], v[160:175]
  ds_read_b64_tr_b16 v[72:73], v108 offset:12288
  buffer_load_dwordx4 v113, s[48:51], s29 offen offset:1024 lds
  ds_read_b64_tr_b16 a[30:31], v101 offset:6656
  v_mfma_f32_32x32x16_bf16 v[176:191], v[52:55], a[172:175], v[176:191]
  ds_read_b64_tr_b16 v[74:75], v108 offset:14336
  s_waitcnt lgkmcnt(12)
  v_mfma_f32_32x32x16_bf16 v[192:207], v[56:59], a[168:171], v[192:207]
  ds_read_b64_tr_b16 v[76:77], v109 offset:12288
  v_mfma_f32_32x32x16_bf16 v[208:223], v[56:59], a[172:175], v[208:223]
  ds_read_b64_tr_b16 v[78:79], v109 offset:14336
  s_waitcnt lgkmcnt(11)
  v_mfma_f32_32x32x16_bf16 v[224:239], v[60:63], a[168:171], v[224:239]
  ds_read_b64_tr_b16 v[80:81], v106 offset:13312
  buffer_load_dwordx4 v114, s[48:51], s29 offen offset:2048 lds
  v_mfma_f32_32x32x16_bf16 v[240:255], v[60:63], a[172:175], v[240:255]
  ds_read_b64_tr_b16 v[82:83], v106 offset:15360
  s_waitcnt vmcnt(25) lgkmcnt(10)
  v_mfma_f32_32x32x16_bf16 v[128:143], v[64:67], a[176:179], v[128:143]
  ds_read_b64_tr_b16 v[84:85], v107 offset:13312
  v_mfma_f32_32x32x16_bf16 v[144:159], v[64:67], a[180:183], v[144:159]
  ds_read_b64_tr_b16 v[86:87], v107 offset:15360
  s_waitcnt lgkmcnt(9)
  v_mfma_f32_32x32x16_bf16 v[160:175], v[68:71], a[176:179], v[160:175]
  ds_read_b64_tr_b16 v[88:89], v108 offset:13312
  buffer_load_dwordx4 v115, s[48:51], s29 offen offset:3072 lds
  v_mfma_f32_32x32x16_bf16 v[176:191], v[68:71], a[180:183], v[176:191]
  ds_read_b64_tr_b16 v[90:91], v108 offset:15360
  s_waitcnt lgkmcnt(8)
  v_mfma_f32_32x32x16_bf16 v[192:207], v[72:75], a[176:179], v[192:207]
  ds_read_b64_tr_b16 v[92:93], v109 offset:13312
  v_mfma_f32_32x32x16_bf16 v[208:223], v[72:75], a[180:183], v[208:223]
  ds_read_b64_tr_b16 v[94:95], v109 offset:15360
  s_waitcnt lgkmcnt(8)
  v_mfma_f32_32x32x16_bf16 v[224:239], v[76:79], a[176:179], v[224:239]
  ds_read_b64_tr_b16 v[32:33], v106 offset:32768
  v_mfma_f32_32x32x16_bf16 v[240:255], v[76:79], a[180:183], v[240:255]
  ds_read_b64_tr_b16 v[34:35], v106 offset:34816
  s_waitcnt vmcnt(22) lgkmcnt(8)
  v_mfma_f32_32x32x16_bf16 v[128:143], v[80:83], a[184:187], v[128:143]
  ds_read_b64_tr_b16 v[36:37], v106 offset:33792
  s_add_u32 m0, s61, 0
  s_nop 0
  buffer_load_dwordx4 v112, s[48:51], s92 offen offset:0 lds
  v_mfma_f32_32x32x16_bf16 v[144:159], v[80:83], a[188:191], v[144:159]
  ds_read_b64_tr_b16 v[38:39], v106 offset:35840
  s_waitcnt lgkmcnt(8)
  v_mfma_f32_32x32x16_bf16 v[160:175], v[84:87], a[184:187], v[160:175]
  ds_read_b64_tr_b16 v[40:41], v106 offset:40960
  v_mfma_f32_32x32x16_bf16 v[176:191], v[84:87], a[188:191], v[176:191]
  ds_read_b64_tr_b16 v[42:43], v106 offset:43008
  s_waitcnt lgkmcnt(8)
  v_mfma_f32_32x32x16_bf16 v[192:207], v[88:91], a[184:187], v[192:207]
  ds_read_b64_tr_b16 v[44:45], v106 offset:41984
  buffer_load_dwordx4 v113, s[48:51], s92 offen offset:1024 lds
  v_mfma_f32_32x32x16_bf16 v[208:223], v[88:91], a[188:191], v[208:223]
  ds_read_b64_tr_b16 v[46:47], v106 offset:44032
  s_waitcnt lgkmcnt(8)
  v_mfma_f32_32x32x16_bf16 v[224:239], v[92:95], a[184:187], v[224:239]
  ds_read_b64_tr_b16 v[48:49], v107 offset:32768
  v_mfma_f32_32x32x16_bf16 v[240:255], v[92:95], a[188:191], v[240:255]
  ds_read_b64_tr_b16 v[50:51], v107 offset:34816
  s_waitcnt vmcnt(19) lgkmcnt(8)
  v_mfma_f32_32x32x16_bf16 v[128:143], v[32:35], a[192:195], v[128:143]
  ds_read_b64_tr_b16 v[52:53], v107 offset:33792
  buffer_load_dwordx4 v114, s[48:51], s92 offen offset:2048 lds
  v_mfma_f32_32x32x16_bf16 v[144:159], v[32:35], a[196:199], v[144:159]
  ds_read_b64_tr_b16 v[54:55], v107 offset:35840
  s_waitcnt vmcnt(16) lgkmcnt(8)
  v_mfma_f32_32x32x16_bf16 v[128:143], v[36:39], a[200:203], v[128:143]
  ds_read_b64_tr_b16 v[56:57], v107 offset:40960
  v_mfma_f32_32x32x16_bf16 v[144:159], v[36:39], a[204:207], v[144:159]
  ds_read_b64_tr_b16 v[58:59], v107 offset:43008
  s_waitcnt vmcnt(13) lgkmcnt(8)
  v_mfma_f32_32x32x16_bf16 v[128:143], v[40:43], a[208:211], v[128:143]
  ds_read_b64_tr_b16 v[60:61], v107 offset:41984
  buffer_load_dwordx4 v115, s[48:51], s92 offen offset:3072 lds
  v_mfma_f32_32x32x16_bf16 v[144:159], v[40:43], a[212:215], v[144:159]
  ds_read_b64_tr_b16 v[62:63], v107 offset:44032
  s_waitcnt vmcnt(12) lgkmcnt(8)
  v_mfma_f32_32x32x16_bf16 v[128:143], v[44:47], a[216:219], v[128:143]
  ds_read_b64_tr_b16 v[64:65], v108 offset:32768
  v_mfma_f32_32x32x16_bf16 v[144:159], v[44:47], a[220:223], v[144:159]
  ds_read_b64_tr_b16 v[66:67], v108 offset:34816
  s_waitcnt lgkmcnt(8)
  v_mfma_f32_32x32x16_bf16 v[160:175], v[48:51], a[192:195], v[160:175]
  ds_read_b64_tr_b16 v[68:69], v108 offset:33792
  s_add_u32 s29, s92, 28672
  s_add_u32 m0, s61, 4096
  s_nop 0
  buffer_load_dwordx4 v112, s[48:51], s29 offen offset:0 lds
  v_mfma_f32_32x32x16_bf16 v[176:191], v[48:51], a[196:199], v[176:191]
  ds_read_b64_tr_b16 v[70:71], v108 offset:35840
  s_nop 5
  v_mul_f32 v128, v128, v136
  v_mul_f32 v129, v129, v137
  v_mul_f32 v130, v130, v138
  v_mul_f32 v131, v131, v139
  s_waitcnt lgkmcnt(8)
  v_mfma_f32_32x32x16_bf16 v[160:175], v[52:55], a[200:203], v[160:175]
  ds_read_b64_tr_b16 v[72:73], v108 offset:40960
  v_mul_f32 v132, v132, v140
  v_mul_f32 v133, v133, v141
  v_mul_f32 v134, v134, v142
  v_mul_f32 v135, v135, v143
  v_mfma_f32_32x32x16_bf16 v[176:191], v[52:55], a[204:207], v[176:191]
  ds_read_b64_tr_b16 v[74:75], v108 offset:43008
  v_cvt_pk_bf16_f32 v136, v128, v129
  v_cvt_pk_bf16_f32 v137, v130, v131
  v_cvt_pk_bf16_f32 v138, v132, v133
  v_cvt_pk_bf16_f32 v139, v134, v135
  s_waitcnt lgkmcnt(8)
  v_mfma_f32_32x32x16_bf16 v[160:175], v[56:59], a[208:211], v[160:175]
  ds_read_b64_tr_b16 v[76:77], v108 offset:41984
  buffer_load_dwordx4 v113, s[48:51], s29 offen offset:1024 lds
  buffer_store_dwordx4 v[136:139], v110, s[16:19], 0 offen offset:0 sc1
  v_mul_f32 v144, v144, v152
  v_mul_f32 v145, v145, v153
  v_mul_f32 v146, v146, v154
  v_mfma_f32_32x32x16_bf16 v[176:191], v[56:59], a[212:215], v[176:191]
  ds_read_b64_tr_b16 v[78:79], v108 offset:44032
  v_mul_f32 v147, v147, v155
  v_mul_f32 v148, v148, v156
  v_mul_f32 v149, v149, v157
  v_mul_f32 v150, v150, v158
  s_waitcnt lgkmcnt(8)
  v_mfma_f32_32x32x16_bf16 v[160:175], v[60:63], a[216:219], v[160:175]
  ds_read_b64_tr_b16 v[80:81], v109 offset:32768
  v_mul_f32 v151, v151, v159
  v_cvt_pk_bf16_f32 v152, v144, v145
  v_cvt_pk_bf16_f32 v153, v146, v147
  v_cvt_pk_bf16_f32 v154, v148, v149
  v_mfma_f32_32x32x16_bf16 v[176:191], v[60:63], a[220:223], v[176:191]
  ds_read_b64_tr_b16 v[82:83], v109 offset:34816
  v_cvt_pk_bf16_f32 v155, v150, v151
  buffer_store_dwordx4 v[152:155], v110, s[16:19], s28 offen offset:0 sc1
  s_waitcnt lgkmcnt(8)
  v_mfma_f32_32x32x16_bf16 v[192:207], v[64:67], a[192:195], v[192:207]
  ds_read_b64_tr_b16 v[84:85], v109 offset:33792
  buffer_load_dwordx4 v114, s[48:51], s29 offen offset:2048 lds
  v_mfma_f32_32x32x16_bf16 v[208:223], v[64:67], a[196:199], v[208:223]
  ds_read_b64_tr_b16 v[86:87], v109 offset:35840
  s_nop 5
  v_mul_f32 v160, v160, v168
  v_mul_f32 v161, v161, v169
  v_mul_f32 v162, v162, v170
  v_mul_f32 v163, v163, v171
  s_waitcnt lgkmcnt(8)
  v_mfma_f32_32x32x16_bf16 v[192:207], v[68:71], a[200:203], v[192:207]
  ds_read_b64_tr_b16 v[88:89], v109 offset:40960
  v_mul_f32 v164, v164, v172
  v_mul_f32 v165, v165, v173
  v_mul_f32 v166, v166, v174
  v_mul_f32 v167, v167, v175
  v_mfma_f32_32x32x16_bf16 v[208:223], v[68:71], a[204:207], v[208:223]
  ds_read_b64_tr_b16 v[90:91], v109 offset:43008
  v_cvt_pk_bf16_f32 v168, v160, v161
  v_cvt_pk_bf16_f32 v169, v162, v163
  v_cvt_pk_bf16_f32 v170, v164, v165
  v_cvt_pk_bf16_f32 v171, v166, v167
  s_waitcnt lgkmcnt(8)
  v_mfma_f32_32x32x16_bf16 v[192:207], v[72:75], a[208:211], v[192:207]
  ds_read_b64_tr_b16 v[92:93], v109 offset:41984
  buffer_load_dwordx4 v115, s[48:51], s29 offen offset:3072 lds
  buffer_store_dwordx4 v[168:171], v110, s[16:19], 0 offen offset:1024 sc1
  v_mul_f32 v176, v176, v184
  v_mul_f32 v177, v177, v185
  v_mul_f32 v178, v178, v186
  v_mfma_f32_32x32x16_bf16 v[208:223], v[72:75], a[212:215], v[208:223]
  ds_read_b64_tr_b16 v[94:95], v109 offset:44032
  v_mul_f32 v179, v179, v187
  v_mul_f32 v180, v180, v188
  v_mul_f32 v181, v181, v189
  v_mul_f32 v182, v182, v190
  s_waitcnt lgkmcnt(8)
  v_mfma_f32_32x32x16_bf16 v[192:207], v[76:79], a[216:219], v[192:207]
  v_mul_f32 v183, v183, v191
  v_cvt_pk_bf16_f32 v184, v176, v177
  v_cvt_pk_bf16_f32 v185, v178, v179
  v_cvt_pk_bf16_f32 v186, v180, v181
  v_mfma_f32_32x32x16_bf16 v[208:223], v[76:79], a[220:223], v[208:223]
  v_cvt_pk_bf16_f32 v187, v182, v183
  buffer_store_dwordx4 v[184:187], v110, s[16:19], s28 offen offset:1024 sc1
  s_waitcnt lgkmcnt(6)
  v_mfma_f32_32x32x16_bf16 v[224:239], v[80:83], a[192:195], v[224:239]
  v_mfma_f32_32x32x16_bf16 v[240:255], v[80:83], a[196:199], v[240:255]
  s_nop 5
  v_mul_f32 v192, v192, v200
  v_mul_f32 v193, v193, v201
  v_mul_f32 v194, v194, v202
  v_mul_f32 v195, v195, v203
  s_waitcnt lgkmcnt(4)
  v_mfma_f32_32x32x16_bf16 v[224:239], v[84:87], a[200:203], v[224:239]
  v_mul_f32 v196, v196, v204
  v_mul_f32 v197, v197, v205
  v_mul_f32 v198, v198, v206
  v_mul_f32 v199, v199, v207
  v_mfma_f32_32x32x16_bf16 v[240:255], v[84:87], a[204:207], v[240:255]
  v_cvt_pk_bf16_f32 v200, v192, v193
  v_cvt_pk_bf16_f32 v201, v194, v195
  v_cvt_pk_bf16_f32 v202, v196, v197
  v_cvt_pk_bf16_f32 v203, v198, v199
  s_waitcnt lgkmcnt(2)
  v_mfma_f32_32x32x16_bf16 v[224:239], v[88:91], a[208:211], v[224:239]
  buffer_store_dwordx4 v[200:203], v110, s[16:19], 0 offen offset:2048 sc1
  v_mul_f32 v208, v208, v216
  v_mul_f32 v209, v209, v217
  v_mul_f32 v210, v210, v218
  v_mfma_f32_32x32x16_bf16 v[240:255], v[88:91], a[212:215], v[240:255]
  v_mul_f32 v211, v211, v219
  v_mul_f32 v212, v212, v220
  v_mul_f32 v213, v213, v221
  v_mul_f32 v214, v214, v222
  s_waitcnt lgkmcnt(0)
  v_mfma_f32_32x32x16_bf16 v[224:239], v[92:95], a[216:219], v[224:239]
  v_mul_f32 v215, v215, v223
  v_cvt_pk_bf16_f32 v216, v208, v209
  v_cvt_pk_bf16_f32 v217, v210, v211
  v_cvt_pk_bf16_f32 v218, v212, v213
  v_mfma_f32_32x32x16_bf16 v[240:255], v[92:95], a[220:223], v[240:255]
  v_cvt_pk_bf16_f32 v219, v214, v215
  buffer_store_dwordx4 v[216:219], v110, s[16:19], s28 offen offset:2048 sc1
  s_nop 9
  v_mul_f32 v224, v224, v232
  v_mul_f32 v225, v225, v233
  v_mul_f32 v226, v226, v234
  v_mul_f32 v227, v227, v235
  v_mul_f32 v228, v228, v236
  v_mul_f32 v229, v229, v237
  v_mul_f32 v230, v230, v238
  v_mul_f32 v231, v231, v239
  v_cvt_pk_bf16_f32 v232, v224, v225
  v_cvt_pk_bf16_f32 v233, v226, v227
  v_cvt_pk_bf16_f32 v234, v228, v229
  v_cvt_pk_bf16_f32 v235, v230, v231
  buffer_store_dwordx4 v[232:235], v110, s[16:19], 0 offen offset:3072 sc1
  v_mul_f32 v240, v240, v248
  v_mul_f32 v241, v241, v249
  v_mul_f32 v242, v242, v250
  v_mul_f32 v243, v243, v251
  v_mul_f32 v244, v244, v252
  v_mul_f32 v245, v245, v253
  v_mul_f32 v246, v246, v254
  v_mul_f32 v247, v247, v255
  v_cvt_pk_bf16_f32 v248, v240, v241
  v_cvt_pk_bf16_f32 v249, v242, v243
  v_cvt_pk_bf16_f32 v250, v244, v245
  v_cvt_pk_bf16_f32 v251, v246, v247
  buffer_store_dwordx4 v[248:251], v110, s[16:19], s28 offen offset:3072 sc1
  s_and_b32 s8, s2, 7
  s_bfe_u32 s9, s2, 0x20003
  s_lshl2_add_u32 s8, s8, s9
  s_lshr_b32 s9, s2, 5
  s_lshr_b32 s3, s59, 1
  s_mul_i32 s3, s3, 114688
  v_lshl_add_u32 v12, v2, 4, s3
  v_xor_b32 v13, 114688, v12
  s_mul_i32 s10, s8, 229376
  s_mul_i32 s11, s59, 28672
  s_add_u32 s10, s10, s11
  s_add_u32 s10, s10, 8388608
  s_add_u32 s12, s6, s10
  s_addc_u32 s13, s7, 0
  s_and_b32 s13, s13, 0xffff
  s_mov_b32 s14, 143360
  s_mov_b32 s15, 0x20000
  v_lshrrev_b32 v3, 5, v2
  s_and_b32 s30, s59, 1
  v_lshl_add_u32 v21, v2, 4, s61
  v_xor_b32 v18, 8192, v21
  v_xor_b32 v19, 16384, v21
  v_xor_b32 v20, 24576, v21
  v_and_b32 v4, 4, v2
  v_bfe_u32 v5, v2, 3, 2
  v_add_u32 v4, v4, v5
  v_and_b32 v5, 3, v2
  v_lshl_add_u32 v4, v4, 2, v5
  v_mul_u32_u24 v4, 896, v4
  v_lshl_add_u32 v22, v3, 4, v4
  v_lshlrev_b32 v23, 6, v3
  s_lshr_b32 s10, s59, 1
  s_lshl1_add_u32 s10, s8, s10
  s_mul_i32 s10, s10, 28672
  s_lshl1_add_u32 s11, s9, s30
  s_lshl_b32 s31, s11, 6
  s_add_u32 s10, s10, s31
  s_add_u32 s24, s46, s10
  s_addc_u32 s25, s47, 0
  s_and_b32 s25, s25, 0xffff
  s_mov_b32 s26, 27840
  s_mov_b32 s27, 0x20000
  s_mul_i32 s31, s31, 31
  s_add_u32 s10, s10, s31
  s_add_u32 s10, s10, 4194304
  s_add_u32 s20, s6, s10
  s_addc_u32 s21, s7, 0
  s_and_b32 s21, s21, 0xffff
  s_mov_b32 s22, 2048
  s_mov_b32 s23, 0x20000
  v_and_b32 v4, 31, v2
  v_lshlrev_b32 v4, 4, v4
  v_lshl_add_u32 v10, v3, 10, v4
  s_lshl_b32 s11, s11, 7
  s_add_u32 s11, s11, 10240
  s_add_u32 s32, s6, s11
  s_addc_u32 s33, s7, 0
  s_and_b32 s33, s33, 0xffff
  s_mov_b32 s34, 128
  s_mov_b32 s35, 0x20000
  s_mul_i32 s8, s62, 37
  s_lshr_b32 s8, s8, 8
  s_lshl2_add_u32 s3, s37, s8
  s_lshl_b32 s3, s3, 7
  s_mul_i32 s8, s8, 7
  s_sub_u32 s8, s62, s8
  s_lshl2_add_u32 s3, s8, s3
  s_add_u32 s3, s3, 4096
  s_waitcnt vmcnt(0)
  s_barrier
  buffer_store_dword v117, v116, s[80:83], s3 offen sc1
  s_cmp_lt_u32 s58, 2
  s_cbranch_scc1 T_L58
  s_add_u32 s62, s62, 1
  s_sub_u32 s58, s58, 1
  s_branch T_AGAIN
T_L58:
  s_add_u32 m0, s61, 65536
  s_nop 0
  buffer_load_dwordx4 v112, s[48:51], s93 offen offset:0 lds
  buffer_load_dwordx4 v113, s[48:51], s93 offen offset:1024 lds
  buffer_load_dwordx4 v114, s[48:51], s93 offen offset:2048 lds
  buffer_load_dwordx4 v115, s[48:51], s93 offen offset:3072 lds
  s_add_u32 s29, s93, 28672
  s_add_u32 m0, s61, 69632
  s_nop 0
  buffer_load_dwordx4 v112, s[48:51], s29 offen offset:0 lds
  buffer_load_dwordx4 v113, s[48:51], s29 offen offset:1024 lds
  buffer_load_dwordx4 v114, s[48:51], s29 offen offset:2048 lds
  buffer_load_dwordx4 v115, s[48:51], s29 offen offset:3072 lds
  s_add_u32 m0, s61, 98304
  s_nop 0
  buffer_load_dwordx4 v112, s[48:51], s94 offen offset:0 lds
  buffer_load_dwordx4 v113, s[48:51], s94 offen offset:1024 lds
  buffer_load_dwordx4 v114, s[48:51], s94 offen offset:2048 lds
  buffer_load_dwordx4 v115, s[48:51], s94 offen offset:3072 lds
  s_add_u32 s29, s94, 28672
  s_add_u32 m0, s61, 102400
  s_nop 0
  buffer_load_dwordx4 v112, s[48:51], s29 offen offset:0 lds
  buffer_load_dwordx4 v113, s[48:51], s29 offen offset:1024 lds
  buffer_load_dwordx4 v114, s[48:51], s29 offen offset:2048 lds
  buffer_load_dwordx4 v115, s[48:51], s29 offen offset:3072 lds
  ds_read_b64_tr_b16 v[192:193], v104 offset:0
  ds_read_b64_tr_b16 v[194:195], v104 offset:512
  ds_read_b64_tr_b16 v[196:197], v105 offset:0
  ds_read_b64_tr_b16 v[198:199], v105 offset:512
  ds_read_b64_tr_b16 v[200:201], v104 offset:2048
  ds_read_b64_tr_b16 v[202:203], v104 offset:2560
  ds_read_b64_tr_b16 v[204:205], v105 offset:2048
  ds_read_b64_tr_b16 v[206:207], v105 offset:2560
  ds_read_b64_tr_b16 v[208:209], v104 offset:4096
  ds_read_b64_tr_b16 v[210:211], v104 offset:4608
  ds_read_b64_tr_b16 v[212:213], v105 offset:4096
  ds_read_b64_tr_b16 v[214:215], v105 offset:4608
  ds_read_b64_tr_b16 v[216:217], v104 offset:6144
  ds_read_b64_tr_b16 v[218:219], v104 offset:6656
  ds_read_b64_tr_b16 v[220:221], v105 offset:6144
  ds_read_b64_tr_b16 v[222:223], v105 offset:6656
  ds_read_b64_tr_b16 v[224:225], v100 offset:32768
  ds_read_b64_tr_b16 v[226:227], v100 offset:33280
  ds_read_b64_tr_b16 v[228:229], v101 offset:32768
  ds_read_b64_tr_b16 v[230:231], v101 offset:33280
  ds_read_b64_tr_b16 v[232:233], v100 offset:34816
  ds_read_b64_tr_b16 v[234:235], v100 offset:35328
  ds_read_b64_tr_b16 v[236:237], v101 offset:34816
  ds_read_b64_tr_b16 v[238:239], v101 offset:35328
  ds_read_b64_tr_b16 v[240:241], v100 offset:36864
  ds_read_b64_tr_b16 v[242:243], v100 offset:37376
  ds_read_b64_tr_b16 v[244:245], v101 offset:36864
  ds_read_b64_tr_b16 v[246:247], v101 offset:37376
  ds_read_b64_tr_b16 v[248:249], v100 offset:38912
  ds_read_b64_tr_b16 v[250:251], v100 offset:39424
  ds_read_b64_tr_b16 v[252:253], v101 offset:38912
  ds_read_b64_tr_b16 v[254:255], v101 offset:39424
  s_mov_b32 s60, 16384
  s_bitcmp1_b32 s39, 13
  s_cbranch_scc1 T_GW
  s_and_b32 s3, s2, 7
  s_lshl2_add_u32 s3, s3, s59
  s_lshl_b32 s3, s3, 7
  s_add_u32 s3, s3, 4096
  v_min_u32 v3, 24, v118
T_GL:
  buffer_load_dword v1, v3, s[80:83], s3 offen sc1
  s_sub_u32 s60, s60, 1
  s_cbranch_scc1 T_GW
  s_waitcnt vmcnt(0)
  v_cmp_ne_u32 vcc, 1, v1
  s_cbranch_vccnz T_GL
T_GW:
  s_waitcnt vmcnt(0)
T_GX:
  s_lshr_b32 s60, s60, 31
  buffer_load_dwordx4 a[32:35], v12, s[12:15], s95 offen offset:0 sc1
  buffer_load_dwordx4 a[36:39], v13, s[12:15], s95 offen offset:0 sc1
  buffer_load_dwordx4 a[40:43], v12, s[12:15], s95 offen offset:1024 sc1
  buffer_load_dwordx4 a[44:47], v13, s[12:15], s95 offen offset:1024 sc1
  buffer_load_dwordx4 a[48:51], v12, s[12:15], s95 offen offset:2048 sc1
  buffer_load_dwordx4 a[52:55], v13, s[12:15], s95 offen offset:2048 sc1
  buffer_load_dwordx4 a[56:59], v12, s[12:15], s95 offen offset:3072 sc1
  buffer_load_dwordx4 a[60:63], v13, s[12:15], s95 offen offset:3072 sc1
  buffer_load_dwordx4 a[64:67], v12, s[12:15], s96 offen offset:0 sc1
  buffer_load_dwordx4 a[68:71], v13, s[12:15], s96 offen offset:0 sc1
  buffer_load_dwordx4 a[72:75], v12, s[12:15], s96 offen offset:1024 sc1
  buffer_load_dwordx4 a[76:79], v13, s[12:15], s96 offen offset:1024 sc1
  buffer_load_dwordx4 a[80:83], v12, s[12:15], s96 offen offset:2048 sc1
  buffer_load_dwordx4 a[84:87], v13, s[12:15], s96 offen offset:2048 sc1
  buffer_load_dwordx4 a[88:91], v12, s[12:15], s96 offen offset:3072 sc1
  buffer_load_dwordx4 a[92:95], v13, s[12:15], s96 offen offset:3072 sc1
  buffer_load_dwordx4 a[96:99], v12, s[12:15], s97 offen offset:0 sc1
  buffer_load_dwordx4 a[100:103], v13, s[12:15], s97 offen offset:0 sc1
  buffer_load_dwordx4 a[104:107], v12, s[12:15], s97 offen offset:1024 sc1
  buffer_load_dwordx4 a[108:111], v13, s[12:15], s97 offen offset:1024 sc1
  buffer_load_dwordx4 a[112:115], v12, s[12:15], s97 offen offset:2048 sc1
  buffer_load_dwordx4 a[116:119], v13, s[12:15], s97 offen offset:2048 sc1
  buffer_load_dwordx4 a[120:123], v12, s[12:15], s97 offen offset:3072 sc1
  buffer_load_dwordx4 a[124:127], v13, s[12:15], s97 offen offset:3072 sc1
  s_waitcnt vmcnt(22)
  v_mfma_f32_32x32x16_bf16 v[128:143], a[224:227], a[32:35], 0
  buffer_load_dwordx4 a[128:131], v12, s[12:15], s98 offen offset:0 sc1
  v_mfma_f32_32x32x16_bf16 v[144:159], a[228:231], a[32:35], 0
  buffer_load_dwordx4 a[132:135], v13, s[12:15], s98 offen offset:0 sc1
  v_mfma_f32_32x32x16_bf16 v[160:175], a[224:227], a[36:39], 0
  buffer_load_dwordx4 a[136:139], v12, s[12:15], s98 offen offset:1024 sc1
  v_mfma_f32_32x32x16_bf16 v[176:191], a[228:231], a[36:39], 0
  buffer_load_dwordx4 a[140:143], v13, s[12:15], s98 offen offset:1024 sc1
  s_waitcnt vmcnt(24)
  v_mfma_f32_32x32x16_bf16 v[128:143], a[232:235], a[40:43], v[128:143]
  buffer_load_dwordx4 a[144:147], v12, s[12:15], s98 offen offset:2048 sc1
  v_mfma_f32_32x32x16_bf16 v[144:159], a[236:239], a[40:43], v[144:159]
  buffer_load_dwordx4 a[148:151], v13, s[12:15], s98 offen offset:2048 sc1
  v_mfma_f32_32x32x16_bf16 v[160:175], a[232:235], a[44:47], v[160:175]
  buffer_load_dwordx4 a[152:155], v12, s[12:15], s98 offen offset:3072 sc1
  v_mfma_f32_32x32x16_bf16 v[176:191], a[236:239], a[44:47], v[176:191]
  buffer_load_dwordx4 a[156:159], v13, s[12:15], s98 offen offset:3072 sc1
  s_waitcnt vmcnt(26)
  v_mfma_f32_32x32x16_bf16 v[128:143], a[240:243], a[48:51], v[128:143]
  v_mfma_f32_32x32x16_bf16 v[144:159], a[244:247], a[48:51], v[144:159]
  v_mfma_f32_32x32x16_bf16 v[160:175], a[240:243], a[52:55], v[160:175]
  v_mfma_f32_32x32x16_bf16 v[176:191], a[244:247], a[52:55], v[176:191]
  s_waitcnt vmcnt(24)
  v_mfma_f32_32x32x16_bf16 v[128:143], a[248:251], a[56:59], v[128:143]
  v_mfma_f32_32x32x16_bf16 v[144:159], a[252:255], a[56:59], v[144:159]
  v_mfma_f32_32x32x16_bf16 v[160:175], a[248:251], a[60:63], v[160:175]
  v_mfma_f32_32x32x16_bf16 v[176:191], a[252:255], a[60:63], v[176:191]
  s_waitcnt vmcnt(22)
  v_mfma_f32_32x32x16_bf16 v[128:143], a[0:3], a[64:67], v[128:143]
  buffer_load_dwordx4 a[160:163], v12, s[12:15], s99 offen offset:0 sc1
  v_mfma_f32_32x32x16_bf16 v[144:159], a[4:7], a[64:67], v[144:159]
  buffer_load_dwordx4 a[164:167], v13, s[12:15], s99 offen offset:0 sc1
  v_mfma_f32_32x32x16_bf16 v[160:175], a[0:3], a[68:71], v[160:175]
  buffer_load_dwordx4 a[168:171], v12, s[12:15], s99 offen offset:1024 sc1
  v_mfma_f32_32x32x16_bf16 v[176:191], a[4:7], a[68:71], v[176:191]
  buffer_load_dwordx4 a[172:175], v13, s[12:15], s99 offen offset:1024 sc1
  s_waitcnt vmcnt(24)
  v_mfma_f32_32x32x16_bf16 v[128:143], a[8:11], a[72:75], v[128:143]
  buffer_load_dwordx4 a[176:179], v12, s[12:15], s99 offen offset:2048 sc1
  v_mfma_f32_32x32x16_bf16 v[144:159], a[12:15], a[72:75], v[144:159]
  buffer_load_dwordx4 a[180:183], v13, s[12:15], s99 offen offset:2048 sc1
  v_mfma_f32_32x32x16_bf16 v[160:175], a[8:11], a[76:79], v[160:175]
  buffer_load_dwordx4 a[184:187], v12, s[12:15], s99 offen offset:3072 sc1
  v_mfma_f32_32x32x16_bf16 v[176:191], a[12:15], a[76:79], v[176:191]
  buffer_load_dwordx4 a[188:191], v13, s[12:15], s99 offen offset:3072 sc1
  s_waitcnt vmcnt(26)
  v_mfma_f32_32x32x16_bf16 v[128:143], a[16:19], a[80:83], v[128:143]
  v_mfma_f32_32x32x16_bf16 v[144:159], a[20:23], a[80:83], v[144:159]
  v_mfma_f32_32x32x16_bf16 v[160:175], a[16:19], a[84:87], v[160:175]
  v_mfma_f32_32x32x16_bf16 v[176:191], a[20:23], a[84:87], v[176:191]
  s_waitcnt vmcnt(24)
  v_mfma_f32_32x32x16_bf16 v[128:143], a[24:27], a[88:91], v[128:143]
  v_mfma_f32_32x32x16_bf16 v[144:159], a[28:31], a[88:91], v[144:159]
  v_mfma_f32_32x32x16_bf16 v[160:175], a[24:27], a[92:95], v[160:175]
  v_mfma_f32_32x32x16_bf16 v[176:191], a[28:31], a[92:95], v[176:191]
  s_waitcnt vmcnt(22) lgkmcnt(15)
  v_mfma_f32_32x32x16_bf16 v[128:143], v[192:195], a[96:99], v[128:143]
  buffer_load_dwordx4 a[192:195], v12, s[12:15], s100 offen offset:0 sc1
  v_mfma_f32_32x32x16_bf16 v[144:159], v[196:199], a[96:99], v[144:159]
  buffer_load_dwordx4 a[196:199], v13, s[12:15], s100 offen offset:0 sc1
  v_mfma_f32_32x32x16_bf16 v[160:175], v[192:195], a[100:103], v[160:175]
  buffer_load_dwordx4 a[200:203], v12, s[12:15], s100 offen offset:1024 sc1
  v_mfma_f32_32x32x16_bf16 v[176:191], v[196:199], a[100:103], v[176:191]
  buffer_load_dwordx4 a[204:207], v13, s[12:15], s100 offen offset:1024 sc1
  s_waitcnt vmcnt(24)
  v_mfma_f32_32x32x16_bf16 v[128:143], v[200:203], a[104:107], v[128:143]
  buffer_load_dwordx4 a[208:211], v12, s[12:15], s100 offen offset:2048 sc1
  v_mfma_f32_32x32x16_bf16 v[144:159], v[204:207], a[104:107], v[144:159]
  buffer_load_dwordx4 a[212:215], v13, s[12:15], s100 offen offset:2048 sc1
  v_mfma_f32_32x32x16_bf16 v[160:175], v[200:203], a[108:111], v[160:175]
  buffer_load_dwordx4 a[216:219], v12, s[12:15], s100 offen offset:3072 sc1
  v_mfma_f32_32x32x16_bf16 v[176:191], v[204:207], a[108:111], v[176:191]
  buffer_load_dwordx4 a[220:223], v13, s[12:15], s100 offen offset:3072 sc1
  s_waitcnt vmcnt(26)
  v_mfma_f32_32x32x16_bf16 v[128:143], v[208:211], a[112:115], v[128:143]
  v_mfma_f32_32x32x16_bf16 v[144:159], v[212:215], a[112:115], v[144:159]
  v_mfma_f32_32x32x16_bf16 v[160:175], v[208:211], a[116:119], v[160:175]
  v_mfma_f32_32x32x16_bf16 v[176:191], v[212:215], a[116:119], v[176:191]
  s_waitcnt vmcnt(24)
  v_mfma_f32_32x32x16_bf16 v[128:143], v[216:219], a[120:123], v[128:143]
  v_mfma_f32_32x32x16_bf16 v[144:159], v[220:223], a[120:123], v[144:159]
  v_mfma_f32_32x32x16_bf16 v[160:175], v[216:219], a[124:127], v[160:175]
  v_mfma_f32_32x32x16_bf16 v[176:191], v[220:223], a[124:127], v[176:191]
  s_waitcnt vmcnt(22) lgkmcnt(14)
  v_mfma_f32_32x32x16_bf16 v[128:143], v[224:227], a[128:131], v[128:143]
  buffer_load_dwordx4 a[32:35], v12, s[12:15], s101 offen offset:0 sc1
  s_waitcnt lgkmcnt(12)
  v_mfma_f32_32x32x16_bf16 v[144:159], v[228:231], a[128:131], v[144:159]
  buffer_load_dwordx4 a[36:39], v13, s[12:15], s101 offen offset:0 sc1
  v_mfma_f32_32x32x16_bf16 v[160:175], v[224:227], a[132:135], v[160:175]
  buffer_load_dwordx4 a[40:43], v12, s[12:15], s101 offen offset:1024 sc1
  v_mfma_f32_32x32x16_bf16 v[176:191], v[228:231], a[132:135], v[176:191]
  buffer_load_dwordx4 a[44:47], v13, s[12:15], s101 offen offset:1024 sc1
  s_waitcnt vmcnt(24) lgkmcnt(10)
  v_mfma_f32_32x32x16_bf16 v[128:143], v[232:235], a[136:139], v[128:143]
  buffer_load_dwordx4 a[48:51], v12, s[12:15], s101 offen offset:2048 sc1
  ds_read_b64_tr_b16 v[192:193], v100 offset:0
  ds_read_b64_tr_b16 v[194:195], v100 offset:512
  s_waitcnt lgkmcnt(10)
  v_mfma_f32_32x32x16_bf16 v[144:159], v[236:239], a[136:139], v[144:159]
  buffer_load_dwordx4 a[52:55], v13, s[12:15], s101 offen offset:2048 sc1
  ds_read_b64_tr_b16 v[196:197], v101 offset:0
  ds_read_b64_tr_b16 v[198:199], v101 offset:512
  v_mfma_f32_32x32x16_bf16 v[160:175], v[232:235], a[140:143], v[160:175]
  buffer_load_dwordx4 a[56:59], v12, s[12:15], s101 offen offset:3072 sc1
  ds_read_b64_tr_b16 v[200:201], v100 offset:2048
  ds_read_b64_tr_b16 v[202:203], v100 offset:2560
  v_mfma_f32_32x32x16_bf16 v[176:191], v[236:239], a[140:143], v[176:191]
  buffer_load_dwordx4 a[60:63], v13, s[12:15], s101 offen offset:3072 sc1
  ds_read_b64_tr_b16 v[204:205], v101 offset:2048
  ds_read_b64_tr_b16 v[206:207], v101 offset:2560
  s_waitcnt vmcnt(26) lgkmcnt(14)
  v_mfma_f32_32x32x16_bf16 v[128:143], v[240:243], a[144:147], v[128:143]
  ds_read_b64_tr_b16 v[208:209], v100 offset:4096
  ds_read_b64_tr_b16 v[210:211], v100 offset:4608
  s_waitcnt lgkmcnt(14)
  v_mfma_f32_32x32x16_bf16 v[144:159], v[244:247], a[144:147], v[144:159]
  ds_read_b64_tr_b16 v[212:213], v101 offset:4096
  ds_read_b64_tr_b16 v[214:215], v101 offset:4608
  v_mfma_f32_32x32x16_bf16 v[160:175], v[240:243], a[148:151], v[160:175]
  ds_read_b64_tr_b16 v[216:217], v100 offset:6144
  ds_read_b64_tr_b16 v[218:219], v100 offset:6656
  v_mfma_f32_32x32x16_bf16 v[176:191], v[244:247], a[148:151], v[176:191]
  ds_read_b64_tr_b16 v[220:221], v101 offset:6144
  ds_read_b64_tr_b16 v[222:223], v101 offset:6656
  s_waitcnt vmcnt(24) lgkmcnt(15)
  v_mfma_f32_32x32x16_bf16 v[128:143], v[248:251], a[152:155], v[128:143]
  v_mfma_f32_32x32x16_bf16 v[144:159], v[252:255], a[152:155], v[144:159]
  v_mfma_f32_32x32x16_bf16 v[160:175], v[248:251], a[156:159], v[160:175]
  v_mfma_f32_32x32x16_bf16 v[176:191], v[252:255], a[156:159], v[176:191]
  s_waitcnt vmcnt(22) lgkmcnt(14)
  v_mfma_f32_32x32x16_bf16 v[128:143], v[192:195], a[160:163], v[128:143]
  buffer_load_dwordx4 v[24:27], v10, s[20:23], 0 offen offset:0 sc1
  s_waitcnt lgkmcnt(12)
  v_mfma_f32_32x32x16_bf16 v[144:159], v[196:199], a[160:163], v[144:159]
  buffer_load_dwordx4 v[28:31], v10, s[20:23], 0 offen offset:512 sc1
  v_mfma_f32_32x32x16_bf16 v[160:175], v[192:195], a[164:167], v[160:175]
  buffer_load_dwordx4 v[32:35], v23, s[32:35], 0 offen offset:0 sc1
  v_mfma_f32_32x32x16_bf16 v[176:191], v[196:199], a[164:167], v[176:191]
  buffer_load_dwordx4 v[36:39], v23, s[32:35], 0 offen offset:32 sc1
  s_waitcnt vmcnt(24) lgkmcnt(10)
  v_mfma_f32_32x32x16_bf16 v[128:143], v[200:203], a[168:171], v[128:143]
  buffer_load_dwordx4 v[40:43], v23, s[32:35], 0 offen offset:16 sc1
  ds_read_b64_tr_b16 v[224:225], v102 offset:0
  ds_read_b64_tr_b16 v[226:227], v102 offset:512
  s_waitcnt lgkmcnt(10)
  v_mfma_f32_32x32x16_bf16 v[144:159], v[204:207], a[168:171], v[144:159]
  buffer_load_dwordx4 v[44:47], v23, s[32:35], 0 offen offset:48 sc1
  ds_read_b64_tr_b16 v[228:229], v103 offset:0
  ds_read_b64_tr_b16 v[230:231], v103 offset:512
  v_mfma_f32_32x32x16_bf16 v[160:175], v[200:203], a[172:175], v[160:175]
  ds_read_b64_tr_b16 v[232:233], v102 offset:2048
  ds_read_b64_tr_b16 v[234:235], v102 offset:2560
  v_mfma_f32_32x32x16_bf16 v[176:191], v[204:207], a[172:175], v[176:191]
  ds_read_b64_tr_b16 v[236:237], v103 offset:2048
  ds_read_b64_tr_b16 v[238:239], v103 offset:2560
  s_waitcnt vmcnt(24) lgkmcnt(14)
  v_mfma_f32_32x32x16_bf16 v[128:143], v[208:211], a[176:179], v[128:143]
  ds_read_b64_tr_b16 v[240:241], v102 offset:4096
  ds_read_b64_tr_b16 v[242:243], v102 offset:4608
  s_waitcnt lgkmcnt(14)
  v_mfma_f32_32x32x16_bf16 v[144:159], v[212:215], a[176:179], v[144:159]
  ds_read_b64_tr_b16 v[244:245], v103 offset:4096
  ds_read_b64_tr_b16 v[246:247], v103 offset:4608
  v_mfma_f32_32x32x16_bf16 v[160:175], v[208:211], a[180:183], v[160:175]
  ds_read_b64_tr_b16 v[248:249], v102 offset:6144
  ds_read_b64_tr_b16 v[250:251], v102 offset:6656
  v_mfma_f32_32x32x16_bf16 v[176:191], v[212:215], a[180:183], v[176:191]
  ds_read_b64_tr_b16 v[252:253], v103 offset:6144
  ds_read_b64_tr_b16 v[254:255], v103 offset:6656
  s_waitcnt vmcnt(22) lgkmcnt(15)
  v_mfma_f32_32x32x16_bf16 v[128:143], v[216:219], a[184:187], v[128:143]
  v_mfma_f32_32x32x16_bf16 v[144:159], v[220:223], a[184:187], v[144:159]
  v_mfma_f32_32x32x16_bf16 v[160:175], v[216:219], a[188:191], v[160:175]
  v_mfma_f32_32x32x16_bf16 v[176:191], v[220:223], a[188:191], v[176:191]
  s_waitcnt vmcnt(20) lgkmcnt(14)
  v_mfma_f32_32x32x16_bf16 v[128:143], v[224:227], a[192:195], v[128:143]
  v_mov_b32 v4, s60
  ds_write_b32 v21, v4 offset:36864
  s_waitcnt lgkmcnt(13)
  v_mfma_f32_32x32x16_bf16 v[144:159], v[228:231], a[192:195], v[144:159]
  v_mfma_f32_32x32x16_bf16 v[160:175], v[224:227], a[196:199], v[160:175]
  v_mfma_f32_32x32x16_bf16 v[176:191], v[228:231], a[196:199], v[176:191]
  s_waitcnt vmcnt(18) lgkmcnt(11)
  v_mfma_f32_32x32x16_bf16 v[128:143], v[232:235], a[200:203], v[128:143]
  ds_read_b64_tr_b16 v[196:197], v103 offset:32768
  ds_read_b64_tr_b16 v[198:199], v103 offset:33280
  s_waitcnt lgkmcnt(11)
  v_mfma_f32_32x32x16_bf16 v[144:159], v[236:239], a[200:203], v[144:159]
  ds_read_b64_tr_b16 v[204:205], v103 offset:34816
  ds_read_b64_tr_b16 v[206:207], v103 offset:35328
  v_mfma_f32_32x32x16_bf16 v[160:175], v[232:235], a[204:207], v[160:175]
  ds_read_b64_tr_b16 v[212:213], v103 offset:36864
  ds_read_b64_tr_b16 v[214:215], v103 offset:37376
  v_mfma_f32_32x32x16_bf16 v[176:191], v[236:239], a[204:207], v[176:191]
  ds_read_b64_tr_b16 v[220:221], v103 offset:38912
  ds_read_b64_tr_b16 v[222:223], v103 offset:39424
  s_waitcnt vmcnt(16) lgkmcnt(15)
  v_mfma_f32_32x32x16_bf16 v[128:143], v[240:243], a[208:211], v[128:143]
  ds_read_b64_tr_b16 v[192:193], v102 offset:32768
  ds_read_b64_tr_b16 v[194:195], v102 offset:33280
  s_waitcnt lgkmcnt(15)
  v_mfma_f32_32x32x16_bf16 v[144:159], v[244:247], a[208:211], v[144:159]
  ds_read_b64_tr_b16 v[200:201], v102 offset:34816
  ds_read_b64_tr_b16 v[202:203], v102 offset:35328
  v_mfma_f32_32x32x16_bf16 v[160:175], v[240:243], a[212:215], v[160:175]
  ds_read_b64_tr_b16 v[208:209], v102 offset:36864
  ds_read_b64_tr_b16 v[210:211], v102 offset:37376
  v_mfma_f32_32x32x16_bf16 v[176:191], v[244:247], a[212:215], v[176:191]
  ds_read_b64_tr_b16 v[216:217], v102 offset:38912
  ds_read_b64_tr_b16 v[218:219], v102 offset:39424
  s_waitcnt vmcnt(14) lgkmcnt(15)
  v_mfma_f32_32x32x16_bf16 v[128:143], v[248:251], a[216:219], v[128:143]
  v_mfma_f32_32x32x16_bf16 v[144:159], v[252:255], a[216:219], v[144:159]
  v_mfma_f32_32x32x16_bf16 v[160:175], v[248:251], a[220:223], v[160:175]
  v_mfma_f32_32x32x16_bf16 v[176:191], v[252:255], a[220:223], v[176:191]
  s_waitcnt vmcnt(12) lgkmcnt(14)
  v_mfma_f32_32x32x16_bf16 v[144:159], v[196:199], a[32:35], v[144:159]
  s_waitcnt vmcnt(10) lgkmcnt(12)
  v_mfma_f32_32x32x16_bf16 v[144:159], v[204:207], a[40:43], v[144:159]
  s_waitcnt vmcnt(8) lgkmcnt(10)
  v_mfma_f32_32x32x16_bf16 v[144:159], v[212:215], a[48:51], v[144:159]
  s_waitcnt vmcnt(6) lgkmcnt(8)
  v_mfma_f32_32x32x16_bf16 v[144:159], v[220:223], a[56:59], v[144:159]
  v_mfma_f32_32x32x16_bf16 v[176:191], v[196:199], a[36:39], v[176:191]
  v_mfma_f32_32x32x16_bf16 v[176:191], v[204:207], a[44:47], v[176:191]
  v_mfma_f32_32x32x16_bf16 v[176:191], v[212:215], a[52:55], v[176:191]
  v_mfma_f32_32x32x16_bf16 v[176:191], v[220:223], a[60:63], v[176:191]
  s_waitcnt lgkmcnt(6)
  v_mfma_f32_32x32x16_bf16 v[160:175], v[192:195], a[36:39], v[160:175]
  s_nop 7
  ds_write_b128 v21, v[144:147] offset:0
  s_waitcnt lgkmcnt(5)
  v_mfma_f32_32x32x16_bf16 v[160:175], v[200:203], a[44:47], v[160:175]
  ds_write_b128 v21, v[148:151] offset:1024
  s_waitcnt lgkmcnt(4)
  v_mfma_f32_32x32x16_bf16 v[160:175], v[208:211], a[52:55], v[160:175]
  ds_write_b128 v21, v[152:155] offset:2048
  s_waitcnt lgkmcnt(3)
  v_mfma_f32_32x32x16_bf16 v[160:175], v[216:219], a[60:63], v[160:175]
  ds_write_b128 v21, v[156:159] offset:3072
  v_mfma_f32_32x32x16_bf16 v[128:143], v[192:195], a[32:35], v[128:143]
  ds_write_b128 v21, v[176:179] offset:32768
  v_mfma_f32_32x32x16_bf16 v[128:143], v[200:203], a[40:43], v[128:143]
  ds_write_b128 v21, v[180:183] offset:33792
  v_mfma_f32_32x32x16_bf16 v[128:143], v[208:211], a[48:51], v[128:143]
  ds_write_b128 v21, v[184:187] offset:34816
  v_mfma_f32_32x32x16_bf16 v[128:143], v[216:219], a[56:59], v[128:143]
  ds_write_b128 v21, v[188:191] offset:35840
  s_nop 3
  ds_write_b128 v21, v[160:163] offset:4096
  ds_write_b128 v21, v[164:167] offset:5120
  ds_write_b128 v21, v[168:171] offset:6144
  ds_write_b128 v21, v[172:175] offset:7168
  s_waitcnt lgkmcnt(0)
  s_barrier
  ds_read_b32 v5, v18 offset:36864
  ds_read_b32 v6, v19 offset:36864
  ds_read_b32 v7, v20 offset:36864
  ds_read_b128 v[192:195], v18 offset:0
  ds_read_b128 v[208:211], v19 offset:4096
  ds_read_b128 v[224:227], v20 offset:32768
  ds_read_b128 v[196:199], v18 offset:1024
  ds_read_b128 v[212:215], v19 offset:5120
  ds_read_b128 v[228:231], v20 offset:33792
  ds_read_b128 v[200:203], v18 offset:2048
  ds_read_b128 v[216:219], v19 offset:6144
  ds_read_b128 v[232:235], v20 offset:34816
  ds_read_b128 v[204:207], v18 offset:3072
  ds_read_b128 v[220:223], v19 offset:7168
  ds_read_b128 v[236:239], v20 offset:35840
  s_waitcnt vmcnt(0)
  v_lshlrev_b32 v48, 16, v24
  v_and_b32 v49, 0xffff0000, v24
  v_lshlrev_b32 v50, 16, v25
  v_and_b32 v51, 0xffff0000, v25
  v_lshlrev_b32 v52, 16, v28
  v_and_b32 v53, 0xffff0000, v28
  v_lshlrev_b32 v54, 16, v29
  v_and_b32 v55, 0xffff0000, v29
  v_lshlrev_b32 v56, 16, v26
  v_and_b32 v57, 0xffff0000, v26
  v_lshlrev_b32 v58, 16, v27
  v_and_b32 v59, 0xffff0000, v27
  v_lshlrev_b32 v60, 16, v30
  v_and_b32 v61, 0xffff0000, v30
  v_lshlrev_b32 v62, 16, v31
  v_and_b32 v63, 0xffff0000, v31
  s_waitcnt lgkmcnt(12)
  v_or3_b32 v4, v4, v5, v6
  v_or_b32 v4, v4, v7
  v_cmp_ne_u32 vcc, 0, v4
  s_cbranch_vccnz T_FB
  s_waitcnt lgkmcnt(9)
  v_pk_add_f32 v[128:129], v[128:129], v[192:193]
  v_pk_add_f32 v[208:209], v[208:209], v[224:225]
  v_pk_add_f32 v[130:131], v[130:131], v[194:195]
  v_pk_add_f32 v[210:211], v[210:211], v[226:227]
  v_pk_add_f32 v[128:129], v[128:129], v[208:209]
  v_pk_add_f32 v[130:131], v[130:131], v[210:211]
  v_pk_fma_f32 v[48:49], v[128:129], v[32:33], v[48:49]
  v_pk_fma_f32 v[50:51], v[130:131], v[34:35], v[50:51]
  v_cvt_pk_bf16_f32 v24, v48, v49
  v_cvt_pk_bf16_f32 v25, v50, v51
  s_waitcnt lgkmcnt(6)
  v_pk_add_f32 v[132:133], v[132:133], v[196:197]
  v_pk_add_f32 v[212:213], v[212:213], v[228:229]
  v_pk_add_f32 v[134:135], v[134:135], v[198:199]
  v_pk_add_f32 v[214:215], v[214:215], v[230:231]
  v_pk_add_f32 v[132:133], v[132:133], v[212:213]
  v_pk_add_f32 v[134:135], v[134:135], v[214:215]
  v_pk_fma_f32 v[52:53], v[132:133], v[36:37], v[52:53]
  v_pk_fma_f32 v[54:55], v[134:135], v[38:39], v[54:55]
  v_cvt_pk_bf16_f32 v26, v52, v53
  v_cvt_pk_bf16_f32 v27, v54, v55
  buffer_store_dwordx4 v[24:27], v22, s[24:27], 0 offen offset:0
  s_waitcnt lgkmcnt(3)
  v_pk_add_f32 v[136:137], v[136:137], v[200:201]
  v_pk_add_f32 v[216:217], v[216:217], v[232:233]
  v_pk_add_f32 v[138:139], v[138:139], v[202:203]
  v_pk_add_f32 v[218:219], v[218:219], v[234:235]
  v_pk_add_f32 v[136:137], v[136:137], v[216:217]
  v_pk_add_f32 v[138:139], v[138:139], v[218:219]
  v_pk_fma_f32 v[56:57], v[136:137], v[40:41], v[56:57]
  v_pk_fma_f32 v[58:59], v[138:139], v[42:43], v[58:59]
  v_cvt_pk_bf16_f32 v28, v56, v57
  v_cvt_pk_bf16_f32 v29, v58, v59
  s_waitcnt lgkmcnt(0)
  v_pk_add_f32 v[140:141], v[140:141], v[204:205]
  v_pk_add_f32 v[220:221], v[220:221], v[236:237]
  v_pk_add_f32 v[142:143], v[142:143], v[206:207]
  v_pk_add_f32 v[222:223], v[222:223], v[238:239]
  v_pk_add_f32 v[140:141], v[140:141], v[220:221]
  v_pk_add_f32 v[142:143], v[142:143], v[222:223]
  v_pk_fma_f32 v[60:61], v[140:141], v[44:45], v[60:61]
  v_pk_fma_f32 v[62:63], v[142:143], v[46:47], v[62:63]
  v_cvt_pk_bf16_f32 v30, v60, v61
  v_cvt_pk_bf16_f32 v31, v62, v63
  buffer_store_dwordx4 v[28:31], v22, s[24:27], 0 offen offset:32
  s_endpgm
T_FB:
  s_waitcnt vmcnt(0) lgkmcnt(0)
  s_barrier
  s_cmp_ge_u32 s38, 224
  s_cbranch_scc1 K1_END
  s_and_b32 s3, s39, 0xff
  s_add_u32 s3, s3, 1
  s_bitcmp1_b32 s39, 13
  s_cselect_b32 s2, s3, 0
  s_or_b32 s39, s2, 0xb000
  s_cmp_lt_u32 s2, 84
  s_cbranch_scc1 K1_TOP
  s_or_b32 s39, s2, 0x3000
  s_and_b32 s37, s38, 7
  s_lshl_b32 s36, s37, 5
  s_add_u32 s2, s2, s36
  s_sub_u32 s2, s2, 84
  s_cmp_lt_u32 s3, 116
  s_cbranch_scc1 K1_TOP
  s_mov_b32 s2, s38
  s_movk_i32 s39, 0x2000
  s_mov_b32 s62, 0
  s_mov_b32 s58, 28
  s_mov_b32 s63, 32
T_AGAIN:
  s_waitcnt vmcnt(0) lgkmcnt(0)
  s_barrier
  s_branch T_TOP
T_PF:
  s_bfe_u32 s3, s2, 0x20003
  s_lshl_b32 s3, s3, 15
  v_lshlrev_b32 v4, 7, v0
  v_add_u32 v4, s3, v4
  s_mov_b32 s20, s44
  s_and_b32 s21, s45, 0xffff
  s_mov_b32 s22, 1605632
  s_mov_b32 s23, 0x20000
  buffer_load_dword v5, v4, s[20:23], 0 offen
  v_add_u32 v4, 131072, v4
  buffer_load_dword v5, v4, s[20:23], 0 offen
  v_add_u32 v4, 131072, v4
  buffer_load_dword v5, v4, s[20:23], 0 offen
  v_add_u32 v4, 131072, v4
  buffer_load_dword v5, v4, s[20:23], 0 offen
  v_add_u32 v4, 131072, v4
  buffer_load_dword v5, v4, s[20:23], 0 offen
  v_add_u32 v4, 131072, v4
  buffer_load_dword v5, v4, s[20:23], 0 offen
  v_add_u32 v4, 131072, v4
  buffer_load_dword v5, v4, s[20:23], 0 offen
  v_add_u32 v4, 131072, v4
  buffer_load_dword v5, v4, s[20:23], 0 offen
  v_add_u32 v4, 131072, v4
  buffer_load_dword v5, v4, s[20:23], 0 offen
  v_add_u32 v4, 131072, v4
  buffer_load_dword v5, v4, s[20:23], 0 offen
  v_add_u32 v4, 131072, v4
  buffer_load_dword v5, v4, s[20:23], 0 offen
  v_add_u32 v4, 131072, v4
  buffer_load_dword v5, v4, s[20:23], 0 offen
  v_add_u32 v4, 131072, v4
  buffer_load_dword v5, v4, s[20:23], 0 offen
  v_add_u32 v4, 131072, v4
K1_END:
  s_endpgm
K1_FB:
  s_nop 7
  s_mov_b32 s62, 0x7f800000
  s_waitcnt vmcnt(0) lgkmcnt(0)
  v_lshrrev_b32 v1, 5, v2
  v_and_b32 v3, 31, v2
  v_lshlrev_b32 v47, 1, v1
  v_xor_b32 v52, v3, v47
  v_xor_b32 v3, v3, v1
  v_xor_b32 v47, 0, v3
  v_lshlrev_b32 v47, 4, v47
  v_lshl_add_u32 v34, v1, 9, v47
  v_xor_b32 v47, 0, v52
  v_lshlrev_b32 v47, 4, v47
  v_lshl_add_u32 v38, v1, 9, v47
  v_xor_b32 v47, 4, v3
  v_lshlrev_b32 v47, 4, v47
  v_lshl_add_u32 v35, v1, 9, v47
  v_xor_b32 v47, 4, v52
  v_lshlrev_b32 v47, 4, v47
  v_lshl_add_u32 v39, v1, 9, v47
  v_xor_b32 v47, 8, v3
  v_lshlrev_b32 v47, 4, v47
  v_lshl_add_u32 v36, v1, 9, v47
  v_xor_b32 v47, 8, v52
  v_lshlrev_b32 v47, 4, v47
  v_lshl_add_u32 v40, v1, 9, v47
  v_xor_b32 v47, 12, v3
  v_lshlrev_b32 v47, 4, v47
  v_lshl_add_u32 v37, v1, 9, v47
  v_xor_b32 v47, 12, v52
  v_lshlrev_b32 v47, 4, v47
  v_lshl_add_u32 v41, v1, 9, v47
  s_and_b32 s42, s3, 1
  s_mul_i32 s42, s42, 16640
  v_and_b32 v1, 15, v2
  v_lshlrev_b32 v1, 9, v1
  v_add_u32 v1, s42, v1
  v_and_b32 v3, 6, v2
  v_lshlrev_b32 v3, 1, v3
  v_and_b32 v47, 1, v2
  v_or_b32 v3, v3, v47
  v_bfe_u32 v47, v2, 4, 1
  v_lshlrev_b32 v47, 1, v47
  v_xor_b32 v3, v3, v47
  v_lshrrev_b32 v47, 5, v2
  v_xor_b32 v3, v3, v47
  v_xor_b32 v47, 0, v3
  v_lshl_add_u32 v8, v47, 4, v1
  v_xor_b32 v12, 0x100, v8
  v_xor_b32 v47, 4, v3
  v_lshl_add_u32 v9, v47, 4, v1
  v_xor_b32 v13, 0x100, v9
  v_xor_b32 v47, 8, v3
  v_lshl_add_u32 v10, v47, 4, v1
  v_xor_b32 v14, 0x100, v10
  v_xor_b32 v47, 12, v3
  v_lshl_add_u32 v11, v47, 4, v1
  v_xor_b32 v15, 0x100, v11
  v_lshrrev_b32 v52, 2, v2
  v_lshlrev_b32 v1, 9, v52
  v_add_u32 v1, s42, v1
  v_add_u32 v1, 65536, v1
  v_and_b32 v47, 1, v2
  v_lshl_add_u32 v1, v47, 3, v1
  v_and_b32 v3, 7, v52
  v_lshlrev_b32 v3, 1, v3
  v_bfe_u32 v47, v2, 1, 1
  v_xor_b32 v3, v3, v47
  v_xor_b32 v47, 0, v3
  v_lshl_add_u32 v16, v47, 4, v1
  v_xor_b32 v24, 0x4000, v16
  v_xor_b32 v47, 2, v3
  v_lshl_add_u32 v17, v47, 4, v1
  v_xor_b32 v25, 0x4000, v17
  v_xor_b32 v47, 4, v3
  v_lshl_add_u32 v18, v47, 4, v1
  v_xor_b32 v26, 0x4000, v18
  v_xor_b32 v47, 6, v3
  v_lshl_add_u32 v19, v47, 4, v1
  v_xor_b32 v27, 0x4000, v19
  v_xor_b32 v47, 8, v3
  v_lshl_add_u32 v20, v47, 4, v1
  v_xor_b32 v28, 0x4000, v20
  v_xor_b32 v47, 10, v3
  v_lshl_add_u32 v21, v47, 4, v1
  v_xor_b32 v29, 0x4000, v21
  v_xor_b32 v47, 12, v3
  v_lshl_add_u32 v22, v47, 4, v1
  v_xor_b32 v30, 0x4000, v22
  v_xor_b32 v47, 14, v3
  v_lshl_add_u32 v23, v47, 4, v1
  v_xor_b32 v31, 0x4000, v23
  s_lshl_b32 s42, s3, 12
  s_add_u32 s42, s42, 131072
  v_lshlrev_b32 v32, 3, v2
  v_add_u32 v32, s42, v32
  v_xor_b32 v33, 0x1000, v32
  s_lshl_b32 s41, s3, 8
  s_add_u32 s41, s41, 147456
  v_and_b32 v3, 15, v2
  v_lshl_add_u32 v3, v3, 4, s41
  v_lshrrev_b32 v1, 4, v2
  v_lshl_add_u32 v1, v1, 2, v3
  v_xor_b32 v47, 0x100, v3
  v_mov_b32 v4, 0xff800000
  v_mov_b32 v5, 0xff800000
  v_mov_b32 v6, 0xff800000
  v_mov_b32 v7, 0xff800000
  s_mov_b32 s33, 32
  s_lshl_b32 s34, s5, 15
  s_add_u32 s34, s34, s32
  s_add_u32 s35, s34, 4096
  s_add_u32 s36, s34, 32768
  s_and_b32 s36, s36, 0xfffff
  s_add_u32 s37, s36, 4096
K1_FBL:
  s_barrier
  s_add_u32 s34, s34, 32768
  s_and_b32 s34, s34, 0xfffff
  s_add_u32 s35, s34, 4096
  s_add_u32 m0, s32, 0
  s_nop 0
  buffer_load_dwordx4 v34, s[8:11], s34 offen lds
  buffer_load_dwordx4 v35, s[8:11], s34 offen offset:1024 lds
  buffer_load_dwordx4 v36, s[8:11], s34 offen offset:2048 lds
  buffer_load_dwordx4 v37, s[8:11], s34 offen offset:3072 lds
  s_add_u32 m0, s32, 4096
  s_nop 0
  buffer_load_dwordx4 v34, s[8:11], s35 offen lds
  buffer_load_dwordx4 v35, s[8:11], s35 offen offset:1024 lds
  buffer_load_dwordx4 v36, s[8:11], s35 offen offset:2048 lds
  buffer_load_dwordx4 v37, s[8:11], s35 offen offset:3072 lds
  s_waitcnt vmcnt(0)
  s_barrier
  ds_read_b128 a[128:131], v8 offset:0
  ds_read_b128 a[132:135], v9 offset:0
  ds_read_b128 a[136:139], v10 offset:0
  ds_read_b128 a[140:143], v11 offset:0
  ds_read_b128 a[144:147], v12 offset:0
  ds_read_b128 a[148:151], v13 offset:0
  ds_read_b128 a[152:155], v14 offset:0
  ds_read_b128 a[156:159], v15 offset:0
  ds_read_b128 a[160:163], v8 offset:8192
  ds_read_b128 a[164:167], v9 offset:8192
  ds_read_b128 a[168:171], v10 offset:8192
  ds_read_b128 a[172:175], v11 offset:8192
  ds_read_b128 a[176:179], v12 offset:8192
  ds_read_b128 a[180:183], v13 offset:8192
  ds_read_b128 a[184:187], v14 offset:8192
  ds_read_b128 a[188:191], v15 offset:8192
  s_waitcnt lgkmcnt(0)
  v_mfma_f32_16x16x32_bf16 v[64:67], a[128:131], a[0:3], 0
  v_mfma_f32_16x16x32_bf16 v[64:67], a[132:135], a[16:19], v[64:67]
  v_mfma_f32_16x16x32_bf16 v[64:67], a[136:139], a[32:35], v[64:67]
  v_mfma_f32_16x16x32_bf16 v[64:67], a[140:143], a[48:51], v[64:67]
  v_mfma_f32_16x16x32_bf16 v[64:67], a[144:147], a[64:67], v[64:67]
  v_mfma_f32_16x16x32_bf16 v[64:67], a[148:151], a[80:83], v[64:67]
  v_mfma_f32_16x16x32_bf16 v[64:67], a[152:155], a[96:99], v[64:67]
  v_mfma_f32_16x16x32_bf16 v[64:67], a[156:159], a[112:115], v[64:67]
  v_mfma_f32_16x16x32_bf16 v[68:71], a[128:131], a[4:7], 0
  v_mfma_f32_16x16x32_bf16 v[68:71], a[132:135], a[20:23], v[68:71]
  v_mfma_f32_16x16x32_bf16 v[68:71], a[136:139], a[36:39], v[68:71]
  v_mfma_f32_16x16x32_bf16 v[68:71], a[140:143], a[52:55], v[68:71]
  v_mfma_f32_16x16x32_bf16 v[68:71], a[144:147], a[68:71], v[68:71]
  v_mfma_f32_16x16x32_bf16 v[68:71], a[148:151], a[84:87], v[68:71]
  v_mfma_f32_16x16x32_bf16 v[68:71], a[152:155], a[100:103], v[68:71]
  v_mfma_f32_16x16x32_bf16 v[68:71], a[156:159], a[116:119], v[68:71]
  v_mfma_f32_16x16x32_bf16 v[72:75], a[128:131], a[8:11], 0
  v_mfma_f32_16x16x32_bf16 v[72:75], a[132:135], a[24:27], v[72:75]
  v_mfma_f32_16x16x32_bf16 v[72:75], a[136:139], a[40:43], v[72:75]
  v_mfma_f32_16x16x32_bf16 v[72:75], a[140:143], a[56:59], v[72:75]
  v_mfma_f32_16x16x32_bf16 v[72:75], a[144:147], a[72:75], v[72:75]
  v_mfma_f32_16x16x32_bf16 v[72:75], a[148:151], a[88:91], v[72:75]
  v_mfma_f32_16x16x32_bf16 v[72:75], a[152:155], a[104:107], v[72:75]
  v_mfma_f32_16x16x32_bf16 v[72:75], a[156:159], a[120:123], v[72:75]
  v_mfma_f32_16x16x32_bf16 v[76:79], a[128:131], a[12:15], 0
  v_mfma_f32_16x16x32_bf16 v[76:79], a[132:135], a[28:31], v[76:79]
  v_mfma_f32_16x16x32_bf16 v[76:79], a[136:139], a[44:47], v[76:79]
  v_mfma_f32_16x16x32_bf16 v[76:79], a[140:143], a[60:63], v[76:79]
  v_mfma_f32_16x16x32_bf16 v[76:79], a[144:147], a[76:79], v[76:79]
  v_mfma_f32_16x16x32_bf16 v[76:79], a[148:151], a[92:95], v[76:79]
  v_mfma_f32_16x16x32_bf16 v[76:79], a[152:155], a[108:111], v[76:79]
  v_mfma_f32_16x16x32_bf16 v[76:79], a[156:159], a[124:127], v[76:79]
  v_mfma_f32_16x16x32_bf16 v[80:83], a[160:163], a[0:3], 0
  v_mfma_f32_16x16x32_bf16 v[80:83], a[164:167], a[16:19], v[80:83]
  v_mfma_f32_16x16x32_bf16 v[80:83], a[168:171], a[32:35], v[80:83]
  v_mfma_f32_16x16x32_bf16 v[80:83], a[172:175], a[48:51], v[80:83]
  v_mfma_f32_16x16x32_bf16 v[80:83], a[176:179], a[64:67], v[80:83]
  v_mfma_f32_16x16x32_bf16 v[80:83], a[180:183], a[80:83], v[80:83]
  v_mfma_f32_16x16x32_bf16 v[80:83], a[184:187], a[96:99], v[80:83]
  v_mfma_f32_16x16x32_bf16 v[80:83], a[188:191], a[112:115], v[80:83]
  v_mfma_f32_16x16x32_bf16 v[84:87], a[160:163], a[4:7], 0
  v_mfma_f32_16x16x32_bf16 v[84:87], a[164:167], a[20:23], v[84:87]
  v_mfma_f32_16x16x32_bf16 v[84:87], a[168:171], a[36:39], v[84:87]
  v_mfma_f32_16x16x32_bf16 v[84:87], a[172:175], a[52:55], v[84:87]
  v_mfma_f32_16x16x32_bf16 v[84:87], a[176:179], a[68:71], v[84:87]
  v_mfma_f32_16x16x32_bf16 v[84:87], a[180:183], a[84:87], v[84:87]
  v_mfma_f32_16x16x32_bf16 v[84:87], a[184:187], a[100:103], v[84:87]
  v_mfma_f32_16x16x32_bf16 v[84:87], a[188:191], a[116:119], v[84:87]
  v_mfma_f32_16x16x32_bf16 v[88:91], a[160:163], a[8:11], 0
  v_mfma_f32_16x16x32_bf16 v[88:91], a[164:167], a[24:27], v[88:91]
  v_mfma_f32_16x16x32_bf16 v[88:91], a[168:171], a[40:43], v[88:91]
  v_mfma_f32_16x16x32_bf16 v[88:91], a[172:175], a[56:59], v[88:91]
  v_mfma_f32_16x16x32_bf16 v[88:91], a[176:179], a[72:75], v[88:91]
  v_mfma_f32_16x16x32_bf16 v[88:91], a[180:183], a[88:91], v[88:91]
  v_mfma_f32_16x16x32_bf16 v[88:91], a[184:187], a[104:107], v[88:91]
  v_mfma_f32_16x16x32_bf16 v[88:91], a[188:191], a[120:123], v[88:91]
  v_mfma_f32_16x16x32_bf16 v[92:95], a[160:163], a[12:15], 0
  v_mfma_f32_16x16x32_bf16 v[92:95], a[164:167], a[28:31], v[92:95]
  v_mfma_f32_16x16x32_bf16 v[92:95], a[168:171], a[44:47], v[92:95]
  v_mfma_f32_16x16x32_bf16 v[92:95], a[172:175], a[60:63], v[92:95]
  v_mfma_f32_16x16x32_bf16 v[92:95], a[176:179], a[76:79], v[92:95]
  v_mfma_f32_16x16x32_bf16 v[92:95], a[180:183], a[92:95], v[92:95]
  v_mfma_f32_16x16x32_bf16 v[92:95], a[184:187], a[108:111], v[92:95]
  v_mfma_f32_16x16x32_bf16 v[92:95], a[188:191], a[124:127], v[92:95]
  s_nop 7
  v_max3_f32 v4, v4, v64, v65
  v_max3_f32 v5, v5, v68, v69
  v_max3_f32 v6, v6, v72, v73
  v_max3_f32 v7, v7, v76, v77
  v_max3_f32 v4, v4, v66, v67
  v_max3_f32 v5, v5, v70, v71
  v_max3_f32 v6, v6, v74, v75
  v_max3_f32 v7, v7, v78, v79
  v_max3_f32 v4, v4, v80, v81
  v_max3_f32 v5, v5, v84, v85
  v_max3_f32 v6, v6, v88, v89
  v_max3_f32 v7, v7, v92, v93
  v_max3_f32 v4, v4, v82, v83
  v_max3_f32 v5, v5, v86, v87
  v_max3_f32 v6, v6, v90, v91
  v_max3_f32 v7, v7, v94, v95
  s_sub_u32 s33, s33, 1
  s_cmp_lg_u32 s33, 0
  s_cbranch_scc1 K1_FBL
  s_add_u32 m0, s32, 32768
  s_nop 0
  buffer_load_dwordx4 v34, s[8:11], s36 offen lds
  buffer_load_dwordx4 v35, s[8:11], s36 offen offset:1024 lds
  buffer_load_dwordx4 v36, s[8:11], s36 offen offset:2048 lds
  buffer_load_dwordx4 v37, s[8:11], s36 offen offset:3072 lds
  s_add_u32 m0, s32, 36864
  s_nop 0
  buffer_load_dwordx4 v34, s[8:11], s37 offen lds
  buffer_load_dwordx4 v35, s[8:11], s37 offen offset:1024 lds
  buffer_load_dwordx4 v36, s[8:11], s37 offen offset:2048 lds
  buffer_load_dwordx4 v37, s[8:11], s37 offen offset:3072 lds
  s_add_u32 m0, s32, 65536
  s_nop 0
  buffer_load_dwordx4 v38, s[12:15], s34 offen lds
  buffer_load_dwordx4 v39, s[12:15], s34 offen offset:1024 lds
  buffer_load_dwordx4 v40, s[12:15], s34 offen offset:2048 lds
  buffer_load_dwordx4 v41, s[12:15], s34 offen offset:3072 lds
  s_add_u32 m0, s32, 69632
  s_nop 0
  buffer_load_dwordx4 v38, s[12:15], s35 offen lds
  buffer_load_dwordx4 v39, s[12:15], s35 offen offset:1024 lds
  buffer_load_dwordx4 v40, s[12:15], s35 offen offset:2048 lds
  buffer_load_dwordx4 v41, s[12:15], s35 offen offset:3072 lds
  v_permlane16_swap_b32 v4, v5
  v_permlane16_swap_b32 v6, v7
  v_max_f32 v4, v4, v5
  v_max_f32 v6, v6, v7
  s_nop 1
  v_permlane32_swap_b32 v4, v6
  v_max_f32 v4, v4, v6
  ds_write_b32 v1, v4
  v_mfma_f32_16x16x32_bf16 v[80:83], a[160:163], a[0:3], 0
  v_mfma_f32_16x16x32_bf16 v[80:83], a[164:167], a[16:19], v[80:83]
  v_mfma_f32_16x16x32_bf16 v[84:87], a[160:163], a[4:7], 0
  v_mfma_f32_16x16x32_bf16 v[84:87], a[164:167], a[20:23], v[84:87]
  v_mfma_f32_16x16x32_bf16 v[88:91], a[160:163], a[8:11], 0
  v_mfma_f32_16x16x32_bf16 v[88:91], a[164:167], a[24:27], v[88:91]
  v_mfma_f32_16x16x32_bf16 v[92:95], a[160:163], a[12:15], 0
  v_mfma_f32_16x16x32_bf16 v[92:95], a[164:167], a[28:31], v[92:95]
  v_mfma_f32_16x16x32_bf16 v[80:83], a[176:179], a[64:67], v[80:83]
  s_nop 7
  s_waitcnt vmcnt(0) lgkmcnt(0)
  s_barrier
  s_branch K1_J
K1_TMO:
  s_waitcnt vmcnt(0) lgkmcnt(0)
  v_mov_b32 v100, 1
  ds_write2_b32 v47, v100, v100 offset0:128 offset1:129
  s_waitcnt lgkmcnt(0)
  s_branch K1_GOT
K1_LOC:
  s_bitset1_b32 s39, 14
  s_mov_b32 s58, 0
K1_LOCL:
  s_barrier
  v_lshrrev_b32 v116, 2, v0
  v_and_b32 v117, 3, v0
  v_mul_u32_u24 v118, 5376, v116
  v_lshl_add_u32 v118, v117, 4, v118
  v_lshlrev_b32 v119, 1, v116
  s_lshl_b32 s59, s58, 6
  buffer_load_short_d16_hi v72, v119, s[84:87], 0 offen offset:0
  buffer_load_short_d16_hi v73, v119, s[84:87], 0 offen offset:128
  buffer_load_short_d16_hi v74, v119, s[84:87], 0 offen offset:256
  buffer_load_short_d16_hi v75, v119, s[84:87], 0 offen offset:384
  buffer_load_short_d16_hi v76, v119, s[84:87], 0 offen offset:512
  buffer_load_short_d16_hi v77, v119, s[84:87], 0 offen offset:640
  buffer_load_short_d16_hi v78, v119, s[84:87], 0 offen offset:768
  buffer_load_dwordx4 v[80:83], v118, s[80:83], s59 offen nt
  s_add_u32 s59, s59, 344064
  buffer_load_dwordx4 v[84:87], v118, s[80:83], s59 offen nt
  s_add_u32 s59, s59, 344064
  buffer_load_dwordx4 v[88:91], v118, s[80:83], s59 offen nt
  s_add_u32 s59, s59, 344064
  buffer_load_dwordx4 v[92:95], v118, s[80:83], s59 offen nt
  s_add_u32 s59, s59, 344064
  buffer_load_dwordx4 v[96:99], v118, s[80:83], s59 offen nt
  s_add_u32 s59, s59, 344064
  buffer_load_dwordx4 v[100:103], v118, s[80:83], s59 offen nt
  s_add_u32 s59, s59, 344064
  buffer_load_dwordx4 v[104:107], v118, s[80:83], s59 offen nt
  s_waitcnt vmcnt(7)
  v_and_b32 v72, 0xffff0000, v72
  v_and_b32 v73, 0xffff0000, v73
  v_and_b32 v74, 0xffff0000, v74
  v_and_b32 v75, 0xffff0000, v75
  v_and_b32 v76, 0xffff0000, v76
  v_and_b32 v77, 0xffff0000, v77
  v_and_b32 v78, 0xffff0000, v78
  v_mul_f32 v116, 0xbfb8aa3b, v72
  v_mul_f32 v117, 0xbfb8aa3b, v73
  v_mul_f32 v118, 0xbfb8aa3b, v74
  v_mul_f32 v119, 0xbfb8aa3b, v75
  v_mul_f32 v120, 0xbfb8aa3b, v76
  v_mul_f32 v121, 0xbfb8aa3b, v77
  v_mul_f32 v122, 0xbfb8aa3b, v78
  v_exp_f32 v116, v116
  v_exp_f32 v117, v117
  v_exp_f32 v118, v118
  v_exp_f32 v119, v119
  v_exp_f32 v120, v120
  v_exp_f32 v121, v121
  v_exp_f32 v122, v122
  v_add_f32 v116, 1.0, v116
  v_add_f32 v117, 1.0, v117
  v_add_f32 v118, 1.0, v118
  v_add_f32 v119, 1.0, v119
  v_add_f32 v120, 1.0, v120
  v_add_f32 v121, 1.0, v121
  v_add_f32 v122, 1.0, v122
  v_rcp_f32 v116, v116
  v_rcp_f32 v117, v117
  v_rcp_f32 v118, v118
  v_rcp_f32 v119, v119
  v_rcp_f32 v120, v120
  v_rcp_f32 v121, v121
  v_rcp_f32 v122, v122
  v_mul_f32 v72, v72, v116
  v_mul_f32 v73, v73, v117
  v_mul_f32 v74, v74, v118
  v_mul_f32 v75, v75, v119
  v_mul_f32 v76, v76, v120
  v_mul_f32 v77, v77, v121
  v_mul_f32 v78, v78, v122
  v_cvt_pk_bf16_f32 v72, v72, v73
  v_cvt_pk_bf16_f32 v73, v74, v75
  v_cvt_pk_bf16_f32 v74, v76, v77
  v_cvt_pk_bf16_f32 v75, v78, 0
  s_mov_b32 s60, 0x05040100
  s_mov_b32 s61, 0x07060302
  v_lshlrev_b32 v76, 5, v0
  s_waitcnt vmcnt(5)
  v_perm_b32 v116, v84, v80, s60
  v_perm_b32 v117, v84, v80, s61
  v_perm_b32 v118, v85, v81, s60
  v_perm_b32 v119, v85, v81, s61
  v_perm_b32 v120, v86, v82, s60
  v_perm_b32 v121, v86, v82, s61
  v_perm_b32 v122, v87, v83, s60
  v_perm_b32 v123, v87, v83, s61
  v_dot2_f32_bf16 v108, v116, v72, 0
  v_dot2_f32_bf16 v109, v117, v72, 0
  v_dot2_f32_bf16 v110, v118, v72, 0
  v_dot2_f32_bf16 v111, v119, v72, 0
  v_dot2_f32_bf16 v112, v120, v72, 0
  v_dot2_f32_bf16 v113, v121, v72, 0
  v_dot2_f32_bf16 v114, v122, v72, 0
  v_dot2_f32_bf16 v115, v123, v72, 0
  s_waitcnt vmcnt(3)
  v_perm_b32 v116, v92, v88, s60
  v_perm_b32 v117, v92, v88, s61
  v_perm_b32 v118, v93, v89, s60
  v_perm_b32 v119, v93, v89, s61
  v_perm_b32 v120, v94, v90, s60
  v_perm_b32 v121, v94, v90, s61
  v_perm_b32 v122, v95, v91, s60
  v_perm_b32 v123, v95, v91, s61
  v_dot2_f32_bf16 v108, v116, v73, v108
  v_dot2_f32_bf16 v109, v117, v73, v109
  v_dot2_f32_bf16 v110, v118, v73, v110
  v_dot2_f32_bf16 v111, v119, v73, v111
  v_dot2_f32_bf16 v112, v120, v73, v112
  v_dot2_f32_bf16 v113, v121, v73, v113
  v_dot2_f32_bf16 v114, v122, v73, v114
  v_dot2_f32_bf16 v115, v123, v73, v115
  s_waitcnt vmcnt(1)
  v_perm_b32 v116, v100, v96, s60
  v_perm_b32 v117, v100, v96, s61
  v_perm_b32 v118, v101, v97, s60
  v_perm_b32 v119, v101, v97, s61
  v_perm_b32 v120, v102, v98, s60
  v_perm_b32 v121, v102, v98, s61
  v_perm_b32 v122, v103, v99, s60
  v_perm_b32 v123, v103, v99, s61
  v_dot2_f32_bf16 v108, v116, v74, v108
  v_dot2_f32_bf16 v109, v117, v74, v109
  v_dot2_f32_bf16 v110, v118, v74, v110
  v_dot2_f32_bf16 v111, v119, v74, v111
  v_dot2_f32_bf16 v112, v120, v74, v112
  v_dot2_f32_bf16 v113, v121, v74, v113
  v_dot2_f32_bf16 v114, v122, v74, v114
  v_dot2_f32_bf16 v115, v123, v74, v115
  s_waitcnt vmcnt(0)
  v_perm_b32 v116, v104, v104, s60
  v_perm_b32 v117, v104, v104, s61
  v_perm_b32 v118, v105, v105, s60
  v_perm_b32 v119, v105, v105, s61
  v_perm_b32 v120, v106, v106, s60
  v_perm_b32 v121, v106, v106, s61
  v_perm_b32 v122, v107, v107, s60
  v_perm_b32 v123, v107, v107, s61
  v_dot2_f32_bf16 v108, v116, v75, v108
  v_dot2_f32_bf16 v109, v117, v75, v109
  v_dot2_f32_bf16 v110, v118, v75, v110
  v_dot2_f32_bf16 v111, v119, v75, v111
  v_dot2_f32_bf16 v112, v120, v75, v112
  v_dot2_f32_bf16 v113, v121, v75, v113
  v_dot2_f32_bf16 v114, v122, v75, v114
  v_dot2_f32_bf16 v115, v123, v75, v115
  ds_write_b128 v76, v[108:111]
  s_nop 2
  ds_write_b128 v76, v[112:115] offset:16
  s_mul_i32 s60, s58, 4682
  s_lshr_b32 s60, s60, 16
  s_waitcnt lgkmcnt(0)
  s_barrier
  s_cmp_lg_u32 s3, 0
  s_cbranch_scc1 K1_LOCN
  v_and_b32 v72, 31, v2
  v_lshrrev_b32 v73, 5, v2
  v_lshlrev_b32 v74, 2, v72
  v_lshl_add_u32 v74, v73, 12, v74
  v_add_u32 v75, 128, v74
  ds_read2st64_b32 v[80:81], v74 offset0:0 offset1:1
  ds_read2st64_b32 v[82:83], v75 offset0:0 offset1:1
  ds_read2st64_b32 v[84:85], v74 offset0:2 offset1:3
  ds_read2st64_b32 v[86:87], v75 offset0:2 offset1:3
  ds_read2st64_b32 v[88:89], v74 offset0:4 offset1:5
  ds_read2st64_b32 v[90:91], v75 offset0:4 offset1:5
  ds_read2st64_b32 v[92:93], v74 offset0:6 offset1:7
  ds_read2st64_b32 v[94:95], v75 offset0:6 offset1:7
  ds_read2st64_b32 v[96:97], v74 offset0:8 offset1:9
  ds_read2st64_b32 v[98:99], v75 offset0:8 offset1:9
  ds_read2st64_b32 v[100:101], v74 offset0:10 offset1:11
  ds_read2st64_b32 v[102:103], v75 offset0:10 offset1:11
  ds_read2st64_b32 v[104:105], v74 offset0:12 offset1:13
  ds_read2st64_b32 v[106:107], v75 offset0:12 offset1:13
  ds_read2st64_b32 v[108:109], v74 offset0:14 offset1:15
  ds_read2st64_b32 v[110:111], v75 offset0:14 offset1:15
  s_cmp_eq_u32 s60, 1
  s_cselect_b32 s61, 1.0, 0
  s_cmp_eq_u32 s60, 4
  s_cselect_b32 s61, 1.0, s61
  s_waitcnt lgkmcnt(12)
  v_pk_add_f32 v[80:81], v[80:81], v[82:83]
  v_pk_add_f32 v[84:85], v[84:85], v[86:87]
  v_pk_add_f32 v[80:81], v[80:81], v[84:85]
  s_waitcnt lgkmcnt(8)
  v_pk_add_f32 v[88:89], v[88:89], v[90:91]
  v_pk_add_f32 v[92:93], v[92:93], v[94:95]
  v_pk_add_f32 v[88:89], v[88:89], v[92:93]
  v_pk_add_f32 v[80:81], v[80:81], v[88:89]
  s_waitcnt lgkmcnt(4)
  v_pk_add_f32 v[96:97], v[96:97], v[98:99]
  v_pk_add_f32 v[100:101], v[100:101], v[102:103]
  v_pk_add_f32 v[96:97], v[96:97], v[100:101]
  v_pk_add_f32 v[80:81], v[80:81], v[96:97]
  s_waitcnt lgkmcnt(0)
  v_pk_add_f32 v[104:105], v[104:105], v[106:107]
  v_pk_add_f32 v[108:109], v[108:109], v[110:111]
  v_pk_add_f32 v[104:105], v[104:105], v[108:109]
  v_pk_add_f32 v[80:81], v[80:81], v[104:105]
  v_add_f32 v80, v80, v81
  v_mov_b32 v81, v80
  s_nop 1
  v_permlane32_swap_b32 v80, v81
  v_add_f32 v80, v80, v81
  v_cvt_pk_bf16_f32 v80, v80, v80
  v_and_b32 v80, 0xffff0000, v80
  v_add_f32 v80, s61, v80
  s_nop 1
  v_mov_b32_dpp v81, v80 quad_perm:[1,0,3,2] row_mask:0xf bank_mask:0xf
  v_cvt_pk_bf16_f32 v80, v80, v81
  s_lshl_b32 s61, s58, 6
  s_add_u32 s61, s61, 57344
  v_lshl_add_u32 v72, v2, 1, s61
  v_mov_b32 v73, 59136
  v_mov_b32 v74, 0
  ds_write_b32 v73, v74
  s_mov_b32 exec_lo, 0x55555555
  s_mov_b32 exec_hi, 0
  ds_write_b32 v72, v80
  s_mov_b64 exec, -1
  s_waitcnt lgkmcnt(0)
K1_LOCN:
  s_add_u32 s58, s58, 1
  s_cmp_lt_u32 s58, 28
  s_cbranch_scc1 K1_LOCL
  v_xor_b32 v72, 128, v64
  v_xor_b32 v73, 144, v64
  v_xor_b32 v74, 160, v64
  v_xor_b32 v75, 176, v64
  v_xor_b32 v76, 192, v64
  v_xor_b32 v77, 208, v64
  v_xor_b32 v78, 224, v64
  v_xor_b32 v79, 240, v64
  s_mov_b32 s60, 0x3db8aa3b
  s_mov_b32 s61, s60
  s_branch K1_GOT
CODE_END:
.section .rodata,"a"
.p2align 6
.amdhsa_kernel k1_kernel
  .amdhsa_next_free_vgpr 512
  .amdhsa_next_free_sgpr 102
  .amdhsa_accum_offset 256
  .amdhsa_group_segment_fixed_size 0
  .amdhsa_kernarg_size 112
  .amdhsa_user_sgpr_count 2
  .amdhsa_user_sgpr_kernarg_segment_ptr 1
  .amdhsa_system_sgpr_workgroup_id_x 1
.end_amdhsa_kernel
```
